```python
import torch

def _softmax(x, axis=-1):
    return torch.softmax(x, dim=axis)
def _gelu(x):
    return torch.nn.functional.gelu(x, approximate="tanh")
def _silu(x):
    return torch.nn.functional.silu(x)
def _sigmoid(x):
    return torch.sigmoid(x)
def _layernorm(x, axis=-1, eps=1e-5):
    m = x.mean(dim=axis, keepdim=True)
    v = x.var(dim=axis, keepdim=True, unbiased=False)
    return (x - m) / torch.sqrt(v + eps)
def _scatter_add(tgt, idx, src, axis=0):
    return tgt.clone().index_add_(axis, idx, src)
def _segment_sum(src, seg, n):
    out = torch.zeros((n,) + src.shape[1:], dtype=src.dtype)
    return out.index_add_(0, seg, src)
def _pad(x, pw):
    flat = tuple(v for pair in reversed(pw) for v in pair)
    return torch.nn.functional.pad(x, flat)

kernel_name = 'interleave_layers__gqa_block_cached__mixer_channel_mlp__decode'

def setup_inputs():

    _w = (lambda a: (lambda t: t.to(torch.bfloat16) if t.is_floating_point() else t)(torch.as_tensor(a)))
    def _A_setup():
        B, Sq, D = 1, 1, 640
        Hq, Hkv, Sk, Dh = 32, 32, 4096, 128
        assert Hq % Hkv == 0, (Hq, Hkv)
        return {
            "x": _w((lambda *s: torch.randn(*s, dtype=torch.bfloat16) * 0.05)(B, Sq, D)),
            "k_cache": _w((lambda *s: torch.randn(*s, dtype=torch.bfloat16) * 3.2)(B, Hkv, Sk, Dh)),
            "v_cache": _w((lambda *s: torch.randn(*s, dtype=torch.bfloat16) * 0.4)(B, Hkv, Sk, Dh)),
            "wq": _w((lambda *s: torch.randn(*s, dtype=torch.bfloat16) * 3.2)(D, Hq * Dh) * (D ** -0.5)),
            "wo": _w((lambda *s: torch.randn(*s, dtype=torch.bfloat16) * 0.4)(Hq * Dh, D) * ((Hq * Dh) ** -0.5)),
        }
    _A_in = _A_setup()

    def _B_setup():
        B, S, D, F = 1, 1, 640, 1728
        return {
            "x": _w((lambda *s: torch.randn(*s, dtype=torch.bfloat16) * 0.05)(B, S, D)),
            "w1": _w((lambda *s: torch.randn(*s, dtype=torch.bfloat16) * 0.4)(D, F) * (D ** -0.5)),
            "b1": _w((lambda *s: torch.randn(*s, dtype=torch.bfloat16) * 0.4)(F)),
            "w2": _w((lambda *s: torch.randn(*s, dtype=torch.bfloat16) * 0.4)(F, D) * (F ** -0.5)),
            "b2": _w((lambda *s: torch.randn(*s, dtype=torch.bfloat16) * 0.2)(D)),
        }
    _B_in = _B_setup()

    return {
        "A_x": _A_in["x"],
        "A_k_cache": _A_in["k_cache"],
        "A_v_cache": _A_in["v_cache"],
        "A_wq": _A_in["wq"],
        "A_wo": _A_in["wo"],
        "B_x": _B_in["x"],
        "B_w1": _B_in["w1"],
        "B_b1": _B_in["b1"],
        "B_w2": _B_in["w2"],
        "B_b2": _B_in["b2"],
    }

def reference(A_x, A_k_cache, A_v_cache, A_wq, A_wo, B_x, B_w1, B_b1, B_w2, B_b2):
    def _A_ref(x, k_cache, v_cache, wq, wo):
        B, Sq, D = x.shape
        Hq, Dh = 32, 128
        Hkv = k_cache.shape[1]
        rep = Hq // Hkv
        q = (lambda x, *d: x.permute(*d))((x @ wq).reshape(B, Sq, Hq, Dh), 0, 2, 1, 3)
        k = (lambda x, n, axis: torch.repeat_interleave(x, n, dim=axis))(k_cache, rep, axis=1)
        v = (lambda x, n, axis: torch.repeat_interleave(x, n, dim=axis))(v_cache, rep, axis=1)
        scores = torch.einsum("bhqd,bhkd->bhqk", q, k) * (Dh ** -0.5)
        p = _softmax(scores, axis=-1)
        o = torch.einsum("bhqk,bhkd->bhqd", p, v)
        return (lambda x, *d: x.permute(*d))(o, 0, 2, 1, 3).reshape(B, Sq, Hq * Dh) @ wo

    def _B_ref(x, w1, b1, w2, b2):
        y = _layernorm(x, axis=-1)
        h = _gelu(torch.einsum("bsd,df->bsf", y, w1) + b1)
        return torch.einsum("bsf,fd->bsd", h, w2) + b2

    x = A_x
    x = x + _A_ref(_layernorm(x, axis=-1), A_k_cache, A_v_cache, A_wq, A_wo)
    x = x + _B_ref(_layernorm(x, axis=-1), B_w1, B_b1, B_w2, B_b2)
    x = x + _A_ref(_layernorm(x, axis=-1), A_k_cache, A_v_cache, A_wq, A_wo)
    x = x + _B_ref(_layernorm(x, axis=-1), B_w1, B_b1, B_w2, B_b2)
    return x
```

```asm
; @launch grid=(256,1,1) block=(256,1,1) lds=12800
.amdgcn_target "amdgcn-amd-amdhsa--gfx950"
.text
.globl interleave_layers__gqa_block_cached__mixer_channel_mlp__decode_kernel
.p2align 8
.type interleave_layers__gqa_block_cached__mixer_channel_mlp__decode_kernel,@function
interleave_layers__gqa_block_cached__mixer_channel_mlp__decode_kernel:
L_top:
    s_cmp_lt_u32 s2, 256
    s_cbranch_scc1 L_go
    s_endpgm
L_go:
    s_load_dwordx16 s[80:95], s[0:1], 0
    s_load_dwordx2 s[16:17], s[0:1], 96
    v_lshrrev_b32 v1, 6, v0
    v_and_b32 v0, 63, v0
    v_readfirstlane_b32 s7, v1
    s_and_b32 s3, s2, 7
    s_lshr_b32 s4, s2, 3
    s_and_b32 s5, s4, 3
    s_lshr_b32 s6, s4, 2
    s_lshl_b32 s3, s3, 2
    s_lshr_b32 s3, 0x73625140, s3
    s_and_b32 s3, s3, 7
    s_lshl_b32 s75, s3, 2
    s_sub_u32 s67, s4, 10
    s_cmp_ge_u32 s67, 2
    s_cbranch_scc1 L_nopf
    s_getpc_b64 s[48:49]
L_pc:
    s_mov_b32 s50, L_fastend-L_pc+1024
    s_mov_b32 s51, 0x00020000
    s_lshl_b32 s67, s67, 2
    s_add_u32 s67, s67, s7
    s_lshl_b32 s67, s67, 13
    v_lshlrev_b32 v122, 7, v0
    buffer_load_dword a255, v122, s[48:51], s67 offen
    buffer_load_dword a254, v122, s[48:51], s67 offen offset:64
L_nopf:
    v_lshlrev_b32 v1, 4, v0
    v_and_b32 v114, 15, v0
    v_lshrrev_b32_e64 v115, 4, v0
    s_mov_b32 s73, s4
    s_sub_u32 s74, s4, 12
    s_mov_b32 s22, 0x500
    s_mov_b32 s23, 0x00020000
    s_mov_b32 s26, 0x500000
    s_mov_b32 s27, 0x00020000
    s_mov_b32 s30, 0x500000
    s_mov_b32 s31, 0x00020000
    v_lshlrev_b32 v116, 16, v115
    v_lshl_add_u32 v116, v114, 4, v116
    s_lshl_b32 s77, s4, 1
    s_add_u32 s68, s4, 8
    s_min_u32 s77, s77, s68
    s_lshl_b32 s72, s77, 18
    s_lshl_b32 s68, s75, 8
    s_add_u32 s72, s72, s68
    s_lshl_b32 s68, s7, 8
    s_add_u32 s72, s72, s68
    v_and_b32 v118, 0x38, v0
    v_lshl_add_u32 v118, s77, 6, v118
    v_and_b32 v120, 1, v115
    v_lshlrev_b32 v120, 6, v120
    v_lshrrev_b32 v122, 3, v114
    v_lshl_add_u32 v120, v122, 1, v120
    v_lshrrev_b32 v121, 1, v115
    v_add_u32 v120, v120, v121
    v_mul_u32_u24 v120, 1280, v120
    v_and_b32 v121, 7, v0
    v_lshl_add_u32 v117, v121, 4, v120
    s_and_b32 s67, s74, 1
    s_lshl_b32 s67, s67, 1
    s_lshr_b32 s68, s7, 1
    s_add_u32 s67, s67, s68
    s_xor_b32 s67, s67, s75
    s_lshl_b32 s67, s67, 7
    s_and_b32 s68, s7, 1
    s_lshl_b32 s68, s68, 2
    s_add_u32 s67, s67, s68
    s_mul_i32 s65, s67, 1280
    s_lshr_b32 s68, s74, 1
    s_lshl_b32 s68, s68, 7
    s_add_u32 s65, s65, s68
    s_cmp_ge_u32 s4, 12
    s_waitcnt lgkmcnt(0)
    s_mov_b64 s[28:29], s[88:89]
    s_cbranch_scc1 L_eB
    s_mov_b64 s[20:21], s[80:81]
    s_mov_b64 s[24:25], s[86:87]
    buffer_load_dwordx4 v[40:43], v1, s[20:23], 0 offen
    buffer_load_dwordx4 v[44:47], v1, s[20:23], 0 offen offset:1024
    buffer_load_dwordx2 v[32:33], v118, s[20:23], 0 offen
    buffer_load_dwordx2 v[28:29], v118, s[20:23], 0 offen offset:64
    buffer_load_dwordx4 v[128:131], v116, s[24:27], s72 offen nt
    s_add_u32 s72, s72, 8192
    buffer_load_dwordx4 v[132:135], v116, s[24:27], s72 offen nt
    s_add_u32 s72, s72, 8192
    buffer_load_dwordx4 v[136:139], v116, s[24:27], s72 offen nt
    s_add_u32 s72, s72, 8192
    buffer_load_dwordx4 v[140:143], v116, s[24:27], s72 offen nt
    s_add_u32 s72, s72, 8192
    buffer_load_dwordx4 v[144:147], v116, s[24:27], s72 offen nt
    s_add_u32 s72, s72, 8192
    buffer_load_dwordx4 v[148:151], v116, s[24:27], s72 offen nt
    s_add_u32 s72, s72, 8192
    buffer_load_dwordx4 v[152:155], v116, s[24:27], s72 offen nt
    s_add_u32 s72, s72, 8192
    buffer_load_dwordx4 v[156:159], v116, s[24:27], s72 offen nt
    s_add_u32 s72, s72, 204800
    s_cmp_ge_u32 s4, 8
    s_cbranch_scc1 L_roleC
    buffer_load_dwordx4 v[192:195], v116, s[24:27], s72 offen nt
    s_add_u32 s72, s72, 8192
    buffer_load_dwordx4 v[196:199], v116, s[24:27], s72 offen nt
    s_add_u32 s72, s72, 8192
    buffer_load_dwordx4 v[200:203], v116, s[24:27], s72 offen nt
    s_add_u32 s72, s72, 8192
    buffer_load_dwordx4 v[204:207], v116, s[24:27], s72 offen nt
    s_add_u32 s72, s72, 8192
    buffer_load_dwordx4 v[208:211], v116, s[24:27], s72 offen nt
    s_add_u32 s72, s72, 8192
    buffer_load_dwordx4 v[212:215], v116, s[24:27], s72 offen nt
    s_add_u32 s72, s72, 8192
    buffer_load_dwordx4 v[216:219], v116, s[24:27], s72 offen nt
    s_add_u32 s72, s72, 8192
    buffer_load_dwordx4 v[220:223], v116, s[24:27], s72 offen nt
    s_branch L_roleA
L_eB:
    s_cmp_ge_u32 s4, 16
    s_cbranch_scc1 L_nv
    s_cmp_lg_u32 s7, 0
    s_cbranch_scc1 L_nw
    s_mov_b32 s18, 0x10000000
    s_mov_b32 s19, 0x00020000
    s_mov_b64 exec, 1
    s_lshl_b32 s67, s3, 3
    s_add_u32 s67, s67, s74
    s_lshl_b32 s67, s67, 7
    s_add_u32 s67, s67, 0xd4000
    v_mov_b32 v32, 0
    v_mov_b32 v33, 0
    v_mov_b32 v34, 0
    v_mov_b32 v35, 0x2000
    buffer_atomic_or v32, v34, s[16:19], s67 offen sc0 sc1
    buffer_atomic_or v33, v35, s[16:19], s67 offen sc0 sc1
    s_mov_b64 exec, -1
L_nw:
    s_barrier
L_nv:
    buffer_load_dwordx4 v[192:195], v117, s[28:31], s65 offen nt
    s_add_u32 s65, s65, 10240
    buffer_load_dwordx4 v[196:199], v117, s[28:31], s65 offen nt
    s_add_u32 s65, s65, 10240
    buffer_load_dwordx4 v[200:203], v117, s[28:31], s65 offen nt
    s_add_u32 s65, s65, 10240
    buffer_load_dwordx4 v[204:207], v117, s[28:31], s65 offen nt
    s_add_u32 s65, s65, 10240
    buffer_load_dwordx4 v[208:211], v117, s[28:31], s65 offen nt
    s_add_u32 s65, s65, 10240
    buffer_load_dwordx4 v[212:215], v117, s[28:31], s65 offen nt
    s_add_u32 s65, s65, 10240
    s_lshl_b32 s67, s7, 5
    s_add_u32 s67, s67, s4
    s_cmp_ge_u32 s67, 16
    s_cbranch_scc1 L_nt
    s_waitcnt vmcnt(7)
    s_memtime s[88:89]
    s_waitcnt vmcnt(6)
    s_memtime s[90:91]
    s_waitcnt lgkmcnt(0)
    s_sub_u32 s88, s90, s88
L_nt:
    s_branch L_roleB
    s_nop 0
    s_nop 0
    s_nop 0
    s_nop 0
    s_nop 0
    s_nop 0
    s_nop 0
    s_nop 0
    s_nop 0
    s_nop 0
    s_nop 0
    s_nop 0
    s_nop 0
    s_nop 0
    s_nop 0
    s_nop 0
    s_nop 0
    s_nop 0
    s_nop 0
    s_nop 0
    s_nop 0
    s_nop 0
    s_nop 0
    s_nop 0
    s_nop 0
    s_nop 0
    s_nop 0
    s_nop 0
    s_nop 0
    s_nop 0
    s_nop 0
    s_nop 0
    s_nop 0
    s_nop 0
    s_nop 0
    s_nop 0
    s_nop 0
    s_nop 0
    s_nop 0
    s_nop 0
    s_nop 0
    s_nop 0
    s_nop 0
    s_nop 0
    s_nop 0
    s_nop 0
    s_nop 0
    s_nop 0
    s_nop 0
    s_nop 0
    s_nop 0
    s_nop 0
    s_nop 0
    s_nop 0
    s_nop 0
    s_nop 0
    s_nop 0
    s_nop 0
    s_nop 0
    s_nop 0
    s_nop 0
    s_nop 0
    s_nop 0
    s_nop 0
    s_nop 0
    s_nop 0
    s_nop 0
    s_nop 0
    s_nop 0
    s_nop 0
    s_nop 0
    s_nop 0
    s_nop 0
    s_nop 0
    s_nop 0
    s_nop 0
    s_nop 0
    s_nop 0
    s_nop 0
    s_nop 0
    s_nop 0
    s_nop 0
    s_nop 0
    s_nop 0
    s_nop 0
    s_nop 0
    s_nop 0
    s_nop 0
    s_nop 0
    s_nop 0
    s_nop 0
    s_nop 0
    s_nop 0
    s_nop 0
    s_nop 0
    s_nop 0
    s_nop 0
    s_nop 0
    s_nop 0
    s_nop 0
    s_nop 0
    s_nop 0
    s_nop 0
    s_nop 0
    s_nop 0
    s_nop 0
    s_nop 0
    s_nop 0
    s_nop 0
    s_nop 0
    s_nop 0
    s_nop 0
    s_nop 0
    s_nop 0
    s_nop 0
    s_nop 0
    s_nop 0
    s_nop 0
    s_nop 0
    s_nop 0
    s_nop 0
    s_nop 0
    s_nop 0
    s_nop 0
    s_nop 0
    s_nop 0
    s_nop 0
    s_nop 0
    s_nop 0
    s_nop 0
    s_nop 0
    s_nop 0
    s_nop 0
    s_nop 0
    s_nop 0
    s_nop 0
    s_nop 0
    s_nop 0
    s_nop 0
    s_nop 0
    s_nop 0
    s_nop 0
    s_nop 0
    s_nop 0
    s_nop 0
    s_nop 0
    s_nop 0
    s_nop 0
    s_nop 0
    s_nop 0
    s_nop 0
    s_nop 0
    s_nop 0
    s_nop 0
    s_nop 0
    s_nop 0
    s_nop 0
    s_nop 0
    s_nop 0
    s_nop 0
    s_nop 0
    s_nop 0
    s_nop 0
    s_nop 0
    s_nop 0
    s_nop 0
    s_nop 0
    s_nop 0
    s_nop 0
    s_nop 0
    s_nop 0
    s_nop 0
    s_nop 0
    s_nop 0
    s_nop 0
    s_nop 0
    s_nop 0
    s_nop 0
    s_nop 0
    s_nop 0
    s_nop 0
    s_nop 0
    s_nop 0
    s_nop 0
    s_nop 0
    s_nop 0
    s_nop 0
    s_nop 0
    s_nop 0
    s_nop 0
    s_nop 0
    s_nop 0
    s_nop 0
    s_nop 0
    s_nop 0
    s_nop 0
    s_nop 0
    s_nop 0
    s_nop 0
    s_nop 0
    s_nop 0
    s_nop 0
    s_nop 0
    s_nop 0
    s_nop 0
    s_nop 0
    s_nop 0
    s_nop 0
    s_nop 0
    s_nop 0
    s_nop 0
    s_nop 0
    s_nop 0
    s_nop 0
    s_nop 0
    s_nop 0
    s_nop 0
    s_nop 0
    s_nop 0
    s_nop 0
    s_nop 0
    s_nop 0
    s_nop 0
    s_nop 0
    s_nop 0
    s_nop 0
    s_nop 0
    s_nop 0
    s_nop 0
    s_nop 0
    s_nop 0
    s_nop 0
    s_nop 0
    s_nop 0
    s_nop 0
    s_nop 0
    s_nop 0
    s_nop 0
    s_nop 0
    s_nop 0
    s_nop 0
    s_nop 0
    s_nop 0
    s_nop 0
    s_nop 0
    s_nop 0
    s_nop 0
    s_nop 0
    s_nop 0
    s_nop 0
    s_nop 0
    s_nop 0
    s_nop 0
    s_nop 0
    s_nop 0
    s_nop 0
    s_nop 0
    s_nop 0
    s_nop 0
    s_nop 0
    s_nop 0
    s_nop 0
    s_nop 0
    s_nop 0
    s_nop 0
    s_nop 0
    s_nop 0
    s_nop 0
    s_nop 0
    s_nop 0
    s_nop 0
    s_nop 0
    s_nop 0
    s_nop 0
    s_nop 0
    s_nop 0
    s_nop 0
    s_nop 0
    s_nop 0
    s_nop 0
    s_nop 0
    s_nop 0
    s_nop 0
    s_nop 0
    s_nop 0
    s_nop 0
    s_nop 0
    s_nop 0
    s_nop 0
    s_nop 0
    s_nop 0
    s_nop 0
    s_nop 0
    s_nop 0
    s_nop 0
    s_nop 0
    s_nop 0
    s_nop 0
    s_nop 0
    s_nop 0
    s_nop 0
    s_nop 0
    s_nop 0
    s_nop 0
    s_nop 0
    s_nop 0
    s_nop 0
    s_nop 0
    s_nop 0
    s_nop 0
    s_nop 0
    s_nop 0
    s_nop 0
    s_nop 0
    s_nop 0
    s_nop 0
    s_nop 0
    s_nop 0
    s_nop 0
    s_nop 0
    s_nop 0
    s_nop 0
    s_nop 0
    s_nop 0
    s_nop 0
    s_nop 0
    s_nop 0
    s_nop 0
    s_nop 0
    s_nop 0
    s_nop 0
    s_nop 0
    s_nop 0
    s_nop 0
    s_nop 0
    s_nop 0
    s_nop 0
    s_nop 0
    s_nop 0
    s_nop 0
    s_nop 0
    s_nop 0
    s_nop 0
    s_nop 0
    s_nop 0
    s_nop 0
    s_nop 0
    s_nop 0
    s_nop 0
    s_nop 0
    s_nop 0
    s_nop 0
    s_nop 0
    s_nop 0
    s_nop 0
    s_nop 0
    s_nop 0
    s_nop 0
    s_nop 0
    s_nop 0
    s_nop 0
    s_nop 0
    s_nop 0
    s_nop 0
    s_nop 0
    s_nop 0
    s_nop 0
    s_nop 0
    s_nop 0
    s_nop 0
    s_nop 0
    s_nop 0
    s_nop 0
    s_nop 0
    s_nop 0
    s_nop 0
    s_nop 0
    s_nop 0
    s_nop 0
    s_nop 0
    s_nop 0
    s_nop 0
    s_nop 0
    s_nop 0
    s_nop 0
    s_nop 0
    s_nop 0
    s_nop 0
    s_nop 0
    s_nop 0
    s_nop 0
    s_nop 0
    s_nop 0
    s_nop 0
    s_nop 0
    s_nop 0
    s_nop 0
    s_nop 0
    s_nop 0
    s_nop 0
    s_nop 0
    s_nop 0
    s_nop 0
    s_nop 0
    s_nop 0
    s_nop 0
    s_nop 0
    s_nop 0
    s_nop 0
    s_nop 0
    s_nop 0
    s_nop 0
    s_nop 0
    s_nop 0
    s_nop 0
    s_nop 0
    s_nop 0
    s_nop 0
    s_nop 0
    s_nop 0
    s_nop 0
    s_nop 0
    s_nop 0
    s_nop 0
    s_nop 0
    s_nop 0
    s_nop 0
    s_nop 0
    s_nop 0
    s_nop 0
    s_nop 0
    s_nop 0
    s_nop 0
    s_nop 0
    s_nop 0
    s_nop 0
    s_nop 0
    s_nop 0
    s_nop 0
    s_nop 0
    s_nop 0
    s_nop 0
    s_nop 0
    s_nop 0
    s_nop 0
    s_nop 0
    s_nop 0
    s_nop 0
    s_nop 0
    s_nop 0
    s_nop 0
    s_nop 0
    s_nop 0
    s_nop 0
    s_nop 0
    s_nop 0
    s_nop 0
    s_nop 0
    s_nop 0
    s_nop 0
    s_nop 0
    s_nop 0
    s_nop 0
    s_nop 0
    s_nop 0
    s_nop 0
    s_nop 0
    s_nop 0
    s_nop 0
    s_nop 0
    s_nop 0
    s_nop 0
    s_nop 0
    s_nop 0
    s_nop 0
    s_nop 0
    s_nop 0
    s_nop 0
    s_nop 0
    s_nop 0
    s_nop 0
    s_nop 0
    s_nop 0
    s_nop 0
    s_nop 0
    s_nop 0
    s_nop 0
    s_nop 0
    s_nop 0
    s_nop 0
    s_nop 0
    s_nop 0
    s_nop 0
    s_nop 0
    s_nop 0
    s_nop 0
    s_nop 0
    s_nop 0
    s_nop 0
    s_nop 0
    s_nop 0
    s_nop 0
    s_nop 0
    s_nop 0
    s_nop 0
    s_nop 0
    s_nop 0
    s_nop 0
    s_nop 0
    s_nop 0
    s_nop 0
    s_nop 0
    s_nop 0
    s_nop 0
    s_nop 0
    s_nop 0
    s_nop 0
    s_nop 0
    s_nop 0
    s_nop 0
    s_nop 0
    s_nop 0
    s_nop 0
    s_nop 0
    s_nop 0
    s_nop 0
    s_nop 0
    s_nop 0
    s_nop 0
    s_nop 0
    s_nop 0
    s_nop 0
    s_nop 0
    s_nop 0
    s_nop 0
    s_nop 0
    s_nop 0
    s_nop 0
    s_nop 0
    s_nop 0
    s_nop 0
    s_nop 0
    s_nop 0
    s_nop 0
    s_nop 0
    s_nop 0
    s_nop 0
    s_nop 0
    s_nop 0
    s_nop 0
    s_nop 0
    s_nop 0
    s_nop 0
    s_nop 0
    s_nop 0
    s_nop 0
    s_nop 0
    s_nop 0
    s_nop 0
    s_nop 0
    s_nop 0
    s_nop 0
    s_nop 0
    s_nop 0
    s_nop 0
    s_nop 0
    s_nop 0
    s_nop 0
    s_nop 0
    s_nop 0
    s_nop 0
    s_nop 0
    s_nop 0
    s_nop 0
    s_nop 0
    s_nop 0
    s_nop 0
    s_nop 0
    s_nop 0
    s_nop 0
    s_nop 0
    s_nop 0
    s_nop 0
    s_nop 0
    s_nop 0
    s_nop 0
    s_nop 0
    s_nop 0
    s_nop 0
    s_nop 0
    s_nop 0
    s_nop 0
    s_nop 0
    s_nop 0
    s_nop 0
    s_nop 0
    s_nop 0
    s_nop 0
    s_nop 0
    s_nop 0
    s_nop 0
    s_nop 0
    s_nop 0
    s_nop 0
    s_nop 0
    s_nop 0
    s_nop 0
    s_nop 0
    s_nop 0
    s_nop 0
    s_nop 0
    s_nop 0
    s_nop 0
    s_nop 0
    s_nop 0
    s_nop 0
    s_nop 0
    s_nop 0
    s_nop 0
    s_nop 0
    s_nop 0
    s_nop 0
    s_nop 0
    s_nop 0
    s_nop 0
    s_nop 0
    s_nop 0
    s_nop 0
    s_nop 0
    s_nop 0
    s_nop 0
    s_nop 0
    s_nop 0
    s_nop 0
    s_nop 0
    s_nop 0
    s_nop 0
    s_nop 0
    s_nop 0
    s_nop 0
    s_nop 0
    s_nop 0
    s_nop 0
    s_nop 0
    s_nop 0
    s_nop 0
    s_nop 0
    s_nop 0
    s_nop 0
    s_nop 0
    s_nop 0
    s_nop 0
    s_nop 0
    s_nop 0
    s_nop 0
    s_nop 0
    s_nop 0
    s_nop 0
    s_nop 0
    s_nop 0
    s_nop 0
    s_nop 0
    s_nop 0
    s_nop 0
    s_nop 0
    s_nop 0
    s_nop 0
    s_nop 0
    s_nop 0
    s_nop 0
    s_nop 0
    s_nop 0
    s_nop 0
    s_nop 0
    s_nop 0
    s_nop 0
    s_nop 0
    s_nop 0
    s_nop 0
    s_nop 0
    s_nop 0
    s_nop 0
    s_nop 0
    s_nop 0
    s_nop 0
    s_nop 0
    s_nop 0
    s_nop 0
    s_nop 0
    s_nop 0
    s_nop 0
    s_nop 0
    s_nop 0
    s_nop 0
    s_nop 0
    s_nop 0
    s_nop 0
    s_nop 0
    s_nop 0
    s_nop 0
    s_nop 0
    s_nop 0
    s_nop 0
    s_nop 0
    s_nop 0
    s_nop 0
    s_nop 0
    s_nop 0
    s_nop 0
    s_nop 0
    s_nop 0
    s_nop 0
    s_nop 0
    s_nop 0
    s_nop 0
    s_nop 0
    s_nop 0
    s_nop 0
    s_nop 0
    s_nop 0
    s_nop 0
    s_nop 0
    s_nop 0
    s_nop 0
    s_nop 0
    s_nop 0
    s_nop 0
    s_nop 0
    s_nop 0
    s_nop 0
    s_nop 0
    s_nop 0
    s_nop 0
    s_nop 0
    s_nop 0
    s_nop 0
    s_nop 0
    s_nop 0
    s_nop 0
    s_nop 0
    s_nop 0
    s_nop 0
    s_nop 0
    s_nop 0
    s_nop 0
    s_nop 0
    s_nop 0
    s_nop 0
    s_nop 0
    s_nop 0
    s_nop 0
    s_nop 0
    s_nop 0
    s_nop 0
    s_nop 0
    s_nop 0
    s_nop 0
    s_nop 0
    s_nop 0
    s_nop 0
    s_nop 0
    s_nop 0
    s_nop 0
    s_nop 0
    s_nop 0
    s_nop 0
    s_nop 0
    s_nop 0
    s_nop 0
    s_nop 0
    s_nop 0
    s_nop 0
    s_nop 0
L_roleA:
    s_mov_b32 s10, 0x2000000
    s_mov_b32 s11, 0x00020000
    s_mov_b32 s14, 0x2000000
    s_mov_b32 s15, 0x00020000
    s_mov_b32 s18, 0x10000000
    s_mov_b32 s19, 0x00020000
    s_mov_b32 s34, 0x21c000
    s_mov_b32 s35, 0x00020000
    s_mov_b32 s38, 0xd80
    s_mov_b32 s39, 0x00020000
    s_mov_b32 s42, 0x21c000
    s_mov_b32 s43, 0x00020000
    s_mov_b32 s46, 0x500
    s_mov_b32 s47, 0x00020000
    s_mov_b32 s50, 0x500
    s_mov_b32 s51, 0x00020000
    s_mov_b32 s54, 0x100
    s_mov_b32 s55, 0x00020000
    v_mov_b32 v100, -1
    v_mov_b32 v101, -1
    v_mov_b32 v102, -1
    v_mov_b32 v103, -1
    s_mul_i32 s76, s3, 0xc000
    s_lshl_b32 s68, s5, 0
    s_xor_b32 s68, s68, s75
    s_lshl_b32 s56, s68, 20
    s_lshl_b32 s68, s6, 17
    s_add_u32 s56, s56, s68
    s_lshl_b32 s68, s6, 14
    s_add_u32 s56, s56, s68
    s_lshl_b32 s68, s7, 12
    s_add_u32 s56, s56, s68
    s_xor_b32 s57, s56, 0x80000
    s_xor_b32 s58, s56, 0x40000
    s_xor_b32 s59, s56, 0xc0000
    s_xor_b32 s60, s56, 0x20000
    s_xor_b32 s61, s56, 0xa0000
    s_xor_b32 s62, s56, 0x60000
    s_xor_b32 s63, s56, 0xe0000
    v_bfe_u32 v121, v0, 2, 2
    v_lshlrev_b32 v124, 8, v121
    v_lshl_add_u32 v124, v115, 6, v124
    v_and_b32 v121, 3, v0
    v_lshl_add_u32 v124, v121, 4, v124
    v_and_b32 v120, 1, v115
    v_lshrrev_b32_e64 v123, 1, v115
    v_lshl_add_u32 v123, v120, 1, v123
    s_mov_b32 s70, 0x05040100
    s_mov_b32 s71, 0x07060302
    v_lshrrev_b32 v120, 2, v114
    v_mul_u32_u24 v2, 1536, v120
    v_and_b32 v120, 3, v114
    v_lshl_add_u32 v2, v120, 5, v2
    v_lshl_add_u32 v2, v115, 4, v2
    s_mul_i32 s67, s7, 6144
    s_lshl_b32 s68, s73, 7
    s_add_u32 s68, s68, s76
    s_add_u32 s67, s67, s68
    v_add_u32 v2, s67, v2
    s_mov_b32 exec_hi, 0
    buffer_store_dwordx4 v[100:103], v2, s[16:19], 0 offen sc1
    s_mov_b64 exec, -1
    s_lshl_b32 s67, s7, 4
    v_add_u32 v120, s67, v114
    v_subrev_u32 v121, 27, v120
    v_cmp_le_u32 vcc, 27, v120
    s_nop 1
    v_cndmask_b32 v121, v120, v121, vcc
    v_cndmask_b32 v122, 0, 4, vcc
    v_mul_u32_u24 v14, 37, v121
    v_lshrrev_b32 v14, 8, v14
    v_add_u32 v122, v122, v14
    v_mul_u32_u24 v14, 7, v14
    v_sub_u32 v121, v121, v14
    v_mul_u32_u24 v14, 1536, v122
    v_lshl_add_u32 v14, v121, 4, v14
    s_add_u32 s68, s68, 0x8000
    v_add_u32_e64 v14, s68, v14
    v_mov_b32 v121, 0x80000000
    v_cmp_gt_u32 vcc, 54, v120
    s_nop 1
    v_cndmask_b32 v14, v121, v14, vcc
    s_mov_b32 s68, 0xe8000
    s_mov_b64 exec, 0xffff
    buffer_store_dwordx4 v[100:103], v14, s[16:19], s68 offen sc1
    s_mov_b64 exec, -1
    s_mov_b64 s[8:9], s[82:83]
    s_mov_b64 s[12:13], s[84:85]
    s_getreg_b32 s75, hwreg(HW_REG_XCC_ID)
    s_and_b32 s75, s75, 15
    s_or_b32 s75, s75, 0x80
    buffer_load_dwordx4 a[0:3], v124, s[8:11], s56 offen offset:0 nt
    buffer_load_dwordx4 a[4:7], v124, s[8:11], s56 offen offset:1024 nt
    s_mov_b64 s[32:33], s[92:93]
    s_mov_b64 s[36:37], s[94:95]
    s_load_dwordx2 s[52:53], s[0:1], 88
    s_load_dwordx2 s[44:45], s[0:1], 72
    s_load_dwordx2 s[40:41], s[0:1], 64
    s_load_dwordx2 s[48:49], s[0:1], 80
    s_lshl_b32 s67, s7, 9
    s_add_u32 s67, s67, s76
    s_add_u32 s67, s67, 0xb000
    s_lshl_b32 s68, s73, 2
    s_add_u32 s77, s67, s68
    v_mov_b32 v5, s77
    s_add_u32 s77, s77, 48
    v_writelane_b32 v5, s77, 0
    s_lshr_b32 s74, s7, 1
    s_lshl_b32 s67, s73, 1
    s_add_u32 s74, s74, s67
    v_bfe_u32 v120, v0, 3, 1
    v_lshlrev_b32 v13, 10, v120
    v_lshl_add_u32 v13, v115, 8, v13
    v_and_b32_e64 v120, 7, v0
    v_lshl_add_u32 v13, v120, 3, v13
    s_lshl_b32 s67, s74, 11
    s_add_u32 s67, s67, 0x60000
    s_lshr_b32 s68, s74, 2
    s_lshl_b32 s68, s68, 13
    s_add_u32 s67, s67, s68
    v_add_u32 v13, s67, v13
    v_mov_b32 v36, 0x3f803f80
    v_mov_b32 v37, 0x3f803f80
    v_mov_b32 v38, 0x3f803f80
    v_mov_b32 v39, 0x3f803f80
    v_mul_u32_u24 v25, 27648, v115
    v_lshl_add_u32 v25, v114, 3, v25
    s_waitcnt vmcnt(20)
LS8_1:
    v_mov_b32 v120, 0
    v_mov_b32_e64 v121, 0
    v_mov_b32 v122, 0x3f803f80
    v_dot2_f32_bf16 v120, v40, v122, v120
    v_dot2_f32_bf16 v121, v40, v40, v121
    v_dot2_f32_bf16 v120, v41, v122, v120
    v_dot2_f32_bf16 v121, v41, v41, v121
    v_dot2_f32_bf16 v120, v42, v122, v120
    v_dot2_f32_bf16 v121, v42, v42, v121
    v_dot2_f32_bf16 v120, v43, v122, v120
    v_dot2_f32_bf16 v121, v43, v43, v121
    v_dot2_f32_bf16 v120, v44, v122, v120
    v_dot2_f32_bf16 v121, v44, v44, v121
    v_dot2_f32_bf16 v120, v45, v122, v120
    v_dot2_f32_bf16 v121, v45, v45, v121
    v_dot2_f32_bf16 v120, v46, v122, v120
    v_dot2_f32_bf16 v121, v46, v46, v121
    v_dot2_f32_bf16 v120, v47, v122, v120
    v_dot2_f32_bf16 v121, v47, v47, v121
    v_lshlrev_b32 v108, 16, v28
    v_and_b32 v109, 0xffff0000, v28
    v_lshlrev_b32 v110, 16, v29
    v_and_b32 v111, 0xffff0000, v29
    v_lshlrev_b32_e64 v40, 16, v32
    v_and_b32 v41, 0xffff0000, v32
    v_lshlrev_b32 v42, 16, v33
    v_and_b32 v43, 0xffff0000, v33
    v_permlane32_swap_b32 v120, v121
    v_add_f32 v120, v120, v121
    s_nop 1
    v_add_f32_dpp v120, v120, v120 row_ror:1 row_mask:0xf bank_mask:0xf
    s_nop 1
    v_add_f32_dpp v120, v120, v120 row_ror:2 row_mask:0xf bank_mask:0xf
    s_nop 1
    v_add_f32_dpp v120, v120, v120 row_ror:4 row_mask:0xf bank_mask:0xf
    s_nop 1
    v_add_f32_dpp v120, v120, v120 row_ror:8 row_mask:0xf bank_mask:0xf
    s_nop 1
    v_add_f32_dpp v120, v120, v120 row_bcast:15 row_mask:0xa bank_mask:0xf
    v_mul_f32 v120, 0x3acccccd, v120
    s_nop 0
    v_readlane_b32 s64, v120, 31
    v_readlane_b32 s66, v120, 63
    s_nop 0
    v_mov_b32 v120, s64
    v_mov_b32 v121, s66
    v_fma_f32 v121, -v120, v120, v121
    v_max_f32 v121, 0, v121
    v_add_f32 v121, 0x3727c5ac, v121
    v_rsq_f32 v121, v121
    s_nop 0
    v_mul_f32 v120, v120, v121
    v_fma_f32 v104, v40, v121, -v120
    v_fma_f32 v105, v41, v121, -v120
    v_fma_f32 v106, v42, v121, -v120
    v_fma_f32 v107, v43, v121, -v120
    v_cvt_pk_bf16_f32 v32, v104, v105
    v_cvt_pk_bf16_f32 v33, v106, v107
    s_nop 0
    v_mov_b32_dpp v34, v32 row_ror:8 row_mask:0xf bank_mask:0xf
    v_mov_b32_dpp v35, v33 row_ror:8 row_mask:0xf bank_mask:0xf
    v_fma_f32 v108, v108, v121, -v120
    v_fma_f32 v109, v109, v121, -v120
    v_fma_f32 v110, v110, v121, -v120
    v_fma_f32 v111, v111, v121, -v120
    v_cvt_pk_bf16_f32 v28, v108, v109
    v_cvt_pk_bf16_f32 v29, v110, v111
    s_nop 0
    v_mov_b32_dpp v30, v28 row_ror:8 row_mask:0xf bank_mask:0xf
    v_mov_b32_dpp v31, v29 row_ror:8 row_mask:0xf bank_mask:0xf
    s_waitcnt lgkmcnt(0)
    s_lshl_b32 s67, s74, 6
    v_and_b32 v120, 7, v0
    v_and_b32 v121, 0x30, v0
    v_lshl_add_u32 v120, v120, 1, v121
    buffer_load_ushort a226, v120, s[44:47], s67 offen
    buffer_load_ushort a227, v120, s[20:23], s67 offen
    buffer_load_dwordx4 a[8:11], v124, s[8:11], s56 offen offset:2048 nt
    buffer_load_dwordx4 a[12:15], v124, s[8:11], s56 offen offset:3072 nt
LS29_2:
    s_nop 0
    s_waitcnt vmcnt(16)
LS9_3:
    v_perm_b32 v160, v132, v128, s70
    v_perm_b32 v161, v140, v136, s70
    v_perm_b32 v162, v148, v144, s70
    v_perm_b32 v163, v156, v152, s70
    s_nop 1
    v_mfma_f32_16x16x32_bf16 v[72:75], v[32:35], v[160:163], 0
    v_perm_b32 v176, v134, v130, s70
    v_perm_b32 v177, v142, v138, s70
    v_perm_b32 v178, v150, v146, s70
    v_perm_b32 v179, v158, v154, s70
    s_nop 1
    v_mfma_f32_16x16x32_bf16 v[88:91], v[32:35], v[176:179], 0
    v_perm_b32 v164, v132, v128, s71
    v_perm_b32 v165, v140, v136, s71
    v_perm_b32 v166, v148, v144, s71
    v_perm_b32 v167, v156, v152, s71
    s_nop 0
    s_nop 0
    v_mfma_f32_16x16x32_bf16 v[76:79], v[32:35], v[164:167], 0
    v_perm_b32 v180, v134, v130, s71
    v_perm_b32 v181, v142, v138, s71
    v_perm_b32 v182, v150, v146, s71
    v_perm_b32 v183, v158, v154, s71
    s_nop 1
    v_mfma_f32_16x16x32_bf16 v[92:95], v[32:35], v[180:183], 0
    v_perm_b32 v168, v133, v129, s70
    v_perm_b32 v169, v141, v137, s70
    v_perm_b32 v170, v149, v145, s70
    v_perm_b32 v171, v157, v153, s70
    s_nop 1
    v_mfma_f32_16x16x32_bf16 v[80:83], v[32:35], v[168:171], 0
    v_perm_b32 v184, v135, v131, s70
    v_perm_b32 v185, v143, v139, s70
    v_perm_b32 v186, v151, v147, s70
    v_perm_b32 v187, v159, v155, s70
    s_nop 0
    s_nop 0
    v_mfma_f32_16x16x32_bf16 v[96:99], v[32:35], v[184:187], 0
    v_perm_b32 v172, v133, v129, s71
    v_perm_b32 v173, v141, v137, s71
    v_perm_b32 v174, v149, v145, s71
    v_perm_b32 v175, v157, v153, s71
    s_nop 0
    s_nop 0
    v_mfma_f32_16x16x32_bf16 v[84:87], v[32:35], v[172:175], 0
    v_perm_b32 v188, v135, v131, s71
    v_perm_b32 v189, v143, v139, s71
    v_perm_b32 v190, v151, v147, s71
    v_perm_b32 v191, v159, v155, s71
    s_nop 1
    v_mfma_f32_16x16x32_bf16 v[100:103], v[32:35], v[188:191], 0
    s_waitcnt vmcnt(8)
    v_perm_b32 v224, v196, v192, s70
    v_perm_b32 v225, v204, v200, s70
    v_perm_b32 v226, v212, v208, s70
    v_perm_b32 v227, v220, v216, s70
    s_nop 0
    s_nop 0
    v_mfma_f32_16x16x32_bf16 v[72:75], v[28:31], v[224:227], v[72:75]
    v_perm_b32 v240, v198, v194, s70
    v_perm_b32 v241, v206, v202, s70
    v_perm_b32 v242, v214, v210, s70
    v_perm_b32 v243, v222, v218, s70
    s_nop 0
    s_nop 0
    v_mfma_f32_16x16x32_bf16 v[88:91], v[28:31], v[240:243], v[88:91]
    v_perm_b32 v228, v196, v192, s71
    v_perm_b32 v229, v204, v200, s71
    v_perm_b32 v230, v212, v208, s71
    v_perm_b32 v231, v220, v216, s71
    s_nop 0
    s_nop 0
    v_mfma_f32_16x16x32_bf16 v[76:79], v[28:31], v[228:231], v[76:79]
    v_perm_b32 v244, v198, v194, s71
    v_perm_b32 v245, v206, v202, s71
    v_perm_b32 v246, v214, v210, s71
    v_perm_b32 v247, v222, v218, s71
    s_nop 1
    v_mfma_f32_16x16x32_bf16 v[92:95], v[28:31], v[244:247], v[92:95]
    v_perm_b32 v232, v197, v193, s70
    v_perm_b32 v233, v205, v201, s70
    v_perm_b32 v234, v213, v209, s70
    v_perm_b32 v235, v221, v217, s70
    s_nop 1
    v_mfma_f32_16x16x32_bf16 v[80:83], v[28:31], v[232:235], v[80:83]
    v_perm_b32 v248, v199, v195, s70
    v_perm_b32 v249, v207, v203, s70
    v_perm_b32 v250, v215, v211, s70
    v_perm_b32 v251, v223, v219, s70
    s_nop 0
    s_nop 0
    v_mfma_f32_16x16x32_bf16 v[96:99], v[28:31], v[248:251], v[96:99]
    v_perm_b32 v236, v197, v193, s71
    v_perm_b32 v237, v205, v201, s71
    v_perm_b32 v238, v213, v209, s71
    v_perm_b32 v239, v221, v217, s71
    s_nop 1
    v_mfma_f32_16x16x32_bf16 v[84:87], v[28:31], v[236:239], v[84:87]
    v_perm_b32 v252, v199, v195, s71
    v_perm_b32 v253, v207, v203, s71
    v_perm_b32 v254, v215, v211, s71
    v_perm_b32 v255, v223, v219, s71
    s_nop 1
    v_mfma_f32_16x16x32_bf16 v[100:103], v[28:31], v[252:255], v[100:103]
    s_mov_b32 exec_hi, 0
    v_mov_b32_dpp v72, v88 quad_perm:[0,1,2,3] row_mask:0x2 bank_mask:0xf
    v_mov_b32_dpp v73, v76 quad_perm:[0,1,2,3] row_mask:0x1 bank_mask:0xf
    v_mov_b32_dpp v73, v92 quad_perm:[0,1,2,3] row_mask:0x2 bank_mask:0xf
    v_mov_b32_dpp v74, v80 quad_perm:[0,1,2,3] row_mask:0x1 bank_mask:0xf
    v_mov_b32_dpp v74, v96 quad_perm:[0,1,2,3] row_mask:0x2 bank_mask:0xf
    v_mov_b32_dpp v75, v84 quad_perm:[0,1,2,3] row_mask:0x1 bank_mask:0xf
    s_nop 0
    v_mov_b32_dpp v75, v100 quad_perm:[0,1,2,3] row_mask:0x2 bank_mask:0xf
    s_waitcnt vmcnt(6)
    buffer_store_dwordx4 v[72:75], v2, s[16:19], 0 offen sc1
    s_mov_b64 exec, -1
LS2_4:
    s_lshl_b32 s67, s3, 5
    s_add_u32 s67, s67, s4
    s_lshl_b32 s68, s7, 8
    s_add_u32 s67, s67, s68
    v_mov_b32 v120, s75
    v_mov_b32_e64 v121, s67
    s_waitcnt vmcnt(7)
    s_waitcnt lgkmcnt(0)
    s_mov_b32 s0, 0
    s_mov_b32 s1, 0x41b80000
    s_nop 0
    s_barrier
    s_mov_b64 exec, 1
    buffer_store_byte v120, v121, s[52:55], 0 offen sc1
    s_mov_b64 exec, -1
LS1_5:
    buffer_load_dwordx4 a[16:19], v124, s[8:11], s57 offen offset:0 nt
    buffer_load_dwordx4 a[20:23], v124, s[8:11], s57 offen offset:1024 nt
    s_mov_b32 s68, 0xe8000
    v_mfma_f32_16x16x32_bf16 v[72:75], v[36:39], v[160:163], 0
    v_mfma_f32_16x16x32_bf16 v[88:91], v[36:39], v[176:179], 0
    v_mfma_f32_16x16x32_bf16 v[76:79], v[36:39], v[164:167], 0
    v_mfma_f32_16x16x32_bf16 v[92:95], v[36:39], v[180:183], 0
    v_mfma_f32_16x16x32_bf16 v[80:83], v[36:39], v[168:171], 0
    v_mfma_f32_16x16x32_bf16 v[96:99], v[36:39], v[184:187], 0
    v_mfma_f32_16x16x32_bf16 v[84:87], v[36:39], v[172:175], 0
    v_mfma_f32_16x16x32_bf16 v[100:103], v[36:39], v[188:191], 0
    v_mfma_f32_16x16x32_bf16 v[72:75], v[36:39], v[224:227], v[72:75]
    v_mfma_f32_16x16x32_bf16 v[88:91], v[36:39], v[240:243], v[88:91]
    v_mfma_f32_16x16x32_bf16 v[76:79], v[36:39], v[228:231], v[76:79]
    v_mfma_f32_16x16x32_bf16 v[92:95], v[36:39], v[244:247], v[92:95]
    v_mfma_f32_16x16x32_bf16 v[80:83], v[36:39], v[232:235], v[80:83]
    v_mfma_f32_16x16x32_bf16 v[96:99], v[36:39], v[248:251], v[96:99]
    v_mfma_f32_16x16x32_bf16 v[84:87], v[36:39], v[236:239], v[84:87]
    v_mfma_f32_16x16x32_bf16 v[100:103], v[36:39], v[252:255], v[100:103]
    s_mov_b32 exec_hi, 0
    s_nop 0
    v_mov_b32_dpp v72, v88 quad_perm:[0,1,2,3] row_mask:0x2 bank_mask:0xf
    v_mov_b32_dpp v73, v76 quad_perm:[0,1,2,3] row_mask:0x1 bank_mask:0xf
    v_mov_b32_dpp v73, v92 quad_perm:[0,1,2,3] row_mask:0x2 bank_mask:0xf
    v_mov_b32_dpp v74, v80 quad_perm:[0,1,2,3] row_mask:0x1 bank_mask:0xf
    v_mov_b32_dpp v74, v96 quad_perm:[0,1,2,3] row_mask:0x2 bank_mask:0xf
    v_mov_b32_dpp v75, v84 quad_perm:[0,1,2,3] row_mask:0x1 bank_mask:0xf
    v_mov_b32_dpp v75, v100 quad_perm:[0,1,2,3] row_mask:0x2 bank_mask:0xf
    buffer_store_dwordx4 v[72:75], v2, s[16:19], s68 offen sc1
    s_mov_b64 exec, -1
    buffer_load_dwordx4 a[24:27], v124, s[8:11], s57 offen offset:2048 nt
    s_waitcnt vmcnt(14)
    v_accvgpr_write_b32 a128, v160
    v_accvgpr_write_b32 a129, v161
    v_accvgpr_write_b32 a130, v162
    v_accvgpr_write_b32 a131, v163
    v_accvgpr_write_b32 a132, v164
    v_accvgpr_write_b32 a133, v165
    v_accvgpr_write_b32 a134, v166
    v_accvgpr_write_b32 a135, v167
    v_accvgpr_write_b32 a136, v168
    v_accvgpr_write_b32 a137, v169
    v_accvgpr_write_b32 a138, v170
    v_accvgpr_write_b32 a139, v171
    v_accvgpr_write_b32 a140, v172
    v_accvgpr_write_b32 a141, v173
    v_accvgpr_write_b32 a142, v174
    v_accvgpr_write_b32 a143, v175
    v_accvgpr_write_b32 a144, v176
    v_accvgpr_write_b32 a145, v177
    v_accvgpr_write_b32 a146, v178
    v_accvgpr_write_b32 a147, v179
    v_accvgpr_write_b32 a148, v180
    v_accvgpr_write_b32 a149, v181
    v_accvgpr_write_b32 a150, v182
    v_accvgpr_write_b32 a151, v183
    v_accvgpr_write_b32 a152, v184
    v_accvgpr_write_b32 a153, v185
    v_accvgpr_write_b32 a154, v186
    v_accvgpr_write_b32 a155, v187
    v_accvgpr_write_b32 a156, v188
    v_accvgpr_write_b32 a157, v189
    v_accvgpr_write_b32 a158, v190
    v_accvgpr_write_b32 a159, v191
    buffer_load_dwordx4 a[28:31], v124, s[8:11], s57 offen offset:3072 nt
    s_nop 0
    s_waitcnt vmcnt(14)
    v_accvgpr_write_b32 a160, v224
    v_accvgpr_write_b32 a161, v225
    v_accvgpr_write_b32 a162, v226
    v_accvgpr_write_b32 a163, v227
    v_accvgpr_write_b32 a164, v228
    v_accvgpr_write_b32 a165, v229
    v_accvgpr_write_b32 a166, v230
    v_accvgpr_write_b32 a167, v231
    v_accvgpr_write_b32 a168, v232
    v_accvgpr_write_b32 a169, v233
    v_accvgpr_write_b32 a170, v234
    v_accvgpr_write_b32 a171, v235
    v_accvgpr_write_b32 a172, v236
    v_accvgpr_write_b32 a173, v237
    v_accvgpr_write_b32 a174, v238
    v_accvgpr_write_b32 a175, v239
    v_accvgpr_write_b32 a176, v240
    v_accvgpr_write_b32 a177, v241
    v_accvgpr_write_b32 a178, v242
    v_accvgpr_write_b32 a179, v243
    v_accvgpr_write_b32 a180, v244
    v_accvgpr_write_b32 a181, v245
    v_accvgpr_write_b32 a182, v246
    v_accvgpr_write_b32 a183, v247
    v_accvgpr_write_b32 a184, v248
    v_accvgpr_write_b32 a185, v249
    v_accvgpr_write_b32 a186, v250
    v_accvgpr_write_b32 a187, v251
    v_accvgpr_write_b32 a188, v252
    v_accvgpr_write_b32 a189, v253
    v_accvgpr_write_b32 a190, v254
    v_accvgpr_write_b32 a191, v255
    buffer_load_dwordx4 a[32:35], v124, s[8:11], s58 offen offset:0 nt
    s_nop 0
    s_waitcnt vmcnt(14)
    s_mov_b32 s69, 100000
    s_mov_b32 s80, 0x11111111
    s_mov_b32 s81, 0x11111111
    s_mov_b32 s82, 0x22222222
    s_mov_b32 s83, 0x22222222
    s_mov_b32 s84, 0x44444444
    s_mov_b32 s85, 0x44444444
    s_mov_b32 s86, 0x88888888
    s_mov_b32 s87, 0x88888888
    s_mov_b32 s88, 0x01010101
    s_mov_b32 s89, 0x01010101
    s_lshl_b32 s67, s5, 3
    s_add_u32 s67, s67, s6
    s_lshl_b32 s68, s67, 8
    s_add_u32 s68, s68, s76
    s_add_u32 s68, s68, 0x6000
    s_lshl_b32 s68, s5, 11
    s_lshl_b32 s77, s6, 4
    s_add_u32 s68, s68, s77
    s_add_u32 s68, s68, s76
    s_add_u32 s68, s68, 0x6000
    v_lshrrev_b32 v120, 2, v0
    v_lshlrev_b32 v8, 7, v120
    v_and_b32 v120, 3, v0
    v_lshl_add_u32 v8, v120, 2, v8
    v_add_u32 v8, s68, v8
    s_lshl_b32 s79, s5, 9
    s_lshl_b32 s68, s6, 3
    s_add_u32 s79, s79, s68
    s_add_u32 s79, s79, s76
    s_add_u32 s79, s79, 0xb800
    s_mul_i32 s67, s5, 6144
    s_mul_i32 s68, s7, 1536
    s_add_u32 s67, s67, s68
    s_add_u32 s67, s67, s76
    v_add_u32 v3, s67, v1
    v_lshlrev_b32 v120, 7, v115
    v_sub_u32 v4, v3, v120
    v_add_u32 v4, 896, v4
    v_mov_b32 v121, 0x80000000
    v_and_b32 v120, 1, v114
    v_mul_u32_u24 v120, 48, v120
    v_lshrrev_b32 v122, 1, v114
    v_lshl_add_u32 v120, v122, 4, v120
    s_lshl_b32 s67, s7, 9
    s_add_u32 s67, s67, s76
    s_add_u32 s67, s67, 0xb000
    v_add_u32 v120, s67, v120
    v_cmp_gt_u32 vcc, 6, v114
    s_nop 1
    v_cndmask_b32 v120, v121, v120, vcc
    v_cmp_gt_u32 vcc, 8, v114
    s_nop 1
    v_cndmask_b32 v4, v4, v120, vcc
    v_mov_b32 v6, 0
    v_and_b32 v120, 7, v0
    v_lshl_add_u32 v120, v120, 2, v123
    s_lshl_b32 s67, s7, 5
    v_add_u32 v120, s67, v120
    v_lshlrev_b32 v16, 1, v120
    v_lshrrev_b32 v120, 2, v0
    v_lshlrev_b32 v17, 4, v120
    v_lshlrev_b32 v18, 3, v0
    v_add_u32 v18, 512, v18
    s_lshl_b32 s67, s7, 3
    s_add_u32 s67, s67, 256
    v_writelane_b32 v18, s67, 63
    v_add_u32 v120, s7, v0
    v_and_b32 v120, 3, v120
    v_lshlrev_b32 v120, 3, v120
    v_add_u32 v19, 256, v120
    s_lshl_b32 s67, s7, 9
    s_add_u32 s67, s67, 1024
    v_lshlrev_b32 v20, 2, v0
    v_add_u32 v20, s67, v20
    v_lshlrev_b32 v21, 3, v0
    v_add_u32 v21, 1024, v21
    v_mov_b32 v27, 0x3e0293ee
    v_mov_b32 v48, 0
    v_mov_b32 v49, 0
    v_mov_b32 v50, 0
    v_mov_b32 v51, 0
    v_mov_b32 v52, 0
    v_mov_b32 v53, 0
    v_mov_b32 v54, 0
    v_mov_b32 v55, 0
    v_mov_b32 v56, 0
    v_mov_b32 v57, 0
    v_mov_b32 v58, 0
    v_mov_b32 v59, 0
    v_mov_b32 v60, 0
    v_mov_b32 v61, 0
    v_mov_b32 v62, 0
    v_mov_b32 v63, 0
    v_mov_b32 v64, 0
    v_mov_b32 v65, 0
    v_mov_b32 v66, 0
    v_mov_b32 v67, 0
    v_mov_b32 v68, 0
    v_mov_b32 v69, 0
    v_mov_b32 v70, 0
    v_mov_b32 v71, 0
    v_lshlrev_b32 v119, 2, v0
    v_and_b32 v118, 28, v119
    s_waitcnt vmcnt(10)
    v_mov_b32 v40, 0
    v_mov_b32 v41, 0xc1b80000
    v_accvgpr_read_b32 v121, a227
    s_mov_b32 exec_lo, 0x00ff00ff
    s_mov_b32 exec_hi, 0x00ff00ff
    v_lshlrev_b32 v112, 16, v121
    v_cvt_f64_f32 v[40:41], v112
    v_add_f64 v[40:41], v[40:41], -s[0:1]
    s_mov_b64 exec, -1
    buffer_load_dwordx4 a[36:39], v124, s[8:11], s58 offen offset:1024 nt
    s_waitcnt vmcnt(14)
    buffer_load_dwordx4 a[40:43], v124, s[8:11], s58 offen offset:2048 nt
    s_waitcnt vmcnt(14)
    buffer_load_dwordx4 a[44:47], v124, s[8:11], s58 offen offset:3072 nt
    s_waitcnt vmcnt(14)
    buffer_load_dwordx4 a[48:51], v124, s[8:11], s59 offen offset:0 nt
    s_waitcnt vmcnt(14)
    buffer_load_dwordx4 a[52:55], v124, s[8:11], s59 offen offset:1024 nt
    s_nop 0
    s_waitcnt vmcnt(14)
    buffer_load_dwordx4 a[56:59], v124, s[8:11], s59 offen offset:2048 nt
    s_waitcnt vmcnt(14)
    buffer_load_dwordx4 a[60:63], v124, s[8:11], s59 offen offset:3072 nt
    s_waitcnt vmcnt(14)
    buffer_load_dwordx4 a[64:67], v124, s[8:11], s60 offen offset:0 nt
    s_waitcnt vmcnt(14)
    buffer_load_dwordx4 a[68:71], v124, s[8:11], s60 offen offset:1024 nt
    s_nop 0
    s_waitcnt vmcnt(14)
LS3_6:
    s_lshl_b32 s77, s3, 5
    buffer_load_dword v114, v118, s[52:55], s77 offen sc1
    buffer_load_dwordx4 a[72:75], v124, s[8:11], s60 offen offset:2048 nt
    s_waitcnt vmcnt(14)
    buffer_load_dwordx4 a[76:79], v124, s[8:11], s60 offen offset:3072 nt
    s_waitcnt vmcnt(14)
    buffer_load_dwordx4 a[80:83], v124, s[8:11], s61 offen offset:0 nt
    s_waitcnt vmcnt(14)
    buffer_load_dwordx4 a[84:87], v124, s[8:11], s61 offen offset:1024 nt
    s_waitcnt vmcnt(14)
    buffer_load_dwordx4 a[88:91], v124, s[8:11], s61 offen offset:2048 nt
    s_nop 0
    s_waitcnt vmcnt(14)
    buffer_load_dwordx4 a[92:95], v124, s[8:11], s61 offen offset:3072 nt
    s_waitcnt vmcnt(14)
    buffer_load_dwordx4 a[96:99], v124, s[8:11], s62 offen offset:0 nt
    s_waitcnt vmcnt(14)
    buffer_load_dwordx4 a[100:103], v124, s[8:11], s62 offen offset:1024 nt
    s_waitcnt vmcnt(14)
    buffer_load_dwordx4 a[104:107], v124, s[8:11], s62 offen offset:2048 nt
    s_waitcnt vmcnt(14)
    buffer_load_dwordx4 a[108:111], v124, s[8:11], s62 offen offset:3072 nt
    s_nop 0
    s_waitcnt vmcnt(14)
    buffer_load_dwordx4 a[112:115], v124, s[8:11], s63 offen offset:0 nt
    s_waitcnt vmcnt(14)
    buffer_load_dwordx4 a[116:119], v124, s[8:11], s63 offen offset:1024 nt
    s_waitcnt vmcnt(14)
    buffer_load_dwordx4 a[120:123], v124, s[8:11], s63 offen offset:2048 nt
    s_waitcnt vmcnt(14)
    s_mul_i32 s75, s75, 0x01010101
    s_waitcnt vmcnt(13)
Lfc_9:
    v_and_b32 v120, 0x80808080, v114
    v_cmp_ne_u32 vcc, 0x80808080, v120
    s_cbranch_vccnz Lretry_10
Lfok_8:
    v_and_b32 v114, 0x8f8f8f8f, v114
    v_cmp_ne_u32 vcc, s75, v114
    s_nop 0
    s_or_b32 s78, vcc_lo, vcc_hi
    buffer_load_dwordx4 v[76:79], v4, s[16:19], 0 offen sc1
    buffer_load_dwordx4 v[72:75], v3, s[16:19], 0 offen sc1
LS4_11:
    buffer_load_dwordx4 a[124:127], v124, s[8:11], s63 offen offset:3072 nt
    s_waitcnt vmcnt(16)
    buffer_load_dwordx4 v[128:131], v1, s[12:15], s56 offen offset:0 nt
    s_waitcnt vmcnt(16)
    buffer_load_dwordx4 v[132:135], v1, s[12:15], s56 offen offset:1024 nt
    s_waitcnt vmcnt(16)
    buffer_load_dwordx4 v[136:139], v1, s[12:15], s56 offen offset:2048 nt
    s_waitcnt vmcnt(16)
    buffer_load_dwordx4 v[140:143], v1, s[12:15], s56 offen offset:3072 nt
    s_waitcnt vmcnt(16)
    buffer_load_dwordx4 v[144:147], v1, s[12:15], s57 offen offset:0 nt
    s_waitcnt vmcnt(16)
    buffer_load_dwordx4 v[148:151], v1, s[12:15], s57 offen offset:1024 nt
    s_nop 0
    s_waitcnt vmcnt(16)
    buffer_load_dwordx4 v[152:155], v1, s[12:15], s57 offen offset:2048 nt
    s_waitcnt vmcnt(16)
    buffer_load_dwordx4 v[156:159], v1, s[12:15], s57 offen offset:3072 nt
    s_waitcnt vmcnt(16)
    buffer_load_dwordx4 v[160:163], v1, s[12:15], s58 offen offset:0 nt
    s_waitcnt vmcnt(16)
    buffer_load_dwordx4 v[164:167], v1, s[12:15], s58 offen offset:1024 nt
    s_waitcnt vmcnt(16)
    buffer_load_dwordx4 v[168:171], v1, s[12:15], s58 offen offset:2048 nt
    s_waitcnt vmcnt(16)
    s_waitcnt vmcnt(12)
Lq_12:
    v_add_f32_dpp v72, v76, v72 quad_perm:[0,1,2,3] row_mask:0xf bank_mask:0xc
    v_add_f32_dpp v73, v77, v73 quad_perm:[0,1,2,3] row_mask:0xf bank_mask:0xc
    v_add_f32_dpp v74, v78, v74 quad_perm:[0,1,2,3] row_mask:0xf bank_mask:0xc
    v_add_f32_dpp v75, v79, v75 quad_perm:[0,1,2,3] row_mask:0xf bank_mask:0xc
    v_permlane32_swap_b32 v72, v73
    s_nop 0
    v_permlane32_swap_b32 v74, v75
    v_add_f32 v72, v72, v73
    v_add_f32 v74, v74, v75
    s_nop 1
    v_permlane16_swap_b32 v72, v74
    v_add_f32 v104, v72, v74
    s_nop 1
    v_add_f32_dpp v104, v104, v104 row_ror:8 row_mask:0xf bank_mask:0xf
    buffer_load_dwordx4 v[172:175], v1, s[12:15], s58 offen offset:3072 nt
    buffer_load_dwordx4 v[176:179], v1, s[12:15], s59 offen offset:0 nt
    v_cvt_pk_bf16_f32 v107, v104, v104
    v_cmp_u_f32 vcc, v104, v104
    s_cbranch_vccnz Lretry_15
Lok_14:
    ds_write_b16 v16, v107
    s_waitcnt lgkmcnt(0)
    s_barrier
LS5_16:
    s_waitcnt vmcnt(13)
    s_mov_b64 exec, s[80:81]
    ds_read_b128 v[48:51], v17
    s_mov_b64 exec, s[82:83]
    ds_read_b128 v[52:55], v17
    s_mov_b64 exec, s[84:85]
    ds_read_b128 v[56:59], v17
    s_mov_b64 exec, s[86:87]
    ds_read_b128 v[60:63], v17
    s_mov_b64 exec, -1
    s_waitcnt lgkmcnt(3)
    v_mfma_f32_16x16x32_bf16 v[72:75], a[0:3], v[48:51], 0
    v_mfma_f32_16x16x32_bf16 v[76:79], a[32:35], v[48:51], 0
    v_mfma_f32_16x16x32_bf16 v[80:83], a[64:67], v[48:51], 0
    v_mfma_f32_16x16x32_bf16 v[84:87], a[96:99], v[48:51], 0
    v_mfma_f32_16x16x32_bf16 v[88:91], a[4:7], v[48:51], 0
    v_mfma_f32_16x16x32_bf16 v[92:95], a[36:39], v[48:51], 0
    v_mfma_f32_16x16x32_bf16 v[96:99], a[68:71], v[48:51], 0
    v_mfma_f32_16x16x32_bf16 v[100:103], a[100:103], v[48:51], 0
    buffer_load_dwordx4 v[180:183], v1, s[12:15], s59 offen offset:1024 nt
    s_nop 0
    s_waitcnt lgkmcnt(2)
    v_mfma_f32_16x16x32_bf16 v[72:75], a[8:11], v[52:55], v[72:75]
    v_mfma_f32_16x16x32_bf16 v[76:79], a[40:43], v[52:55], v[76:79]
    v_mfma_f32_16x16x32_bf16 v[80:83], a[72:75], v[52:55], v[80:83]
    v_mfma_f32_16x16x32_bf16 v[84:87], a[104:107], v[52:55], v[84:87]
    v_mfma_f32_16x16x32_bf16 v[88:91], a[12:15], v[52:55], v[88:91]
    v_mfma_f32_16x16x32_bf16 v[92:95], a[44:47], v[52:55], v[92:95]
    v_mfma_f32_16x16x32_bf16 v[96:99], a[76:79], v[52:55], v[96:99]
    v_mfma_f32_16x16x32_bf16 v[100:103], a[108:111], v[52:55], v[100:103]
    s_nop 0
    s_waitcnt lgkmcnt(1)
    v_mfma_f32_16x16x32_bf16 v[72:75], a[16:19], v[56:59], v[72:75]
    v_mfma_f32_16x16x32_bf16 v[76:79], a[48:51], v[56:59], v[76:79]
    v_mfma_f32_16x16x32_bf16 v[80:83], a[80:83], v[56:59], v[80:83]
    v_mfma_f32_16x16x32_bf16 v[84:87], a[112:115], v[56:59], v[84:87]
    v_mfma_f32_16x16x32_bf16 v[88:91], a[20:23], v[56:59], v[88:91]
    v_mfma_f32_16x16x32_bf16 v[92:95], a[52:55], v[56:59], v[92:95]
    v_mfma_f32_16x16x32_bf16 v[96:99], a[84:87], v[56:59], v[96:99]
    v_mfma_f32_16x16x32_bf16 v[100:103], a[116:119], v[56:59], v[100:103]
    buffer_load_dwordx4 v[184:187], v1, s[12:15], s59 offen offset:2048 nt
    s_waitcnt lgkmcnt(0)
    v_mfma_f32_16x16x32_bf16 v[72:75], a[24:27], v[60:63], v[72:75]
    v_mfma_f32_16x16x32_bf16 v[76:79], a[56:59], v[60:63], v[76:79]
    v_mfma_f32_16x16x32_bf16 v[80:83], a[88:91], v[60:63], v[80:83]
    v_mfma_f32_16x16x32_bf16 v[84:87], a[120:123], v[60:63], v[84:87]
    s_nop 4
    v_add_f32_dpp v104, v73, v72 row_ror:12 row_mask:0xf bank_mask:0x1
    v_add_f32_dpp v104, v74, v104 row_ror:8 row_mask:0xf bank_mask:0x1
    v_add_f32_dpp v104, v75, v104 row_ror:4 row_mask:0xf bank_mask:0x1
    v_mfma_f32_16x16x32_bf16 v[88:91], a[28:31], v[60:63], v[88:91]
    v_add_f32_dpp v104, v76, v77 row_ror:4 row_mask:0xf bank_mask:0x2
    v_add_f32_dpp v104, v78, v104 row_ror:12 row_mask:0xf bank_mask:0x2
    v_add_f32_dpp v104, v79, v104 row_ror:8 row_mask:0xf bank_mask:0x2
    v_mfma_f32_16x16x32_bf16 v[92:95], a[60:63], v[60:63], v[92:95]
    v_add_f32_dpp v104, v80, v82 row_ror:8 row_mask:0xf bank_mask:0x4
    v_add_f32_dpp v104, v81, v104 row_ror:4 row_mask:0xf bank_mask:0x4
    v_add_f32_dpp v104, v83, v104 row_ror:12 row_mask:0xf bank_mask:0x4
    v_mfma_f32_16x16x32_bf16 v[96:99], a[92:95], v[60:63], v[96:99]
    v_add_f32_dpp v104, v84, v87 row_ror:12 row_mask:0xf bank_mask:0x8
    v_add_f32_dpp v104, v85, v104 row_ror:8 row_mask:0xf bank_mask:0x8
    v_add_f32_dpp v104, v86, v104 row_ror:4 row_mask:0xf bank_mask:0x8
    v_mfma_f32_16x16x32_bf16 v[100:103], a[124:127], v[60:63], v[100:103]
    v_add_f32_dpp v105, v89, v88 row_ror:12 row_mask:0xf bank_mask:0x1
    v_add_f32_dpp v105, v90, v105 row_ror:8 row_mask:0xf bank_mask:0x1
    v_add_f32_dpp v105, v91, v105 row_ror:4 row_mask:0xf bank_mask:0x1
    v_add_f32_dpp v105, v92, v93 row_ror:4 row_mask:0xf bank_mask:0x2
    v_add_f32_dpp v105, v94, v105 row_ror:12 row_mask:0xf bank_mask:0x2
    v_add_f32_dpp v105, v95, v105 row_ror:8 row_mask:0xf bank_mask:0x2
    v_add_f32_dpp v105, v96, v98 row_ror:8 row_mask:0xf bank_mask:0x4
    v_add_f32_dpp v105, v97, v105 row_ror:4 row_mask:0xf bank_mask:0x4
    v_add_f32_dpp v105, v99, v105 row_ror:12 row_mask:0xf bank_mask:0x4
    v_add_f32_dpp v105, v100, v103 row_ror:12 row_mask:0xf bank_mask:0x8
    v_add_f32_dpp v105, v101, v105 row_ror:8 row_mask:0xf bank_mask:0x8
    v_add_f32_dpp v105, v102, v105 row_ror:4 row_mask:0xf bank_mask:0x8
    v_max_f32 v106, v104, v105
    s_nop 1
    v_max_f32_dpp v106, v106, v106 row_ror:1 row_mask:0xf bank_mask:0xf
    s_nop 1
    v_max_f32_dpp v106, v106, v106 row_ror:2 row_mask:0xf bank_mask:0xf
    s_nop 1
    v_max_f32_dpp v106, v106, v106 row_ror:4 row_mask:0xf bank_mask:0xf
    s_nop 1
    v_max_f32_dpp v106, v106, v106 row_ror:8 row_mask:0xf bank_mask:0xf
    s_nop 1
    v_max_f32_dpp v106, v106, v106 row_bcast:15 row_mask:0xa bank_mask:0xf
    s_nop 1
    v_max_f32_dpp v106, v106, v106 row_bcast:31 row_mask:0xc bank_mask:0xf
    buffer_load_dwordx4 v[188:191], v1, s[12:15], s59 offen offset:3072 nt
    v_mul_f32_e64 v106, v106, v27
    s_nop 0
    v_readlane_b32 s72, v106, 63
    s_nop 1
    v_fma_f32 v104, v104, v27, -s72
    v_fma_f32 v105, v105, v27, -s72
    v_exp_f32 v104, v104
    v_exp_f32 v105, v105
    s_nop 0
    v_cvt_pk_bf16_f32 v108, v104, v105
LS6_17:
    buffer_load_dwordx4 v[192:195], v1, s[12:15], s60 offen offset:0 nt
    buffer_load_dwordx4 v[196:199], v1, s[12:15], s60 offen offset:1024 nt
    v_lshlrev_b32 v107, 16, v108
    v_and_b32 v104, 0xffff0000, v108
    v_add_f32 v107, v107, v104
    s_nop 1
    v_add_f32_dpp v107, v107, v107 row_ror:1 row_mask:0xf bank_mask:0xf
    s_nop 1
    v_add_f32_dpp v107, v107, v107 row_ror:2 row_mask:0xf bank_mask:0xf
    s_nop 1
    v_add_f32_dpp v107, v107, v107 row_ror:4 row_mask:0xf bank_mask:0xf
    s_nop 1
    v_add_f32_dpp v107, v107, v107 row_ror:8 row_mask:0xf bank_mask:0xf
    s_nop 1
    v_add_f32_dpp v107, v107, v107 row_bcast:15 row_mask:0xa bank_mask:0xf
    s_nop 1
    v_add_f32_dpp v107, v107, v107 row_bcast:31 row_mask:0xc bank_mask:0xf
    ds_write_b64 v18, v[106:107]
    s_waitcnt lgkmcnt(0)
    s_barrier
    ds_read_b64 v[110:111], v19
    s_waitcnt lgkmcnt(0)
    v_max_f32_dpp v112, v110, v110 quad_perm:[1,0,3,2] row_mask:0xf bank_mask:0xf
    s_nop 1
    v_max_f32_dpp v112, v112, v112 quad_perm:[2,3,0,1] row_mask:0xf bank_mask:0xf
    v_sub_f32 v109, v110, v112
    v_exp_f32 v109, v109
    s_nop 0
    v_mul_f32 v113, v109, v111
    s_nop 1
    v_add_f32_dpp v113, v113, v113 quad_perm:[1,0,3,2] row_mask:0xf bank_mask:0xf
    s_nop 1
    v_add_f32_dpp v113, v113, v113 quad_perm:[2,3,0,1] row_mask:0xf bank_mask:0xf
    s_cmp_lg_u32 s7, 0
    s_cbranch_scc1 Lnos_18
    s_mov_b64 exec, 0x10001
    s_cmp_eq_u32 s78, 0
    s_cbranch_scc1 Lm_19
    buffer_store_dwordx2 v[112:113], v1, s[16:19], s79 offen sc1
    s_branch Lm_20
Lm_19:
    buffer_store_dwordx2 v[112:113], v1, s[16:19], s79 offen
Lm_20:
    s_mov_b64 exec, -1
Lnos_18:
LS7_21:
    v_mov_b32_dpp v64, v108 row_newbcast:0 row_mask:0xf bank_mask:0x1
    v_mov_b32_dpp v65, v108 row_newbcast:0 row_mask:0xf bank_mask:0x2
    v_mov_b32_dpp v66, v108 row_newbcast:0 row_mask:0xf bank_mask:0x4
    v_mov_b32_dpp v67, v108 row_newbcast:0 row_mask:0xf bank_mask:0x8
    s_nop 0
    s_waitcnt vmcnt(16)
    v_perm_b32 v126, v132, v128, s70
    v_perm_b32 v127, v132, v128, s71
    v_perm_b32 v128, v133, v129, s70
    v_perm_b32 v129, v133, v129, s71
    v_perm_b32 v132, v135, v131, s70
    v_perm_b32 v133, v135, v131, s71
    v_perm_b32 v131, v134, v130, s71
    v_perm_b32 v130, v134, v130, s70
    v_mfma_f32_16x16x32_bf16 v[72:75], v[64:67], v[126:129], 0
    v_mov_b32_dpp v68, v108 row_newbcast:1 row_mask:0xf bank_mask:0x1
    v_mov_b32_dpp v69, v108 row_newbcast:1 row_mask:0xf bank_mask:0x2
    v_mov_b32_dpp v70, v108 row_newbcast:1 row_mask:0xf bank_mask:0x4
    v_mfma_f32_16x16x32_bf16 v[76:79], v[64:67], v[130:133], 0
    v_mov_b32_dpp v71, v108 row_newbcast:1 row_mask:0xf bank_mask:0x8
    s_nop 0
    s_waitcnt vmcnt(14)
    v_perm_b32 v134, v140, v136, s70
    v_perm_b32 v135, v140, v136, s71
    v_perm_b32 v136, v141, v137, s70
    v_perm_b32 v137, v141, v137, s71
    v_perm_b32 v140, v143, v139, s70
    v_perm_b32 v141, v143, v139, s71
    v_perm_b32 v139, v142, v138, s71
    v_perm_b32 v138, v142, v138, s70
    v_mfma_f32_16x16x32_bf16 v[72:75], v[68:71], v[134:137], v[72:75]
    v_mov_b32_dpp v64, v108 row_newbcast:2 row_mask:0xf bank_mask:0x1
    v_mov_b32_dpp v65, v108 row_newbcast:2 row_mask:0xf bank_mask:0x2
    v_mov_b32_dpp v66, v108 row_newbcast:2 row_mask:0xf bank_mask:0x4
    v_mfma_f32_16x16x32_bf16 v[76:79], v[68:71], v[138:141], v[76:79]
    v_mov_b32_dpp v67, v108 row_newbcast:2 row_mask:0xf bank_mask:0x8
    buffer_load_dwordx4 v[200:203], v1, s[12:15], s60 offen offset:2048 nt
    buffer_load_dwordx4 v[204:207], v1, s[12:15], s60 offen offset:3072 nt
    s_nop 0
    s_waitcnt vmcnt(14)
    v_perm_b32 v142, v148, v144, s70
    v_perm_b32 v143, v148, v144, s71
    v_perm_b32 v144, v149, v145, s70
    v_perm_b32 v145, v149, v145, s71
    v_perm_b32 v148, v151, v147, s70
    v_perm_b32 v149, v151, v147, s71
    v_perm_b32 v147, v150, v146, s71
    v_perm_b32 v146, v150, v146, s70
    v_mfma_f32_16x16x32_bf16 v[72:75], v[64:67], v[142:145], v[72:75]
    v_mov_b32_dpp v68, v108 row_newbcast:3 row_mask:0xf bank_mask:0x1
    v_mov_b32_dpp v69, v108 row_newbcast:3 row_mask:0xf bank_mask:0x2
    v_mov_b32_dpp v70, v108 row_newbcast:3 row_mask:0xf bank_mask:0x4
    v_mfma_f32_16x16x32_bf16 v[76:79], v[64:67], v[146:149], v[76:79]
    v_mov_b32_dpp v71, v108 row_newbcast:3 row_mask:0xf bank_mask:0x8
    buffer_load_dwordx4 v[208:211], v1, s[12:15], s61 offen offset:0 nt
    buffer_load_dwordx4 v[212:215], v1, s[12:15], s61 offen offset:1024 nt
    s_nop 0
    s_waitcnt vmcnt(14)
    v_perm_b32 v150, v156, v152, s70
    v_perm_b32 v151, v156, v152, s71
    v_perm_b32 v152, v157, v153, s70
    v_perm_b32 v153, v157, v153, s71
    v_perm_b32 v156, v159, v155, s70
    v_perm_b32 v157, v159, v155, s71
    v_perm_b32 v155, v158, v154, s71
    v_perm_b32 v154, v158, v154, s70
    v_mfma_f32_16x16x32_bf16 v[72:75], v[68:71], v[150:153], v[72:75]
    v_mov_b32_dpp v64, v108 row_newbcast:4 row_mask:0xf bank_mask:0x1
    v_mov_b32_dpp v65, v108 row_newbcast:4 row_mask:0xf bank_mask:0x2
    v_mov_b32_dpp v66, v108 row_newbcast:4 row_mask:0xf bank_mask:0x4
    v_mfma_f32_16x16x32_bf16 v[76:79], v[68:71], v[154:157], v[76:79]
    v_mov_b32_dpp v67, v108 row_newbcast:4 row_mask:0xf bank_mask:0x8
    buffer_load_dwordx4 v[216:219], v1, s[12:15], s61 offen offset:2048 nt
    buffer_load_dwordx4 v[220:223], v1, s[12:15], s61 offen offset:3072 nt
    s_nop 0
    s_waitcnt vmcnt(14)
    v_perm_b32 v158, v164, v160, s70
    v_perm_b32 v159, v164, v160, s71
    v_perm_b32 v160, v165, v161, s70
    v_perm_b32 v161, v165, v161, s71
    v_perm_b32 v164, v167, v163, s70
    v_perm_b32 v165, v167, v163, s71
    v_perm_b32 v163, v166, v162, s71
    v_perm_b32 v162, v166, v162, s70
    v_mfma_f32_16x16x32_bf16 v[72:75], v[64:67], v[158:161], v[72:75]
    v_mov_b32_dpp v68, v108 row_newbcast:5 row_mask:0xf bank_mask:0x1
    v_mov_b32_dpp v69, v108 row_newbcast:5 row_mask:0xf bank_mask:0x2
    v_mov_b32_dpp v70, v108 row_newbcast:5 row_mask:0xf bank_mask:0x4
    v_mfma_f32_16x16x32_bf16 v[76:79], v[64:67], v[162:165], v[76:79]
    v_mov_b32_dpp v71, v108 row_newbcast:5 row_mask:0xf bank_mask:0x8
    buffer_load_dwordx4 v[224:227], v1, s[12:15], s62 offen offset:0 nt
    buffer_load_dwordx4 v[228:231], v1, s[12:15], s62 offen offset:1024 nt
    s_nop 0
    s_waitcnt vmcnt(14)
    v_perm_b32 v166, v172, v168, s70
    v_perm_b32 v167, v172, v168, s71
    v_perm_b32 v168, v173, v169, s70
    v_perm_b32 v169, v173, v169, s71
    v_perm_b32 v172, v175, v171, s70
    v_perm_b32 v173, v175, v171, s71
    v_perm_b32 v171, v174, v170, s71
    v_perm_b32 v170, v174, v170, s70
    v_mfma_f32_16x16x32_bf16 v[72:75], v[68:71], v[166:169], v[72:75]
    v_mov_b32_dpp v64, v108 row_newbcast:6 row_mask:0xf bank_mask:0x1
    v_mov_b32_dpp v65, v108 row_newbcast:6 row_mask:0xf bank_mask:0x2
    v_mov_b32_dpp v66, v108 row_newbcast:6 row_mask:0xf bank_mask:0x4
    v_mfma_f32_16x16x32_bf16 v[76:79], v[68:71], v[170:173], v[76:79]
    v_mov_b32_dpp v67, v108 row_newbcast:6 row_mask:0xf bank_mask:0x8
    buffer_load_dword v114, v119, s[52:55], 0 offen sc1
    buffer_load_dwordx4 v[232:235], v1, s[12:15], s62 offen offset:2048 nt
    s_nop 0
    s_waitcnt vmcnt(14)
    v_perm_b32 v174, v180, v176, s70
    v_perm_b32 v175, v180, v176, s71
    v_perm_b32 v176, v181, v177, s70
    v_perm_b32 v177, v181, v177, s71
    v_perm_b32 v180, v183, v179, s70
    v_perm_b32 v181, v183, v179, s71
    v_perm_b32 v179, v182, v178, s71
    v_perm_b32 v178, v182, v178, s70
    v_mfma_f32_16x16x32_bf16 v[72:75], v[64:67], v[174:177], v[72:75]
    v_mov_b32_dpp v68, v108 row_newbcast:7 row_mask:0xf bank_mask:0x1
    v_mov_b32_dpp v69, v108 row_newbcast:7 row_mask:0xf bank_mask:0x2
    v_mov_b32_dpp v70, v108 row_newbcast:7 row_mask:0xf bank_mask:0x4
    v_mfma_f32_16x16x32_bf16 v[76:79], v[64:67], v[178:181], v[76:79]
    v_mov_b32_dpp v71, v108 row_newbcast:7 row_mask:0xf bank_mask:0x8
    buffer_load_dwordx4 v[236:239], v1, s[12:15], s62 offen offset:3072 nt
    buffer_load_dwordx4 v[240:243], v1, s[12:15], s63 offen offset:0 nt
    s_nop 0
    s_waitcnt vmcnt(14)
    v_perm_b32 v182, v188, v184, s70
    v_perm_b32 v183, v188, v184, s71
    v_perm_b32 v184, v189, v185, s70
    v_perm_b32 v185, v189, v185, s71
    v_perm_b32 v188, v191, v187, s70
    v_perm_b32 v189, v191, v187, s71
    v_perm_b32 v187, v190, v186, s71
    v_perm_b32 v186, v190, v186, s70
    v_mfma_f32_16x16x32_bf16 v[72:75], v[68:71], v[182:185], v[72:75]
    v_mov_b32_dpp v64, v108 row_newbcast:8 row_mask:0xf bank_mask:0x1
    v_mov_b32_dpp v65, v108 row_newbcast:8 row_mask:0xf bank_mask:0x2
    v_mov_b32_dpp v66, v108 row_newbcast:8 row_mask:0xf bank_mask:0x4
    v_mfma_f32_16x16x32_bf16 v[76:79], v[68:71], v[186:189], v[76:79]
    v_mov_b32_dpp v67, v108 row_newbcast:8 row_mask:0xf bank_mask:0x8
    buffer_load_dwordx4 v[244:247], v1, s[12:15], s63 offen offset:1024 nt
    buffer_load_dwordx4 v[248:251], v1, s[12:15], s63 offen offset:2048 nt
    s_nop 0
    s_waitcnt vmcnt(14)
    v_perm_b32 v190, v196, v192, s70
    v_perm_b32 v191, v196, v192, s71
    v_perm_b32 v192, v197, v193, s70
    v_perm_b32 v193, v197, v193, s71
    v_perm_b32 v196, v199, v195, s70
    v_perm_b32 v197, v199, v195, s71
    v_perm_b32 v195, v198, v194, s71
    v_perm_b32 v194, v198, v194, s70
    v_mfma_f32_16x16x32_bf16 v[72:75], v[64:67], v[190:193], v[72:75]
    v_mov_b32_dpp v68, v108 row_newbcast:9 row_mask:0xf bank_mask:0x1
    v_mov_b32_dpp v69, v108 row_newbcast:9 row_mask:0xf bank_mask:0x2
    v_mov_b32_dpp v70, v108 row_newbcast:9 row_mask:0xf bank_mask:0x4
    v_mfma_f32_16x16x32_bf16 v[76:79], v[64:67], v[194:197], v[76:79]
    v_mov_b32_dpp v71, v108 row_newbcast:9 row_mask:0xf bank_mask:0x8
    buffer_load_dwordx4 v[252:255], v1, s[12:15], s63 offen offset:3072 nt
    s_mul_i32 s90, s73, 221184
    s_mul_i32 s91, s3, 432
    s_add_u32 s90, s90, s91
    s_lshl_b32 s91, s7, 7
    s_add_u32 s90, s90, s91
    buffer_load_dwordx2 a[192:193], v25, s[32:35], s90 offen
    s_add_u32 s90, s90, 3456
    buffer_load_dwordx2 a[194:195], v25, s[32:35], s90 offen
    s_add_u32 s90, s90, 3456
    buffer_load_dwordx2 a[196:197], v25, s[32:35], s90 offen
    s_add_u32 s90, s90, 3456
    buffer_load_dwordx2 a[198:199], v25, s[32:35], s90 offen
    s_add_u32 s90, s90, 3456
    buffer_load_dwordx2 a[200:201], v25, s[32:35], s90 offen
    s_add_u32 s90, s90, 3456
    buffer_load_dwordx2 a[202:203], v25, s[32:35], s90 offen
    s_add_u32 s90, s90, 3456
    buffer_load_dwordx2 a[204:205], v25, s[32:35], s90 offen
    s_add_u32 s90, s90, 3456
    buffer_load_dwordx2 a[206:207], v25, s[32:35], s90 offen
    s_waitcnt vmcnt(21)
    v_perm_b32 v198, v204, v200, s70
    v_perm_b32 v199, v204, v200, s71
    v_perm_b32 v200, v205, v201, s70
    v_perm_b32 v201, v205, v201, s71
    v_perm_b32 v204, v207, v203, s70
    v_perm_b32 v205, v207, v203, s71
    v_perm_b32 v203, v206, v202, s71
    v_perm_b32 v202, v206, v202, s70
    v_mfma_f32_16x16x32_bf16 v[72:75], v[68:71], v[198:201], v[72:75]
    v_mov_b32_dpp v64, v108 row_newbcast:10 row_mask:0xf bank_mask:0x1
    v_mov_b32_dpp v65, v108 row_newbcast:10 row_mask:0xf bank_mask:0x2
    v_mov_b32_dpp v66, v108 row_newbcast:10 row_mask:0xf bank_mask:0x4
    v_mfma_f32_16x16x32_bf16 v[76:79], v[68:71], v[202:205], v[76:79]
    v_mov_b32_dpp v67, v108 row_newbcast:10 row_mask:0xf bank_mask:0x8
    s_nop 0
    s_waitcnt vmcnt(19)
    v_perm_b32 v206, v212, v208, s70
    v_perm_b32 v207, v212, v208, s71
    v_perm_b32 v208, v213, v209, s70
    v_perm_b32 v209, v213, v209, s71
    v_perm_b32 v212, v215, v211, s70
    v_perm_b32 v213, v215, v211, s71
    v_perm_b32 v211, v214, v210, s71
    v_perm_b32 v210, v214, v210, s70
    v_mfma_f32_16x16x32_bf16 v[72:75], v[64:67], v[206:209], v[72:75]
    v_mov_b32_dpp v68, v108 row_newbcast:11 row_mask:0xf bank_mask:0x1
    v_mov_b32_dpp v69, v108 row_newbcast:11 row_mask:0xf bank_mask:0x2
    v_mov_b32_dpp v70, v108 row_newbcast:11 row_mask:0xf bank_mask:0x4
    v_mfma_f32_16x16x32_bf16 v[76:79], v[64:67], v[210:213], v[76:79]
    v_mov_b32_dpp v71, v108 row_newbcast:11 row_mask:0xf bank_mask:0x8
    s_nop 0
    s_waitcnt vmcnt(17)
    v_perm_b32 v214, v220, v216, s70
    v_perm_b32 v215, v220, v216, s71
    v_perm_b32 v216, v221, v217, s70
    v_perm_b32 v217, v221, v217, s71
    v_perm_b32 v220, v223, v219, s70
    v_perm_b32 v221, v223, v219, s71
    v_perm_b32 v219, v222, v218, s71
    v_perm_b32 v218, v222, v218, s70
    v_mfma_f32_16x16x32_bf16 v[72:75], v[68:71], v[214:217], v[72:75]
    v_mov_b32_dpp v64, v108 row_newbcast:12 row_mask:0xf bank_mask:0x1
    v_mov_b32_dpp v65, v108 row_newbcast:12 row_mask:0xf bank_mask:0x2
    v_mov_b32_dpp v66, v108 row_newbcast:12 row_mask:0xf bank_mask:0x4
    v_mfma_f32_16x16x32_bf16 v[76:79], v[68:71], v[218:221], v[76:79]
    v_mov_b32_dpp v67, v108 row_newbcast:12 row_mask:0xf bank_mask:0x8
    s_nop 0
    s_waitcnt vmcnt(15)
    v_perm_b32 v222, v228, v224, s70
    v_perm_b32 v223, v228, v224, s71
    v_perm_b32 v224, v229, v225, s70
    v_perm_b32 v225, v229, v225, s71
    v_perm_b32 v228, v231, v227, s70
    v_perm_b32 v229, v231, v227, s71
    v_perm_b32 v227, v230, v226, s71
    v_perm_b32 v226, v230, v226, s70
    v_mfma_f32_16x16x32_bf16 v[72:75], v[64:67], v[222:225], v[72:75]
    v_mov_b32_dpp v68, v108 row_newbcast:13 row_mask:0xf bank_mask:0x1
    v_mov_b32_dpp v69, v108 row_newbcast:13 row_mask:0xf bank_mask:0x2
    v_mov_b32_dpp v70, v108 row_newbcast:13 row_mask:0xf bank_mask:0x4
    v_mfma_f32_16x16x32_bf16 v[76:79], v[64:67], v[226:229], v[76:79]
    v_mov_b32_dpp v71, v108 row_newbcast:13 row_mask:0xf bank_mask:0x8
    s_nop 0
    s_waitcnt vmcnt(12)
    v_perm_b32 v230, v236, v232, s70
    v_perm_b32 v231, v236, v232, s71
    v_perm_b32 v232, v237, v233, s70
    v_perm_b32 v233, v237, v233, s71
    v_perm_b32 v236, v239, v235, s70
    v_perm_b32 v237, v239, v235, s71
    v_perm_b32 v235, v238, v234, s71
    v_perm_b32 v234, v238, v234, s70
    v_mfma_f32_16x16x32_bf16 v[72:75], v[68:71], v[230:233], v[72:75]
    v_mov_b32_dpp v64, v108 row_newbcast:14 row_mask:0xf bank_mask:0x1
    v_mov_b32_dpp v65, v108 row_newbcast:14 row_mask:0xf bank_mask:0x2
    v_mov_b32_dpp v66, v108 row_newbcast:14 row_mask:0xf bank_mask:0x4
    v_mfma_f32_16x16x32_bf16 v[76:79], v[68:71], v[234:237], v[76:79]
    v_mov_b32_dpp v67, v108 row_newbcast:14 row_mask:0xf bank_mask:0x8
    s_nop 0
    s_waitcnt vmcnt(10)
    v_perm_b32 v238, v244, v240, s70
    v_perm_b32 v239, v244, v240, s71
    v_perm_b32 v240, v245, v241, s70
    v_perm_b32 v241, v245, v241, s71
    v_perm_b32 v244, v247, v243, s70
    v_perm_b32 v245, v247, v243, s71
    v_perm_b32 v243, v246, v242, s71
    v_perm_b32 v242, v246, v242, s70
    v_mfma_f32_16x16x32_bf16 v[72:75], v[64:67], v[238:241], v[72:75]
    v_mov_b32_dpp v68, v108 row_newbcast:15 row_mask:0xf bank_mask:0x1
    v_mov_b32_dpp v69, v108 row_newbcast:15 row_mask:0xf bank_mask:0x2
    v_mov_b32_dpp v70, v108 row_newbcast:15 row_mask:0xf bank_mask:0x4
    v_mfma_f32_16x16x32_bf16 v[76:79], v[64:67], v[242:245], v[76:79]
    v_mov_b32_dpp v71, v108 row_newbcast:15 row_mask:0xf bank_mask:0x8
    s_nop 0
    s_waitcnt vmcnt(8)
    v_perm_b32 v246, v252, v248, s70
    v_perm_b32 v247, v252, v248, s71
    v_perm_b32 v248, v253, v249, s70
    v_perm_b32 v249, v253, v249, s71
    v_perm_b32 v252, v255, v251, s70
    v_perm_b32 v253, v255, v251, s71
    v_perm_b32 v251, v254, v250, s71
    v_perm_b32 v250, v254, v250, s70
    v_mfma_f32_16x16x32_bf16 v[72:75], v[68:71], v[246:249], v[72:75]
    s_nop 0
    v_mfma_f32_16x16x32_bf16 v[76:79], v[68:71], v[250:253], v[76:79]
    s_mov_b32 s64, 0x0
    s_add_u32 s65, s79, 0x0
    s_movk_i32 s66, 0x2000
    s_cmp_lg_u32 s78, 0
    s_cbranch_scc1 L_loopA_slow
L_loopA_fast:
LS10_22:
    s_nop 0
    v_mul_f32_dpp v104, v109, v72 quad_perm:[0,0,0,0] row_mask:0xf bank_mask:0xf
    s_nop 0
    v_mul_f32_dpp v105, v109, v76 quad_perm:[0,0,0,0] row_mask:0xf bank_mask:0xf
    ds_write2_b32 v20, v104, v105 offset0:0 offset1:64
    s_cmp_lg_u32 s7, 0
    s_waitcnt lgkmcnt(0)
    s_barrier
    s_cbranch_scc1 Lsk_23
    ds_read2_b64 v[72:75], v21 offset0:0 offset1:64
    ds_read2_b64 v[76:79], v21 offset0:128 offset1:192
    s_waitcnt lgkmcnt(1)
    v_pk_add_f32 v[72:73], v[72:73], v[74:75]
    s_waitcnt lgkmcnt(0)
    v_pk_add_f32 v[76:77], v[76:77], v[78:79]
    v_pk_add_f32 v[72:73], v[72:73], v[76:77]
    v_cvt_pk_bf16_f32 v72, v72, v73
    buffer_store_dword v72, v8, s[16:19], s64 offen
Lsk_23:
LS11_24:
    s_nop 0
    s_barrier
    s_add_u32 s90, s90, 86400
    buffer_load_dwordx2 a[208:209], v25, s[32:35], s90 offen
    s_add_u32 s90, s90, 3456
    buffer_load_dwordx2 a[210:211], v25, s[32:35], s90 offen
    s_add_u32 s90, s90, 3456
    buffer_load_dwordx2 a[212:213], v25, s[32:35], s90 offen
    s_add_u32 s90, s90, 3456
    buffer_load_dwordx2 a[214:215], v25, s[32:35], s90 offen
    s_add_u32 s90, s90, 3456
    buffer_load_dwordx2 a[216:217], v25, s[32:35], s90 offen
    s_add_u32 s90, s90, 3456
    buffer_load_dwordx2 a[218:219], v25, s[32:35], s90 offen
    s_add_u32 s90, s90, 3456
    buffer_load_dwordx2 a[220:221], v25, s[32:35], s90 offen
    s_add_u32 s90, s90, 3456
    buffer_load_dwordx2 a[222:223], v25, s[32:35], s90 offen
    s_nop 0
    s_waitcnt vmcnt(22)
Lfc_27:
    v_and_b32 v120, 0x80808080, v114
    v_cmp_ne_u32 vcc, 0x80808080, v120
    s_cbranch_vccnz Lretry_28
Lfok_26:
    v_and_b32 v120, 0x40404040, v114
    v_bcnt_u32_b32 v120, v120, 0
    s_nop 1
    v_add_u32_dpp v120, v120, v120 row_ror:1 row_mask:0xf bank_mask:0xf
    s_nop 1
    v_add_u32_dpp v120, v120, v120 row_ror:2 row_mask:0xf bank_mask:0xf
    s_nop 1
    v_add_u32_dpp v120, v120, v120 row_ror:4 row_mask:0xf bank_mask:0xf
    s_nop 1
    v_add_u32_dpp v120, v120, v120 row_ror:8 row_mask:0xf bank_mask:0xf
    s_nop 1
    v_add_u32_dpp v120, v120, v120 row_bcast:15 row_mask:0xa bank_mask:0xf
    s_nop 1
    v_add_u32_dpp v120, v120, v120 row_bcast:31 row_mask:0xc bank_mask:0xf
    s_nop 0
    v_readlane_b32 s67, v120, 63
    s_nop 0
    s_cmp_gt_u32 s67, 16
    s_cselect_b32 s67, 0, 0x2000
    s_lshl_b32 s68, s75, 11
    s_and_b32 s68, s68, 0x2000
    s_xor_b32 s66, s67, s68
    v_bfe_u32 v105, v0, 3, 2
    v_lshlrev_b32 v105, 11, v105
    v_and_b32 v104, 7, v0
    v_lshl_add_u32 v105, v104, 4, v105
    s_add_u32 s67, s76, 0x6000
Lp_29:
    buffer_load_dword v104, v105, s[16:19], s67 offen sc1
    s_sub_u32 s69, s69, 1
    s_cbranch_scc1 Lgive_30
    s_waitcnt vmcnt(0)
    v_cmp_eq_u32 vcc, -1, v104
    s_cbranch_vccnz Lp_29
Lok_31:
    s_bitcmp0_b32 s7, 0
    s_cbranch_scc1 La_35
    v_mov_b32 v42, 0
    v_mov_b32_e64 v43, 0
    buffer_atomic_or_x2 v[42:43], v13, s[16:19], s66 offen offset:0 sc0 sc1
La_35:
    v_accvgpr_read_b32 v72, a192
    v_accvgpr_read_b32 v73, a193
    v_accvgpr_read_b32 v74, a194
    v_accvgpr_read_b32 v75, a195
    v_accvgpr_read_b32 v76, a196
    v_accvgpr_read_b32 v77, a197
    v_accvgpr_read_b32 v78, a198
    v_accvgpr_read_b32 v79, a199
    v_accvgpr_read_b32 v80, a200
    v_accvgpr_read_b32 v81, a201
    v_accvgpr_read_b32 v82, a202
    v_accvgpr_read_b32 v83, a203
    v_accvgpr_read_b32 v84, a204
    v_accvgpr_read_b32 v85, a205
    v_accvgpr_read_b32 v86, a206
    v_accvgpr_read_b32 v87, a207
    v_perm_b32 v88, v74, v72, s70
    v_accvgpr_write_b32 a192, v88
    v_perm_b32 v89, v78, v76, s70
    v_accvgpr_write_b32 a193, v89
    v_perm_b32 v88, v82, v80, s70
    v_accvgpr_write_b32 a194, v88
    v_perm_b32 v89, v86, v84, s70
    v_accvgpr_write_b32 a195, v89
    v_perm_b32 v88, v74, v72, s71
    v_accvgpr_write_b32 a196, v88
    v_perm_b32 v89, v78, v76, s71
    v_accvgpr_write_b32 a197, v89
    v_perm_b32 v88, v82, v80, s71
    v_accvgpr_write_b32 a198, v88
    v_perm_b32 v89, v86, v84, s71
    v_accvgpr_write_b32 a199, v89
    v_perm_b32 v88, v75, v73, s70
    v_accvgpr_write_b32 a200, v88
    v_perm_b32 v89, v79, v77, s70
    v_accvgpr_write_b32 a201, v89
    v_perm_b32 v88, v83, v81, s70
    v_accvgpr_write_b32 a202, v88
    v_perm_b32 v89, v87, v85, s70
    v_accvgpr_write_b32 a203, v89
    v_perm_b32 v88, v75, v73, s71
    v_accvgpr_write_b32 a204, v88
    v_perm_b32 v89, v79, v77, s71
    v_accvgpr_write_b32 a205, v89
    v_perm_b32 v88, v83, v81, s71
    v_accvgpr_write_b32 a206, v88
    v_perm_b32 v89, v87, v85, s71
    v_accvgpr_write_b32 a207, v89
    s_bitcmp0_b32 s7, 0
    s_cbranch_scc1 La_36
    v_mov_b32 v44, 0
    v_mov_b32 v45, 0
    buffer_atomic_or_x2 v[44:45], v13, s[16:19], s66 offen offset:0 sc0 sc1
La_36:
    v_accvgpr_read_b32 v72, a208
    v_accvgpr_read_b32 v73, a209
    v_accvgpr_read_b32 v74, a210
    v_accvgpr_read_b32 v75, a211
    v_accvgpr_read_b32 v76, a212
    v_accvgpr_read_b32 v77, a213
    v_accvgpr_read_b32 v78, a214
    v_accvgpr_read_b32 v79, a215
    v_accvgpr_read_b32 v80, a216
    v_accvgpr_read_b32 v81, a217
    v_accvgpr_read_b32 v82, a218
    v_accvgpr_read_b32 v83, a219
    v_accvgpr_read_b32 v84, a220
    v_accvgpr_read_b32 v85, a221
    v_accvgpr_read_b32 v86, a222
    v_accvgpr_read_b32 v87, a223
    v_perm_b32 v88, v74, v72, s70
    v_accvgpr_write_b32 a208, v88
    v_perm_b32 v89, v78, v76, s70
    v_accvgpr_write_b32 a209, v89
    v_perm_b32 v88, v82, v80, s70
    v_accvgpr_write_b32 a210, v88
    v_perm_b32 v89, v86, v84, s70
    v_accvgpr_write_b32 a211, v89
    v_perm_b32 v88, v74, v72, s71
    v_accvgpr_write_b32 a212, v88
    v_perm_b32 v89, v78, v76, s71
    v_accvgpr_write_b32 a213, v89
    v_perm_b32 v88, v82, v80, s71
    v_accvgpr_write_b32 a214, v88
    v_perm_b32 v89, v86, v84, s71
    v_accvgpr_write_b32 a215, v89
    v_perm_b32 v88, v75, v73, s70
    v_accvgpr_write_b32 a216, v88
    v_perm_b32 v89, v79, v77, s70
    v_accvgpr_write_b32 a217, v89
    v_perm_b32 v88, v83, v81, s70
    v_accvgpr_write_b32 a218, v88
    v_perm_b32 v89, v87, v85, s70
    v_accvgpr_write_b32 a219, v89
    v_perm_b32 v88, v75, v73, s71
    v_accvgpr_write_b32 a220, v88
    v_perm_b32 v89, v79, v77, s71
    v_accvgpr_write_b32 a221, v89
    v_perm_b32 v88, v83, v81, s71
    v_accvgpr_write_b32 a222, v88
    v_perm_b32 v89, v87, v85, s71
    v_accvgpr_write_b32 a223, v89
    s_mov_b32 s68, 0xe8000
    v_mfma_f32_16x16x32_bf16 v[72:75], v[36:39], a[192:195], 0
    v_mfma_f32_16x16x32_bf16 v[76:79], v[36:39], a[196:199], 0
    v_mfma_f32_16x16x32_bf16 v[80:83], v[36:39], a[200:203], 0
    v_mfma_f32_16x16x32_bf16 v[84:87], v[36:39], a[204:207], 0
    v_mfma_f32_16x16x32_bf16 v[72:75], v[36:39], a[208:211], v[72:75]
    v_mfma_f32_16x16x32_bf16 v[76:79], v[36:39], a[212:215], v[76:79]
    v_mfma_f32_16x16x32_bf16 v[80:83], v[36:39], a[216:219], v[80:83]
    v_mfma_f32_16x16x32_bf16 v[84:87], v[36:39], a[220:223], v[84:87]
    s_mov_b64 exec, 0xffff
    s_nop 4
    v_mov_b32 v73, v76
    v_mov_b32 v74, v80
    v_mov_b32 v75, v84
    buffer_store_dwordx4 v[72:75], v14, s[16:19], s68 offen
    s_mov_b64 exec, -1
    v_and_b32 v113, 0x30, v0
    s_cmp_lg_u32 s7, 0
    s_cbranch_scc1 Lpr_37
    s_branch Lb_32
Lpr_37:
    s_bitcmp0_b32 s7, 0
    s_cbranch_scc1 Lb_32
    v_and_b32 v112, 7, v0
    v_lshl_add_u32 v112, v112, 1, v113
    s_and_b32 s67, s74, 1
    s_lshl_b32 s67, s67, 6
    v_add_u32 v112, s67, v112
Lp_33:
    v_mov_b32 v46, 0
    v_mov_b32 v47, 0
    buffer_atomic_or_x2 v[46:47], v13, s[16:19], s66 offen offset:0 sc0 sc1
    s_waitcnt vmcnt(2)
    v_cmp_gt_u32 vcc, 0x41000000, v43
    v_add_f64 v[110:111], v[42:43], v[40:41]
    s_cbranch_vccz Lok_34
    v_mov_b32 v42, 0
    v_mov_b32 v43, 0
    buffer_atomic_or_x2 v[42:43], v13, s[16:19], s66 offen offset:0 sc0 sc1
    s_waitcnt vmcnt(2)
    v_cmp_gt_u32 vcc, 0x41000000, v45
    v_add_f64 v[110:111], v[44:45], v[40:41]
    s_cbranch_vccz Lok_34
    v_mov_b32 v44, 0
    v_mov_b32_e64 v45, 0
    buffer_atomic_or_x2 v[44:45], v13, s[16:19], s66 offen offset:0 sc0 sc1
    s_waitcnt vmcnt(2)
    v_cmp_gt_u32 vcc, 0x41000000, v47
    v_add_f64 v[110:111], v[46:47], v[40:41]
    s_cbranch_vccz Lok_34
    s_sub_u32 s69, s69, 1
    s_cbranch_scc0 Lp_33
    s_mov_b32 s69, 0
Lok_34:
    v_cvt_f32_f64_e64 v109, v[110:111]
    s_nop 1
    v_add_f32_dpp v109, v109, v109 row_ror:8 row_mask:0xf bank_mask:0xf
    v_cvt_pk_bf16_f32 v109, v109, v109
    ds_write_b16 v112, v109 offset:10240
    s_waitcnt lgkmcnt(0)
Lb_32:
    s_barrier
    ds_read_b128 v[32:35], v113 offset:10240
    ds_read_b128 v[28:31], v113 offset:10304
    s_nop 0
    s_waitcnt lgkmcnt(1)
LS13_38:
    v_mfma_f32_16x16x32_bf16 v[72:75], v[32:35], a[192:195], 0
    v_mov_b32_dpp v36, v32 quad_perm:[0,1,2,3] row_mask:0xf bank_mask:0x3
    v_mov_b32_dpp v37, v33 quad_perm:[0,1,2,3] row_mask:0xf bank_mask:0x3
    v_mfma_f32_16x16x32_bf16 v[76:79], v[32:35], a[196:199], 0
    v_mov_b32_dpp v38, v34 quad_perm:[0,1,2,3] row_mask:0xf bank_mask:0x3
    v_mov_b32_dpp v39, v35 quad_perm:[0,1,2,3] row_mask:0xf bank_mask:0x3
    v_mfma_f32_16x16x32_bf16 v[80:83], v[32:35], a[200:203], 0
    v_mfma_f32_16x16x32_bf16 v[84:87], v[32:35], a[204:207], 0
    v_mfma_f32_16x16x32_bf16 v[120:123], v[32:35], v[36:39], 0
    s_nop 0
    s_waitcnt lgkmcnt(0)
    v_mfma_f32_16x16x32_bf16 v[72:75], v[28:31], a[208:211], v[72:75]
    v_mov_b32_dpp v36, v28 quad_perm:[0,1,2,3] row_mask:0xf bank_mask:0x3
    v_mov_b32_dpp v37, v29 quad_perm:[0,1,2,3] row_mask:0xf bank_mask:0x3
    v_mfma_f32_16x16x32_bf16 v[76:79], v[28:31], a[212:215], v[76:79]
    v_mov_b32_dpp v38, v30 quad_perm:[0,1,2,3] row_mask:0xf bank_mask:0x3
    v_mov_b32_dpp v39, v31 quad_perm:[0,1,2,3] row_mask:0xf bank_mask:0x3
    v_mfma_f32_16x16x32_bf16 v[80:83], v[28:31], a[216:219], v[80:83]
    v_mfma_f32_16x16x32_bf16 v[84:87], v[28:31], a[220:223], v[84:87]
    v_mfma_f32_16x16x32_bf16 v[120:123], v[28:31], v[36:39], v[120:123]
    s_mov_b64 exec, 0xffff
    s_nop 1
    v_mov_b32 v73, v76
    s_nop 1
    v_mov_b32 v74, v80
    v_mov_b32 v75, v84
    buffer_store_dwordx4 v[72:75], v14, s[16:19], s64 offen
    s_mov_b64 exec, 0x101
    buffer_store_dword v120, v5, s[16:19], s64 offen offset:256
    s_mov_b64 exec, -1
    s_mov_b32 exec_lo, 0x00ff00ff
    s_mov_b32 exec_hi, 0x00ff00ff
    v_lshlrev_b32 v112, 16, v109
    v_accvgpr_read_b32 v113, a226
    v_lshlrev_b32 v113, 16, v113
    v_add_f32 v112, v112, v113
    v_cvt_f64_f32 v[40:41], v112
    v_add_f64 v[40:41], v[40:41], -s[0:1]
    s_mov_b64 exec, -1
LS14_39:
    v_and_b32 v113, 0x30, v0
    s_cmp_lg_u32 s7, 0
    s_cbranch_scc1 Lpr_43
    s_lshl_b32 s56, s3, 3
    s_lshl_b64 exec, 0xff, s56
    s_movk_i32 s66, 0x2000
    v_mov_b32 v42, 0
    v_mov_b32 v43, 0
    v_mov_b32 v44, 0
    v_mov_b32 v45, 0
    buffer_atomic_or_x2 v[42:43], v13, s[16:19], 0 offen offset:192 sc0 sc1
    buffer_atomic_or_x2 v[44:45], v13, s[16:19], s66 offen offset:192 sc0 sc1
    s_mov_b64 exec, -1
    s_waitcnt vmcnt(1)
    s_memtime s[56:57]
    s_waitcnt vmcnt(0)
    s_memtime s[58:59]
    s_waitcnt lgkmcnt(0)
    s_sub_u32 s56, s58, s56
    s_cmp_gt_u32 s56, 64
    s_cselect_b32 s66, 0, 8192
    v_mov_b32 v42, s66
    v_mov_b32 v43, 0
    ds_write_b32 v43, v42 offset:10368
Lpr_43:
    s_waitcnt vmcnt(0) lgkmcnt(0)
    s_barrier
    s_mov_b32 s68, 0xe8000
    buffer_load_dwordx4 a[248:251], v4, s[16:19], s68 offen sc1
    buffer_load_dwordx4 a[244:247], v3, s[16:19], s68 offen sc1
    s_bitcmp0_b32 s7, 0
    s_cbranch_scc1 Lbw_44
    s_bitcmp0_b32 s7, 0
    s_cbranch_scc1 Lb_40
    v_mov_b32 v43, 0
    ds_read_b32 v42, v43 offset:10368
    s_waitcnt lgkmcnt(0)
    v_readfirstlane_b32 s67, v42
    s_nop 0
    s_and_b32 s66, s67, 0x2000
    s_nop 15
    s_nop 15
    s_nop 15
    v_mov_b32 v42, 0
    v_mov_b32 v43, 0
    buffer_atomic_or_x2 v[42:43], v13, s[16:19], s66 offen offset:64 sc0 sc1
    v_and_b32 v112, 7, v0
    v_lshl_add_u32 v112, v112, 1, v113
    s_and_b32 s67, s74, 1
    s_lshl_b32 s67, s67, 6
    v_add_u32 v112, s67, v112
    s_nop 15
    s_nop 15
    s_nop 15
    v_mov_b32 v44, 0
    v_mov_b32 v45, 0
    buffer_atomic_or_x2 v[44:45], v13, s[16:19], s66 offen offset:64 sc0 sc1
    s_nop 15
    s_nop 15
    s_nop 15
Lp_41:
    v_mov_b32 v46, 0
    v_mov_b32 v47, 0
    buffer_atomic_or_x2 v[46:47], v13, s[16:19], s66 offen offset:64 sc0 sc1
    s_waitcnt vmcnt(2)
    v_cmp_gt_u32 vcc, 0x41000000, v43
    v_add_f64 v[110:111], v[42:43], v[40:41]
    s_cbranch_vccz Lok_42
    v_mov_b32 v42, 0
    v_mov_b32 v43, 0
    buffer_atomic_or_x2 v[42:43], v13, s[16:19], s66 offen offset:64 sc0 sc1
    s_waitcnt vmcnt(2)
    v_cmp_gt_u32 vcc, 0x41000000, v45
    v_add_f64 v[110:111], v[44:45], v[40:41]
    s_cbranch_vccz Lok_42
    v_mov_b32 v44, 0
    v_mov_b32 v45, 0
    buffer_atomic_or_x2 v[44:45], v13, s[16:19], s66 offen offset:64 sc0 sc1
    s_waitcnt vmcnt(2)
    v_cmp_gt_u32 vcc, 0x41000000, v47
    v_add_f64 v[110:111], v[46:47], v[40:41]
    s_cbranch_vccz Lok_42
    s_sub_u32 s69, s69, 1
    s_cbranch_scc0 Lp_41
    s_mov_b32 s69, 0
Lok_42:
    v_cvt_f32_f64 v109, v[110:111]
    s_nop 1
    v_add_f32_dpp v109, v109, v109 row_ror:8 row_mask:0xf bank_mask:0xf
    v_cvt_pk_bf16_f32 v109, v109, v109
    ds_write_b16 v112, v109 offset:10240
    s_waitcnt lgkmcnt(0)
Lb_40:
    s_barrier
    ds_read_b128 v[32:35], v113 offset:10240
    ds_read_b128 v[28:31], v113 offset:10304
    s_nop 0
    s_waitcnt lgkmcnt(1)
LS16_45:
    s_mov_b32 s64, 0x74000
    s_add_u32 s65, s79, 0x74000
    v_mfma_f32_16x16x32_bf16 v[72:75], v[32:35], a[128:131], 0
    v_mov_b32_dpp v36, v32 quad_perm:[0,1,2,3] row_mask:0xf bank_mask:0x3
    v_mov_b32_dpp v37, v33 quad_perm:[0,1,2,3] row_mask:0xf bank_mask:0x3
    v_mfma_f32_16x16x32_bf16 v[88:91], v[32:35], a[144:147], 0
    v_mov_b32_dpp v38, v34 quad_perm:[0,1,2,3] row_mask:0xf bank_mask:0x3
    v_mov_b32_dpp v39, v35 quad_perm:[0,1,2,3] row_mask:0xf bank_mask:0x3
    v_mfma_f32_16x16x32_bf16 v[76:79], v[32:35], a[132:135], 0
    v_mfma_f32_16x16x32_bf16 v[92:95], v[32:35], a[148:151], 0
    v_mfma_f32_16x16x32_bf16 v[120:123], v[32:35], v[36:39], 0
    v_mfma_f32_16x16x32_bf16 v[80:83], v[32:35], a[136:139], 0
    v_mfma_f32_16x16x32_bf16 v[96:99], v[32:35], a[152:155], 0
    v_mfma_f32_16x16x32_bf16 v[84:87], v[32:35], a[140:143], 0
    v_mfma_f32_16x16x32_bf16 v[100:103], v[32:35], a[156:159], 0
    s_nop 0
    s_waitcnt lgkmcnt(0)
    v_mfma_f32_16x16x32_bf16 v[72:75], v[28:31], a[160:163], v[72:75]
    v_mov_b32_dpp v36, v28 quad_perm:[0,1,2,3] row_mask:0xf bank_mask:0x3
    v_mov_b32_dpp v37, v29 quad_perm:[0,1,2,3] row_mask:0xf bank_mask:0x3
    v_mfma_f32_16x16x32_bf16 v[88:91], v[28:31], a[176:179], v[88:91]
    v_mov_b32_dpp v38, v30 quad_perm:[0,1,2,3] row_mask:0xf bank_mask:0x3
    v_mov_b32_dpp v39, v31 quad_perm:[0,1,2,3] row_mask:0xf bank_mask:0x3
    v_mfma_f32_16x16x32_bf16 v[76:79], v[28:31], a[164:167], v[76:79]
    v_mfma_f32_16x16x32_bf16 v[92:95], v[28:31], a[180:183], v[92:95]
    v_mfma_f32_16x16x32_bf16 v[120:123], v[28:31], v[36:39], v[120:123]
    v_mfma_f32_16x16x32_bf16 v[80:83], v[28:31], a[168:171], v[80:83]
    v_mfma_f32_16x16x32_bf16 v[96:99], v[28:31], a[184:187], v[96:99]
    v_mfma_f32_16x16x32_bf16 v[84:87], v[28:31], a[172:175], v[84:87]
    v_mfma_f32_16x16x32_bf16 v[100:103], v[28:31], a[188:191], v[100:103]
    s_mov_b64 exec, 0x101
    s_nop 2
    buffer_store_dword v120, v5, s[16:19], s64 offen
    s_mov_b32 exec_lo, -1
    v_mov_b32_dpp v72, v88 quad_perm:[0,1,2,3] row_mask:0x2 bank_mask:0xf
    v_mov_b32_dpp v73, v76 quad_perm:[0,1,2,3] row_mask:0x1 bank_mask:0xf
    v_mov_b32_dpp v73, v92 quad_perm:[0,1,2,3] row_mask:0x2 bank_mask:0xf
    v_mov_b32_dpp v74, v80 quad_perm:[0,1,2,3] row_mask:0x1 bank_mask:0xf
    v_mov_b32_dpp v74, v96 quad_perm:[0,1,2,3] row_mask:0x2 bank_mask:0xf
    v_mov_b32_dpp v75, v84 quad_perm:[0,1,2,3] row_mask:0x1 bank_mask:0xf
    v_mov_b32_dpp v75, v100 quad_perm:[0,1,2,3] row_mask:0x2 bank_mask:0xf
    buffer_store_dwordx4 v[72:75], v2, s[16:19], s64 offen
    s_mov_b64 exec, -1
    s_mov_b32 exec_lo, 0x00ff00ff
    s_mov_b32 exec_hi, 0x00ff00ff
    v_lshlrev_b32 v112, 16, v109
    v_cvt_f64_f32_e64 v[40:41], v112
    v_add_f64 v[40:41], v[40:41], -s[0:1]
    s_mov_b64 exec, -1
LS17_46:
    buffer_load_dwordx4 v[76:79], v4, s[16:19], s64 offen sc1
    buffer_load_dwordx4 v[72:75], v3, s[16:19], s64 offen sc1
    v_accvgpr_read_b32 v84, a244
    v_accvgpr_read_b32 v85, a245
    v_accvgpr_read_b32 v86, a246
    v_accvgpr_read_b32 v87, a247
    v_accvgpr_read_b32 v88, a248
    v_accvgpr_read_b32 v89, a249
    v_accvgpr_read_b32 v90, a250
    v_accvgpr_read_b32 v91, a251
    v_add_f32_dpp v84, v88, v84 quad_perm:[0,1,2,3] row_mask:0xf bank_mask:0xc
    v_add_f32_dpp v85, v89, v85 quad_perm:[0,1,2,3] row_mask:0xf bank_mask:0xc
    v_add_f32_dpp v86, v90, v86 quad_perm:[0,1,2,3] row_mask:0xf bank_mask:0xc
    v_add_f32_dpp v87, v91, v87 quad_perm:[0,1,2,3] row_mask:0xf bank_mask:0xc
    v_permlane32_swap_b32 v84, v85
    s_nop 0
    v_permlane32_swap_b32 v86, v87
    v_add_f32 v84, v84, v85
    v_add_f32 v86, v86, v87
    s_nop 1
    v_permlane16_swap_b32 v84, v86
    v_add_f32 v24, v84, v86
    s_nop 1
    v_add_f32_dpp v24, v24, v24 row_ror:8 row_mask:0xf bank_mask:0xf
    s_branch Lp_47w
Lp_47:
    buffer_load_dwordx4 v[76:79], v4, s[16:19], s64 offen sc1
    buffer_load_dwordx4 v[72:75], v3, s[16:19], s64 offen sc1
    s_sub_u32 s69, s69, 1
    s_cbranch_scc1 Lgive_49
Lp_47w:
    s_waitcnt vmcnt(1)
    v_pk_add_f32 v[80:81], v[76:77], v[78:79]
    s_nop 0
    s_nop 0
    v_add_f32_dpp v6, v80, v81 quad_perm:[0,1,2,3] row_mask:0xf bank_mask:0x3
    s_waitcnt vmcnt(0)
    v_add_f32_dpp v72, v76, v72 quad_perm:[0,1,2,3] row_mask:0xf bank_mask:0xc
    v_add_f32_dpp v73, v77, v73 quad_perm:[0,1,2,3] row_mask:0xf bank_mask:0xc
    v_add_f32_dpp v105, v6, v6 row_ror:2 row_mask:0xf bank_mask:0xf
    v_cmp_u_f32 vcc, v72, v6
    v_add_f32_dpp v74, v78, v74 quad_perm:[0,1,2,3] row_mask:0xf bank_mask:0xc
    v_add_f32_dpp v75, v79, v75 quad_perm:[0,1,2,3] row_mask:0xf bank_mask:0xc
    s_cbranch_vccnz Lp_47
    v_add_f32_dpp v105, v105, v105 row_ror:4 row_mask:0xf bank_mask:0xf
    v_permlane32_swap_b32 v72, v73
    s_nop 0
    v_add_f32_dpp v105, v105, v105 row_ror:8 row_mask:0xf bank_mask:0xf
    v_permlane32_swap_b32 v74, v75
    v_mul_f32 v105, 0x3acccccd, v105
    v_add_f32 v72, v72, v73
    s_nop 0
    v_mov_b32_dpp v106, v105 quad_perm:[0,0,2,2] row_mask:0xf bank_mask:0xf
    v_add_f32 v74, v74, v75
    v_mov_b32_dpp v107, v105 quad_perm:[1,1,3,3] row_mask:0xf bank_mask:0xf
    s_nop 0
    v_permlane16_swap_b32 v72, v74
    v_fma_f32 v107, -v106, v106, v107
    v_add_f32 v104, v72, v74
    v_max_f32 v107, 0, v107
    s_nop 0
    v_add_f32_dpp v104, v104, v104 row_ror:8 row_mask:0xf bank_mask:0xf
    v_add_f32 v107, 0x3727c5ac, v107
    v_rsq_f32 v107, v107
    v_fma_f32 v104, -v106, v24, v104
    v_mul_f32 v104, v104, v107
    v_cvt_pk_bf16_f32 v107, v104, v104
    v_cmp_u_f32 vcc, v104, v105
    s_cbranch_vccnz Lp_47
Lok_48:
    ds_write_b16 v16, v107
    s_waitcnt lgkmcnt(0)
    s_barrier
LS18_50:
    s_mov_b64 exec, s[80:81]
    ds_read_b128 v[48:51], v17
    s_mov_b64 exec, s[82:83]
    ds_read_b128 v[52:55], v17
    s_mov_b64 exec, s[84:85]
    ds_read_b128 v[56:59], v17
    s_mov_b64 exec, s[86:87]
    ds_read_b128 v[60:63], v17
    s_mov_b64 exec, -1
    s_waitcnt lgkmcnt(3)
    v_mfma_f32_16x16x32_bf16 v[72:75], a[0:3], v[48:51], 0
    v_mfma_f32_16x16x32_bf16 v[76:79], a[32:35], v[48:51], 0
    s_nop 0
    s_waitcnt lgkmcnt(2)
    v_mfma_f32_16x16x32_bf16 v[72:75], a[8:11], v[52:55], v[72:75]
    v_mfma_f32_16x16x32_bf16 v[76:79], a[40:43], v[52:55], v[76:79]
    s_waitcnt lgkmcnt(1)
    v_mfma_f32_16x16x32_bf16 v[72:75], a[16:19], v[56:59], v[72:75]
    v_mfma_f32_16x16x32_bf16 v[76:79], a[48:51], v[56:59], v[76:79]
    s_waitcnt lgkmcnt(0)
    v_mfma_f32_16x16x32_bf16 v[72:75], a[24:27], v[60:63], v[72:75]
    v_mfma_f32_16x16x32_bf16 v[76:79], a[56:59], v[60:63], v[76:79]
    v_mfma_f32_16x16x32_bf16 v[80:83], a[64:67], v[48:51], 0
    v_mfma_f32_16x16x32_bf16 v[84:87], a[96:99], v[48:51], 0
    v_mfma_f32_16x16x32_bf16 v[80:83], a[72:75], v[52:55], v[80:83]
    v_mfma_f32_16x16x32_bf16 v[84:87], a[104:107], v[52:55], v[84:87]
    v_mfma_f32_16x16x32_bf16 v[80:83], a[80:83], v[56:59], v[80:83]
    v_mfma_f32_16x16x32_bf16 v[84:87], a[112:115], v[56:59], v[84:87]
    v_mfma_f32_16x16x32_bf16 v[80:83], a[88:91], v[60:63], v[80:83]
    v_add_f32_dpp v104, v73, v72 row_ror:12 row_mask:0xf bank_mask:0x1
    v_add_f32_dpp v104, v74, v104 row_ror:8 row_mask:0xf bank_mask:0x1
    v_mfma_f32_16x16x32_bf16 v[84:87], a[120:123], v[60:63], v[84:87]
    v_add_f32_dpp v104, v75, v104 row_ror:4 row_mask:0xf bank_mask:0x1
    v_add_f32_dpp v104, v76, v77 row_ror:4 row_mask:0xf bank_mask:0x2
    v_mfma_f32_16x16x32_bf16 v[88:91], a[4:7], v[48:51], 0
    v_add_f32_dpp v104, v78, v104 row_ror:12 row_mask:0xf bank_mask:0x2
    v_add_f32_dpp v104, v79, v104 row_ror:8 row_mask:0xf bank_mask:0x2
    v_mfma_f32_16x16x32_bf16 v[92:95], a[36:39], v[48:51], 0
    v_add_f32_dpp v104, v80, v82 row_ror:8 row_mask:0xf bank_mask:0x4
    v_add_f32_dpp v104, v81, v104 row_ror:4 row_mask:0xf bank_mask:0x4
    v_mfma_f32_16x16x32_bf16 v[88:91], a[12:15], v[52:55], v[88:91]
    v_add_f32_dpp v104, v83, v104 row_ror:12 row_mask:0xf bank_mask:0x4
    v_add_f32_dpp v104, v84, v87 row_ror:12 row_mask:0xf bank_mask:0x8
    v_mfma_f32_16x16x32_bf16 v[92:95], a[44:47], v[52:55], v[92:95]
    v_add_f32_dpp v104, v85, v104 row_ror:8 row_mask:0xf bank_mask:0x8
    v_add_f32_dpp v104, v86, v104 row_ror:4 row_mask:0xf bank_mask:0x8
    v_mfma_f32_16x16x32_bf16 v[88:91], a[20:23], v[56:59], v[88:91]
    v_mfma_f32_16x16x32_bf16 v[92:95], a[52:55], v[56:59], v[92:95]
    v_mfma_f32_16x16x32_bf16 v[88:91], a[28:31], v[60:63], v[88:91]
    v_mfma_f32_16x16x32_bf16 v[92:95], a[60:63], v[60:63], v[92:95]
    v_mfma_f32_16x16x32_bf16 v[96:99], a[68:71], v[48:51], 0
    v_mfma_f32_16x16x32_bf16 v[100:103], a[100:103], v[48:51], 0
    v_mfma_f32_16x16x32_bf16 v[96:99], a[76:79], v[52:55], v[96:99]
    v_mfma_f32_16x16x32_bf16 v[100:103], a[108:111], v[52:55], v[100:103]
    v_mfma_f32_16x16x32_bf16 v[96:99], a[84:87], v[56:59], v[96:99]
    v_mfma_f32_16x16x32_bf16 v[100:103], a[116:119], v[56:59], v[100:103]
    v_mfma_f32_16x16x32_bf16 v[96:99], a[92:95], v[60:63], v[96:99]
    v_add_f32_dpp v105, v89, v88 row_ror:12 row_mask:0xf bank_mask:0x1
    v_add_f32_dpp v105, v90, v105 row_ror:8 row_mask:0xf bank_mask:0x1
    v_mfma_f32_16x16x32_bf16 v[100:103], a[124:127], v[60:63], v[100:103]
    v_add_f32_dpp v105, v91, v105 row_ror:4 row_mask:0xf bank_mask:0x1
    v_add_f32_dpp v105, v92, v93 row_ror:4 row_mask:0xf bank_mask:0x2
    v_add_f32_dpp v105, v94, v105 row_ror:12 row_mask:0xf bank_mask:0x2
    v_add_f32_dpp v105, v95, v105 row_ror:8 row_mask:0xf bank_mask:0x2
    s_nop 0
    v_add_f32_dpp v105, v96, v98 row_ror:8 row_mask:0xf bank_mask:0x4
    v_add_f32_dpp v105, v97, v105 row_ror:4 row_mask:0xf bank_mask:0x4
    v_add_f32_dpp v105, v99, v105 row_ror:12 row_mask:0xf bank_mask:0x4
    v_add_f32_dpp v105, v100, v103 row_ror:12 row_mask:0xf bank_mask:0x8
    v_add_f32_dpp v105, v101, v105 row_ror:8 row_mask:0xf bank_mask:0x8
    v_add_f32_dpp v105, v102, v105 row_ror:4 row_mask:0xf bank_mask:0x8
    v_max_f32 v106, v104, v105
    s_nop 1
    v_max_f32_dpp v106, v106, v106 row_ror:1 row_mask:0xf bank_mask:0xf
    s_nop 1
    v_max_f32_dpp v106, v106, v106 row_ror:2 row_mask:0xf bank_mask:0xf
    s_nop 1
    v_max_f32_dpp v106, v106, v106 row_ror:4 row_mask:0xf bank_mask:0xf
    s_nop 1
    v_max_f32_dpp v106, v106, v106 row_ror:8 row_mask:0xf bank_mask:0xf
    s_nop 1
    v_max_f32_dpp v106, v106, v106 row_bcast:15 row_mask:0xa bank_mask:0xf
    s_nop 1
    v_max_f32_dpp v106, v106, v106 row_bcast:31 row_mask:0xc bank_mask:0xf
    v_mul_f32 v106, v106, v27
    s_nop 0
    v_readlane_b32 s72, v106, 63
    s_nop 1
    v_fma_f32 v104, v104, v27, -s72
    v_fma_f32 v105, v105, v27, -s72
    v_exp_f32 v104, v104
    v_exp_f32 v105, v105
    s_nop 0
    v_cvt_pk_bf16_f32 v108, v104, v105
LS19_51:
    s_nop 1
    v_mov_b32_dpp v64, v108 row_newbcast:0 row_mask:0xf bank_mask:0x1
    v_mov_b32_dpp v65, v108 row_newbcast:0 row_mask:0xf bank_mask:0x2
    v_mov_b32_dpp v66, v108 row_newbcast:0 row_mask:0xf bank_mask:0x4
    v_mov_b32_dpp v67, v108 row_newbcast:0 row_mask:0xf bank_mask:0x8
    s_nop 1
    v_mfma_f32_16x16x32_bf16 v[72:75], v[64:67], v[126:129], 0
    v_mov_b32_dpp v68, v108 row_newbcast:1 row_mask:0xf bank_mask:0x1
    v_mov_b32_dpp v69, v108 row_newbcast:1 row_mask:0xf bank_mask:0x2
    v_mov_b32_dpp v70, v108 row_newbcast:1 row_mask:0xf bank_mask:0x4
    v_mfma_f32_16x16x32_bf16 v[76:79], v[64:67], v[130:133], 0
    v_mov_b32_dpp v71, v108 row_newbcast:1 row_mask:0xf bank_mask:0x8
    v_lshlrev_b32_e64 v107, 16, v108
    v_and_b32 v104, 0xffff0000, v108
    v_mfma_f32_16x16x32_bf16 v[72:75], v[68:71], v[134:137], v[72:75]
    v_mov_b32_dpp v64, v108 row_newbcast:2 row_mask:0xf bank_mask:0x1
    v_mov_b32_dpp v65, v108 row_newbcast:2 row_mask:0xf bank_mask:0x2
    v_mov_b32_dpp v66, v108 row_newbcast:2 row_mask:0xf bank_mask:0x4
    v_mfma_f32_16x16x32_bf16 v[76:79], v[68:71], v[138:141], v[76:79]
    v_mov_b32_dpp v67, v108 row_newbcast:2 row_mask:0xf bank_mask:0x8
    v_add_f32 v107, v107, v104
    s_nop 1
    v_add_f32_dpp v107, v107, v107 row_ror:1 row_mask:0xf bank_mask:0xf
    v_mfma_f32_16x16x32_bf16 v[72:75], v[64:67], v[142:145], v[72:75]
    v_mov_b32_dpp v68, v108 row_newbcast:3 row_mask:0xf bank_mask:0x1
    v_mov_b32_dpp v69, v108 row_newbcast:3 row_mask:0xf bank_mask:0x2
    v_mov_b32_dpp v70, v108 row_newbcast:3 row_mask:0xf bank_mask:0x4
    v_mfma_f32_16x16x32_bf16 v[76:79], v[64:67], v[146:149], v[76:79]
    v_mov_b32_dpp v71, v108 row_newbcast:3 row_mask:0xf bank_mask:0x8
    v_add_f32_dpp v107, v107, v107 row_ror:2 row_mask:0xf bank_mask:0xf
    s_nop 0
    v_mfma_f32_16x16x32_bf16 v[72:75], v[68:71], v[150:153], v[72:75]
    v_mov_b32_dpp v64, v108 row_newbcast:4 row_mask:0xf bank_mask:0x1
    v_mov_b32_dpp v65, v108 row_newbcast:4 row_mask:0xf bank_mask:0x2
    v_mov_b32_dpp v66, v108 row_newbcast:4 row_mask:0xf bank_mask:0x4
    v_mfma_f32_16x16x32_bf16 v[76:79], v[68:71], v[154:157], v[76:79]
    v_mov_b32_dpp v67, v108 row_newbcast:4 row_mask:0xf bank_mask:0x8
    v_add_f32_dpp v107, v107, v107 row_ror:4 row_mask:0xf bank_mask:0xf
    s_nop 0
    v_mfma_f32_16x16x32_bf16 v[72:75], v[64:67], v[158:161], v[72:75]
    v_mov_b32_dpp v68, v108 row_newbcast:5 row_mask:0xf bank_mask:0x1
    v_mov_b32_dpp v69, v108 row_newbcast:5 row_mask:0xf bank_mask:0x2
    v_mov_b32_dpp v70, v108 row_newbcast:5 row_mask:0xf bank_mask:0x4
    v_mfma_f32_16x16x32_bf16 v[76:79], v[64:67], v[162:165], v[76:79]
    v_mov_b32_dpp v71, v108 row_newbcast:5 row_mask:0xf bank_mask:0x8
    v_add_f32_dpp v107, v107, v107 row_ror:8 row_mask:0xf bank_mask:0xf
    s_nop 0
    v_mfma_f32_16x16x32_bf16 v[72:75], v[68:71], v[166:169], v[72:75]
    v_mov_b32_dpp v64, v108 row_newbcast:6 row_mask:0xf bank_mask:0x1
    v_mov_b32_dpp v65, v108 row_newbcast:6 row_mask:0xf bank_mask:0x2
    v_mov_b32_dpp v66, v108 row_newbcast:6 row_mask:0xf bank_mask:0x4
    v_mfma_f32_16x16x32_bf16 v[76:79], v[68:71], v[170:173], v[76:79]
    v_mov_b32_dpp v67, v108 row_newbcast:6 row_mask:0xf bank_mask:0x8
    v_add_f32_dpp v107, v107, v107 row_bcast:15 row_mask:0xa bank_mask:0xf
    s_nop 0
    v_mfma_f32_16x16x32_bf16 v[72:75], v[64:67], v[174:177], v[72:75]
    v_mov_b32_dpp v68, v108 row_newbcast:7 row_mask:0xf bank_mask:0x1
    v_mov_b32_dpp v69, v108 row_newbcast:7 row_mask:0xf bank_mask:0x2
    v_mov_b32_dpp v70, v108 row_newbcast:7 row_mask:0xf bank_mask:0x4
    v_mfma_f32_16x16x32_bf16 v[76:79], v[64:67], v[178:181], v[76:79]
    v_mov_b32_dpp v71, v108 row_newbcast:7 row_mask:0xf bank_mask:0x8
    v_add_f32_dpp v107, v107, v107 row_bcast:31 row_mask:0xc bank_mask:0xf
    s_nop 0
    v_mfma_f32_16x16x32_bf16 v[72:75], v[68:71], v[182:185], v[72:75]
    v_mov_b32_dpp v64, v108 row_newbcast:8 row_mask:0xf bank_mask:0x1
    v_mov_b32_dpp v65, v108 row_newbcast:8 row_mask:0xf bank_mask:0x2
    v_mov_b32_dpp v66, v108 row_newbcast:8 row_mask:0xf bank_mask:0x4
    v_mfma_f32_16x16x32_bf16 v[76:79], v[68:71], v[186:189], v[76:79]
    v_mov_b32_dpp v67, v108 row_newbcast:8 row_mask:0xf bank_mask:0x8
    ds_write_b64 v18, v[106:107]
    s_nop 0
    v_mfma_f32_16x16x32_bf16 v[72:75], v[64:67], v[190:193], v[72:75]
    v_mov_b32_dpp v68, v108 row_newbcast:9 row_mask:0xf bank_mask:0x1
    v_mov_b32_dpp v69, v108 row_newbcast:9 row_mask:0xf bank_mask:0x2
    v_mov_b32_dpp v70, v108 row_newbcast:9 row_mask:0xf bank_mask:0x4
    v_mfma_f32_16x16x32_bf16 v[76:79], v[64:67], v[194:197], v[76:79]
    v_mov_b32_dpp v71, v108 row_newbcast:9 row_mask:0xf bank_mask:0x8
    s_waitcnt lgkmcnt(0)
    s_barrier
    ds_read_b64 v[110:111], v19
    v_mfma_f32_16x16x32_bf16 v[72:75], v[68:71], v[198:201], v[72:75]
    v_mov_b32_dpp v64, v108 row_newbcast:10 row_mask:0xf bank_mask:0x1
    v_mov_b32_dpp v65, v108 row_newbcast:10 row_mask:0xf bank_mask:0x2
    v_mov_b32_dpp v66, v108 row_newbcast:10 row_mask:0xf bank_mask:0x4
    v_mfma_f32_16x16x32_bf16 v[76:79], v[68:71], v[202:205], v[76:79]
    v_mov_b32_dpp v67, v108 row_newbcast:10 row_mask:0xf bank_mask:0x8
    s_nop 0
    s_nop 0
    v_mfma_f32_16x16x32_bf16 v[72:75], v[64:67], v[206:209], v[72:75]
    v_mov_b32_dpp v68, v108 row_newbcast:11 row_mask:0xf bank_mask:0x1
    v_mov_b32_dpp v69, v108 row_newbcast:11 row_mask:0xf bank_mask:0x2
    v_mov_b32_dpp v70, v108 row_newbcast:11 row_mask:0xf bank_mask:0x4
    v_mfma_f32_16x16x32_bf16 v[76:79], v[64:67], v[210:213], v[76:79]
    v_mov_b32_dpp v71, v108 row_newbcast:11 row_mask:0xf bank_mask:0x8
    s_waitcnt lgkmcnt(0)
    s_nop 0
    v_mfma_f32_16x16x32_bf16 v[72:75], v[68:71], v[214:217], v[72:75]
    v_mov_b32_dpp v64, v108 row_newbcast:12 row_mask:0xf bank_mask:0x1
    v_mov_b32_dpp v65, v108 row_newbcast:12 row_mask:0xf bank_mask:0x2
    v_mov_b32_dpp v66, v108 row_newbcast:12 row_mask:0xf bank_mask:0x4
    v_mfma_f32_16x16x32_bf16 v[76:79], v[68:71], v[218:221], v[76:79]
    v_mov_b32_dpp v67, v108 row_newbcast:12 row_mask:0xf bank_mask:0x8
    v_max_f32_dpp v112, v110, v110 quad_perm:[1,0,3,2] row_mask:0xf bank_mask:0xf
    s_nop 0
    v_mfma_f32_16x16x32_bf16 v[72:75], v[64:67], v[222:225], v[72:75]
    v_mov_b32_dpp v68, v108 row_newbcast:13 row_mask:0xf bank_mask:0x1
    v_mov_b32_dpp v69, v108 row_newbcast:13 row_mask:0xf bank_mask:0x2
    v_mov_b32_dpp v70, v108 row_newbcast:13 row_mask:0xf bank_mask:0x4
    v_mfma_f32_16x16x32_bf16 v[76:79], v[64:67], v[226:229], v[76:79]
    v_mov_b32_dpp v71, v108 row_newbcast:13 row_mask:0xf bank_mask:0x8
    v_max_f32_dpp v112, v112, v112 quad_perm:[2,3,0,1] row_mask:0xf bank_mask:0xf
    v_sub_f32 v109, v110, v112
    v_mfma_f32_16x16x32_bf16 v[72:75], v[68:71], v[230:233], v[72:75]
    v_mov_b32_dpp v64, v108 row_newbcast:14 row_mask:0xf bank_mask:0x1
    v_mov_b32_dpp v65, v108 row_newbcast:14 row_mask:0xf bank_mask:0x2
    v_mov_b32_dpp v66, v108 row_newbcast:14 row_mask:0xf bank_mask:0x4
    v_mfma_f32_16x16x32_bf16 v[76:79], v[68:71], v[234:237], v[76:79]
    v_mov_b32_dpp v67, v108 row_newbcast:14 row_mask:0xf bank_mask:0x8
    v_exp_f32 v109, v109
    s_nop 0
    v_mfma_f32_16x16x32_bf16 v[72:75], v[64:67], v[238:241], v[72:75]
    v_mov_b32_dpp v68, v108 row_newbcast:15 row_mask:0xf bank_mask:0x1
    v_mov_b32_dpp v69, v108 row_newbcast:15 row_mask:0xf bank_mask:0x2
    v_mov_b32_dpp v70, v108 row_newbcast:15 row_mask:0xf bank_mask:0x4
    v_mfma_f32_16x16x32_bf16 v[76:79], v[64:67], v[242:245], v[76:79]
    v_mov_b32_dpp v71, v108 row_newbcast:15 row_mask:0xf bank_mask:0x8
    v_mul_f32 v113, v109, v111
    s_nop 0
    v_mfma_f32_16x16x32_bf16 v[72:75], v[68:71], v[246:249], v[72:75]
    v_mfma_f32_16x16x32_bf16 v[76:79], v[68:71], v[250:253], v[76:79]
    v_add_f32_dpp v113, v113, v113 quad_perm:[1,0,3,2] row_mask:0xf bank_mask:0xf
    s_nop 0
    s_nop 0
    v_add_f32_dpp v113, v113, v113 quad_perm:[2,3,0,1] row_mask:0xf bank_mask:0xf
    s_cmp_lg_u32 s7, 0
    s_cbranch_scc1 Lnos_52
    s_mov_b64 exec, 0x10001
    buffer_store_dwordx2 v[112:113], v1, s[16:19], s65 offen
    s_mov_b64 exec, -1
Lnos_52:
LS20_53:
    s_nop 0
    v_mul_f32_dpp v104, v109, v72 quad_perm:[0,0,0,0] row_mask:0xf bank_mask:0xf
    v_mul_f32_dpp v105, v109, v76 quad_perm:[0,0,0,0] row_mask:0xf bank_mask:0xf
    ds_write2_b32 v20, v104, v105 offset0:0 offset1:64
    s_cmp_lg_u32 s7, 0
    s_waitcnt lgkmcnt(0)
    s_barrier
    s_cbranch_scc1 Lsk_54
    ds_read2_b64 v[72:75], v21 offset0:0 offset1:64
    ds_read2_b64 v[76:79], v21 offset0:128 offset1:192
    s_waitcnt lgkmcnt(1)
    v_pk_add_f32 v[72:73], v[72:73], v[74:75]
    s_waitcnt lgkmcnt(0)
    v_pk_add_f32 v[76:77], v[76:77], v[78:79]
    v_pk_add_f32 v[72:73], v[72:73], v[76:77]
    v_cvt_pk_bf16_f32 v72, v72, v73
    buffer_store_dword v72, v8, s[16:19], s64 offen
Lsk_54:
LS21_55:
    v_and_b32 v113, 0x30, v0
    s_bitcmp0_b32 s7, 0
    s_cbranch_scc1 Lb_56
    s_nop 15
    s_nop 15
    s_nop 15
    s_nop 15
    s_nop 15
    s_nop 15
    s_nop 15
    s_nop 15
    s_nop 15
    s_nop 15
    s_nop 15
    s_nop 15
    s_nop 15
    s_nop 15
    s_nop 15
    s_nop 15
    s_nop 15
    s_nop 15
    s_nop 15
    v_mov_b32 v42, 0
    v_mov_b32 v43, 0
    buffer_atomic_or_x2 v[42:43], v13, s[16:19], s66 offen offset:128 sc0 sc1
    v_and_b32 v112, 7, v0
    v_lshl_add_u32 v112, v112, 1, v113
    s_and_b32 s67, s74, 1
    s_lshl_b32 s67, s67, 6
    v_add_u32 v112, s67, v112
    s_nop 15
    s_nop 15
    s_nop 15
    v_mov_b32 v44, 0
    v_mov_b32 v45, 0
    buffer_atomic_or_x2 v[44:45], v13, s[16:19], s66 offen offset:128 sc0 sc1
    s_nop 15
    s_nop 15
    s_nop 15
Lp_57:
    v_mov_b32 v46, 0
    v_mov_b32 v47, 0
    buffer_atomic_or_x2 v[46:47], v13, s[16:19], s66 offen offset:128 sc0 sc1
    s_waitcnt vmcnt(2)
    v_cmp_gt_u32 vcc, 0x41000000, v43
    v_add_f64 v[110:111], v[42:43], v[40:41]
    s_cbranch_vccz Lok_58
    v_mov_b32 v42, 0
    v_mov_b32_e64 v43, 0
    buffer_atomic_or_x2 v[42:43], v13, s[16:19], s66 offen offset:128 sc0 sc1
    s_waitcnt vmcnt(2)
    v_cmp_gt_u32 vcc, 0x41000000, v45
    v_add_f64 v[110:111], v[44:45], v[40:41]
    s_cbranch_vccz Lok_58
    v_mov_b32 v44, 0
    v_mov_b32 v45, 0
    buffer_atomic_or_x2 v[44:45], v13, s[16:19], s66 offen offset:128 sc0 sc1
    s_waitcnt vmcnt(2)
    v_cmp_gt_u32 vcc, 0x41000000, v47
    v_add_f64 v[110:111], v[46:47], v[40:41]
    s_cbranch_vccz Lok_58
    s_sub_u32 s69, s69, 1
    s_cbranch_scc0 Lp_57
    s_mov_b32 s69, 0
Lok_58:
    v_cvt_f32_f64 v109, v[110:111]
    s_nop 1
    v_add_f32_dpp v109, v109, v109 row_ror:8 row_mask:0xf bank_mask:0xf
    v_cvt_pk_bf16_f32 v109, v109, v109
    ds_write_b16 v112, v109 offset:10240
    s_waitcnt lgkmcnt(0)
Lb_56:
    s_barrier
    ds_read_b128 v[32:35], v113 offset:10240
    ds_read_b128 v[28:31], v113 offset:10304
    s_nop 0
    s_waitcnt lgkmcnt(1)
LS23_59:
    v_mfma_f32_16x16x32_bf16 v[72:75], v[32:35], a[192:195], 0
    v_mov_b32_dpp v36, v32 quad_perm:[0,1,2,3] row_mask:0xf bank_mask:0x3
    v_mov_b32_dpp v37, v33 quad_perm:[0,1,2,3] row_mask:0xf bank_mask:0x3
    v_mfma_f32_16x16x32_bf16 v[76:79], v[32:35], a[196:199], 0
    v_mov_b32_dpp v38, v34 quad_perm:[0,1,2,3] row_mask:0xf bank_mask:0x3
    v_mov_b32_dpp v39, v35 quad_perm:[0,1,2,3] row_mask:0xf bank_mask:0x3
    v_mfma_f32_16x16x32_bf16 v[80:83], v[32:35], a[200:203], 0
    v_mfma_f32_16x16x32_bf16 v[84:87], v[32:35], a[204:207], 0
    v_mfma_f32_16x16x32_bf16 v[120:123], v[32:35], v[36:39], 0
    s_nop 0
    s_waitcnt lgkmcnt(0)
    v_mfma_f32_16x16x32_bf16 v[72:75], v[28:31], a[208:211], v[72:75]
    v_mov_b32_dpp v36, v28 quad_perm:[0,1,2,3] row_mask:0xf bank_mask:0x3
    v_mov_b32_dpp v37, v29 quad_perm:[0,1,2,3] row_mask:0xf bank_mask:0x3
    v_mfma_f32_16x16x32_bf16 v[76:79], v[28:31], a[212:215], v[76:79]
    v_mov_b32_dpp v38, v30 quad_perm:[0,1,2,3] row_mask:0xf bank_mask:0x3
    v_mov_b32_dpp v39, v31 quad_perm:[0,1,2,3] row_mask:0xf bank_mask:0x3
    v_mfma_f32_16x16x32_bf16 v[80:83], v[28:31], a[216:219], v[80:83]
    v_mfma_f32_16x16x32_bf16 v[84:87], v[28:31], a[220:223], v[84:87]
    v_mfma_f32_16x16x32_bf16 v[120:123], v[28:31], v[36:39], v[120:123]
    s_mov_b64 exec, 0xffff
    s_nop 1
    v_mov_b32 v73, v76
    s_nop 1
    v_mov_b32 v74, v80
    v_mov_b32_e64 v75, v84
    buffer_store_dwordx4 v[72:75], v14, s[16:19], s64 offen
    s_mov_b64 exec, 0x101
    buffer_store_dword v120, v5, s[16:19], s64 offen offset:256
    s_mov_b64 exec, -1
    s_mov_b32 exec_lo, 0x00ff00ff
    s_mov_b32 exec_hi, 0x00ff00ff
    v_lshlrev_b32 v112, 16, v109
    v_accvgpr_read_b32 v113, a226
    v_lshlrev_b32 v113, 16, v113
    v_add_f32 v112, v112, v113
    v_cvt_f64_f32 v[40:41], v112
    v_add_f64 v[40:41], v[40:41], -s[0:1]
    s_mov_b64 exec, -1
LS24_60:
    s_mov_b32 s67, s3
    s_cmp_lg_u32 s67, 0
    s_cbranch_scc1 Lfin_61
    v_and_b32 v113, 0x30, v0
    s_bitcmp0_b32 s7, 0
    s_cbranch_scc1 Lb_62
    s_waitcnt vmcnt(0)
    v_mov_b32 v42, 0
    v_mov_b32 v43, 0
    buffer_atomic_or_x2 v[42:43], v13, s[16:19], s66 offen offset:192 sc0 sc1
    v_and_b32 v112, 7, v0
    v_lshl_add_u32 v112, v112, 1, v113
    s_lshl_b32 s67, s74, 6
    s_nop 15
    s_nop 15
    v_mov_b32 v44, 0
    v_mov_b32 v45, 0
    buffer_atomic_or_x2 v[44:45], v13, s[16:19], s66 offen offset:192 sc0 sc1
    s_nop 15
    s_nop 15
Lp_63:
    v_mov_b32 v46, 0
    v_mov_b32 v47, 0
    buffer_atomic_or_x2 v[46:47], v13, s[16:19], s66 offen offset:192 sc0 sc1
    s_waitcnt vmcnt(2)
    v_cmp_gt_u32 vcc, 0x41000000, v43
    v_add_f64 v[110:111], v[42:43], v[40:41]
    s_cbranch_vccz Lok_64
    v_mov_b32 v42, 0
    v_mov_b32 v43, 0
    buffer_atomic_or_x2 v[42:43], v13, s[16:19], s66 offen offset:192 sc0 sc1
    s_waitcnt vmcnt(2)
    v_cmp_gt_u32 vcc, 0x41000000, v45
    v_add_f64 v[110:111], v[44:45], v[40:41]
    s_cbranch_vccz Lok_64
    v_mov_b32 v44, 0
    v_mov_b32 v45, 0
    buffer_atomic_or_x2 v[44:45], v13, s[16:19], s66 offen offset:192 sc0 sc1
    s_waitcnt vmcnt(2)
    v_cmp_gt_u32 vcc, 0x41000000, v47
    v_add_f64 v[110:111], v[46:47], v[40:41]
    s_cbranch_vccz Lok_64
    s_sub_u32 s69, s69, 1
    s_cbranch_scc0 Lp_63
    s_mov_b32 s69, 0
Lok_64:
    v_cvt_f32_f64 v109, v[110:111]
    s_nop 1
    v_add_f32_dpp v109, v109, v109 row_ror:8 row_mask:0xf bank_mask:0xf
    v_cvt_pk_bf16_f32 v109, v109, v109
    s_mov_b32 exec_lo, 0x00ff00ff
    s_mov_b32 exec_hi, 0x00ff00ff
    buffer_store_short v109, v112, s[48:51], s67 offen
    s_mov_b64 exec, -1
Lb_62:
Lfin_61:
    s_endpgm
Lretry_10:
    s_cmp_eq_u32 s69, 0
    s_cbranch_scc1 Lfok_8
    s_sub_u32 s69, s69, 1
    s_branch Lfp_7
Lfp_7:
    buffer_load_dword v114, v118, s[52:55], s77 offen sc1
    s_waitcnt vmcnt(0)
    s_branch Lfc_9
Lqp_13:
    buffer_load_dwordx4 v[76:79], v4, s[16:19], 0 offen sc1
    buffer_load_dwordx4 v[72:75], v3, s[16:19], 0 offen sc1
    s_waitcnt vmcnt(0)
    s_branch Lq_12
Lretry_15:
    s_cmp_eq_u32 s69, 0
    s_cbranch_scc1 Lok_14
    s_sub_u32 s69, s69, 1
    s_branch Lqp_13
Lretry_28:
    s_cmp_eq_u32 s69, 0
    s_cbranch_scc1 Lfok_26
    s_sub_u32 s69, s69, 1
    s_branch Lfp_25
Lfp_25:
    buffer_load_dword v114, v119, s[52:55], 0 offen sc1
    s_waitcnt vmcnt(0)
    s_branch Lfc_27
Lgive_30:
    s_mov_b32 s69, 0
    s_waitcnt vmcnt(0)
    s_branch Lok_31
Lbw_44:
    s_waitcnt vmcnt(0)
    s_branch Lb_40
Lgive_49:
    s_mov_b32 s69, 0
    s_waitcnt vmcnt(0)
    s_branch Lok_48
    s_nop 0
    s_nop 0
    s_nop 0
    s_nop 0
    s_nop 0
    s_nop 0
    s_nop 0
    s_nop 0
    s_nop 0
    s_nop 0
    s_nop 0
    s_nop 0
    s_nop 0
    s_nop 0
    s_nop 0
    s_nop 0
    s_nop 0
    s_nop 0
    s_nop 0
    s_nop 0
    s_nop 0
    s_nop 0
    s_nop 0
    s_nop 0
    s_nop 0
    s_nop 0
    s_nop 0
    s_nop 0
    s_nop 0
    s_nop 0
    s_nop 0
    s_nop 0
    s_nop 0
    s_nop 0
    s_nop 0
    s_nop 0
L_roleB:
    s_mov_b32 s10, 0x2000000
    s_mov_b32 s11, 0x00020000
    s_mov_b32 s14, 0x2000000
    s_mov_b32 s15, 0x00020000
    s_mov_b32 s18, 0x10000000
    s_mov_b32 s19, 0x00020000
    s_mov_b32 s34, 0x21c000
    s_mov_b32 s35, 0x00020000
    s_mov_b32 s38, 0xd80
    s_mov_b32 s39, 0x00020000
    s_mov_b32 s42, 0x21c000
    s_mov_b32 s43, 0x00020000
    s_mov_b32 s46, 0x500
    s_mov_b32 s47, 0x00020000
    s_mov_b32 s50, 0x500
    s_mov_b32 s51, 0x00020000
    s_mov_b32 s54, 0x100
    s_mov_b32 s55, 0x00020000
    v_mov_b32 v100, -1
    v_mov_b32 v101, -1
    v_mov_b32 v102, -1
    v_mov_b32 v103, -1
    s_mul_i32 s76, s3, 0xc000
    s_lshl_b32 s68, s5, 0
    s_xor_b32 s68, s68, s75
    s_lshl_b32 s56, s68, 20
    s_lshl_b32 s68, s6, 17
    s_add_u32 s56, s56, s68
    s_lshl_b32 s68, s6, 14
    s_add_u32 s56, s56, s68
    s_lshl_b32 s68, s7, 12
    s_add_u32 s56, s56, s68
    s_xor_b32 s57, s56, 0x80000
    s_xor_b32 s58, s56, 0x40000
    s_xor_b32 s59, s56, 0xc0000
    s_xor_b32 s60, s56, 0x20000
    s_xor_b32 s61, s56, 0xa0000
    s_xor_b32 s62, s56, 0x60000
    s_xor_b32 s63, s56, 0xe0000
    v_bfe_u32 v121, v0, 2, 2
    v_lshlrev_b32 v124, 8, v121
    v_lshl_add_u32 v124, v115, 6, v124
    v_and_b32 v121, 3, v0
    v_lshl_add_u32 v124, v121, 4, v124
    v_and_b32 v120, 1, v115
    v_lshrrev_b32_e64 v123, 1, v115
    v_lshl_add_u32 v123, v120, 1, v123
    s_mov_b32 s70, 0x05040100
    s_mov_b32 s71, 0x07060302
    s_sub_u32 s67, s4, 20
    s_lshl_b32 s67, s67, 2
    s_add_u32 s77, s67, s7
    s_lshl_b32 s67, s77, 10
    s_add_u32 s78, s67, s76
    s_add_u32 s78, s78, 0x6000
    s_mul_i32 s68, s3, 10240
    s_add_u32 s67, s67, s68
    s_add_u32 s67, s67, 0x5a000
    s_cmp_lt_u32 s77, 24
    s_cselect_b32 s78, s78, s67
    s_cselect_b32 s67, -1, 0
    s_cselect_b32 s68, -1, 0x39b80000
    v_mov_b32 v100, s67
    v_mov_b32 v101, s68
    v_mov_b32 v102, s67
    v_mov_b32 v103, s68
    s_cmp_lt_u32 s77, 34
    s_cselect_b32 s78, s78, 0x80000000
    v_add_u32 v120, s78, v1
    s_cmp_lt_u32 s4, 20
    s_cbranch_scc1 L_nclr
    buffer_store_dwordx4 v[100:103], v120, s[16:19], 0 offen sc1
L_nclr:
    s_mov_b64 s[8:9], s[82:83]
    s_mov_b64 s[12:13], s[84:85]
    s_getreg_b32 s75, hwreg(HW_REG_XCC_ID)
    s_and_b32 s75, s75, 15
    s_or_b32 s75, s75, 0x80
    s_mov_b64 s[32:33], s[92:93]
    s_mov_b64 s[36:37], s[94:95]
    s_cmp_gt_u32 s88, 64
    s_cselect_b32 s67, 4, 0
    s_xor_b32 s67, s67, s75
    s_lshl_b32 s67, s67, 4
    s_cmp_lt_u32 s4, 16
    s_cselect_b32 s68, 0x40, 0
    s_and_b32 s67, s67, s68
    s_or_b32 s75, s75, s67
    s_load_dwordx2 s[52:53], s[0:1], 88
    s_load_dwordx2 s[44:45], s[0:1], 72
    s_load_dwordx2 s[40:41], s[0:1], 64
    s_load_dwordx2 s[48:49], s[0:1], 80
    s_mov_b32 s69, 100000
    s_mov_b32 s80, 0x11111111
    s_mov_b32 s81, 0x11111111
    s_mov_b32 s82, 0x22222222
    s_mov_b32 s83, 0x22222222
    s_mov_b32 s84, 0x44444444
    s_mov_b32 s85, 0x44444444
    s_mov_b32 s86, 0x88888888
    s_mov_b32 s87, 0x88888888
    s_mov_b32 s88, 0x01010101
    s_mov_b32 s89, 0x01010101
    s_lshl_b32 s67, s5, 3
    s_add_u32 s67, s67, s6
    s_lshl_b32 s68, s67, 8
    s_add_u32 s68, s68, s76
    s_add_u32 s68, s68, 0x6000
    s_lshl_b32 s68, s5, 11
    s_lshl_b32 s77, s6, 4
    s_add_u32 s68, s68, s77
    s_add_u32 s68, s68, s76
    s_add_u32 s68, s68, 0x6000
    v_lshrrev_b32 v120, 2, v0
    v_lshlrev_b32 v8, 7, v120
    v_and_b32 v120, 3, v0
    v_lshl_add_u32 v8, v120, 2, v8
    v_add_u32 v8, s68, v8
    s_lshl_b32 s79, s5, 9
    s_lshl_b32 s68, s6, 3
    s_add_u32 s79, s79, s68
    s_add_u32 s79, s79, s76
    s_add_u32 s79, s79, 0xb800
    s_mul_i32 s67, s5, 6144
    s_mul_i32 s68, s7, 1536
    s_add_u32 s67, s67, s68
    s_add_u32 s67, s67, s76
    v_add_u32 v3, s67, v1
    v_lshlrev_b32 v120, 7, v115
    v_sub_u32 v4, v3, v120
    v_add_u32 v4, 896, v4
    v_mov_b32 v121, 0x80000000
    v_and_b32 v120, 1, v114
    v_mul_u32_u24 v120, 48, v120
    v_lshrrev_b32 v122, 1, v114
    v_lshl_add_u32 v120, v122, 4, v120
    s_lshl_b32 s67, s7, 9
    s_add_u32 s67, s67, s76
    s_add_u32 s67, s67, 0xb000
    v_add_u32 v120, s67, v120
    v_cmp_gt_u32 vcc, 6, v114
    s_nop 1
    v_cndmask_b32 v120, v121, v120, vcc
    v_cmp_gt_u32 vcc, 8, v114
    s_nop 1
    v_cndmask_b32 v4, v4, v120, vcc
    v_mov_b32 v6, 0
    v_and_b32 v120, 7, v0
    v_lshl_add_u32 v120, v120, 2, v123
    s_lshl_b32 s67, s7, 5
    v_add_u32 v120, s67, v120
    v_lshlrev_b32 v16, 1, v120
    v_lshrrev_b32 v120, 2, v0
    v_lshlrev_b32 v17, 4, v120
    v_lshlrev_b32_e64 v18, 3, v0
    v_add_u32 v18, 512, v18
    s_lshl_b32 s67, s7, 3
    s_add_u32 s67, s67, 256
    v_writelane_b32 v18, s67, 63
    v_add_u32 v120, s7, v0
    v_and_b32 v120, 3, v120
    v_lshlrev_b32 v120, 3, v120
    v_add_u32 v19, 256, v120
    s_lshl_b32 s67, s7, 9
    s_add_u32 s67, s67, 1024
    v_lshlrev_b32 v20, 2, v0
    v_add_u32 v20, s67, v20
    v_lshlrev_b32_e64 v21, 3, v0
    v_add_u32 v21, 1024, v21
    v_mov_b32 v27, 0x3e0293ee
    v_mov_b32 v48, 0
    v_mov_b32 v49, 0
    v_mov_b32 v50, 0
    v_mov_b32 v51, 0
    v_mov_b32 v52, 0
    v_mov_b32 v53, 0
    v_mov_b32 v54, 0
    v_mov_b32 v55, 0
    v_mov_b32 v56, 0
    v_mov_b32 v57, 0
    v_mov_b32 v58, 0
    v_mov_b32 v59, 0
    v_mov_b32 v60, 0
    v_mov_b32 v61, 0
    v_mov_b32 v62, 0
    v_mov_b32 v63, 0
    v_mov_b32 v64, 0
    v_mov_b32 v65, 0
    v_mov_b32 v66, 0
    v_mov_b32 v67, 0
    v_mov_b32 v68, 0
    v_mov_b32 v69, 0
    v_mov_b32 v70, 0
    v_mov_b32 v71, 0
    v_lshlrev_b32 v119, 2, v0
    v_and_b32 v118, 28, v119
    buffer_load_dwordx4 v[216:219], v117, s[28:31], s65 offen nt
    s_add_u32 s65, s65, 10240
    s_waitcnt vmcnt(5)
    s_and_b32 s64, s74, 1
    s_lshr_b32 s66, s74, 1
    v_and_b32 v120, 1, v115
    v_lshlrev_b32 v12, 11, v120
    v_and_b32_e64 v120, 7, v0
    v_lshl_add_u32 v12, v120, 4, v12
    s_lshl_b32 s67, s66, 12
    s_lshl_b32 s68, s3, 8
    s_add_u32 s67, s67, s68
    s_lshl_b32 s68, s64, 7
    s_add_u32 s67, s67, s68
    s_add_u32 s67, s67, 0x60000
    v_add_u32 v12, s67, v12
    v_lshrrev_b32 v12, 5, v0
    v_lshlrev_b32 v12, 11, v12
    v_bfe_u32 v121, v0, 3, 2
    v_lshl_add_u32 v12, v121, 8, v12
    v_lshl_add_u32 v12, v120, 3, v12
    s_lshl_b32 s67, s66, 12
    s_lshl_b32 s68, s64, 10
    s_add_u32 s67, s67, s68
    s_add_u32 s67, s67, 0x60000
    s_lshr_b32 s68, s66, 1
    s_lshl_b32 s68, s68, 13
    s_add_u32 s67, s67, s68
    v_add_u32 v12, s67, v12
    s_lshr_b32 s77, s7, 1
    s_lshl_b32 s67, s64, 1
    s_add_u32 s77, s77, s67
    v_lshlrev_b32 v9, 4, v120
    v_lshrrev_b32 v122, 3, v114
    v_lshl_add_u32 v9, v122, 9, v9
    v_lshl_add_u32 v9, v115, 7, v9
    s_lshl_b32 s67, s77, 11
    s_and_b32 s68, s7, 1
    s_lshl_b32 s68, s68, 10
    s_add_u32 s67, s67, s68
    s_add_u32 s67, s67, s76
    s_add_u32 s67, s67, 0x6000
    v_add_u32 v9, s67, v9
    v_lshl_add_u32 v121, v115, 2, v114
    v_and_b32 v121, 7, v121
    v_lshlrev_b32 v121, 3, v121
    s_lshl_b32 s67, s77, 9
    s_and_b32 s68, s7, 1
    s_lshl_b32 s68, s68, 8
    s_add_u32 s67, s67, s68
    v_lshl_add_u32 v121, v122, 31, v121
    s_add_u32 s67, s67, s76
    s_add_u32 s67, s67, 0xb800
    v_add_u32 v11, s67, v121
    s_lshl_b32 s67, s64, 2
    s_add_u32 s67, s67, s7
    s_mul_i32 s67, s67, 1536
    s_add_u32 s67, s67, s76
    s_add_u32 s67, s67, 0x8000
    v_add_u32 v15, s67, v1
    s_cmp_eq_u32 s7, 3
    s_cselect_b32 s77, 6, 7
    v_mov_b32 v121, 0x80000000
    v_cmp_gt_u32 vcc, s77, v120
    s_nop 1
    v_cndmask_b32 v15, v121, v15, vcc
    v_lshlrev_b32 v104, 7, v115
    v_sub_u32 v7, v15, v104
    v_add_u32 v7, 896, v7
    v_add_u32 v104, 256, v4
    v_cmp_gt_u32 vcc, 8, v114
    s_nop 1
    v_cndmask_b32 v7, v7, v104, vcc
    v_and_b32 v104, 1, v0
    v_lshlrev_b32 v104, 4, v104
    v_mov_b32 v121, 0xffff
    v_lshlrev_b32 v121, v104, v121
    v_cmp_gt_u32 vcc, s77, v114
    s_nop 1
    v_cndmask_b32 v121, 0, v121, vcc
    v_bfe_u32 v104, v0, 1, 2
    v_cmp_eq_u32 vcc, 0, v104
    s_nop 1
    v_cndmask_b32 v28, 0, v121, vcc
    v_cmp_eq_u32 vcc, 1, v104
    s_nop 1
    v_cndmask_b32 v29, 0, v121, vcc
    v_cmp_eq_u32 vcc, 2, v104
    s_nop 1
    v_cndmask_b32 v30, 0, v121, vcc
    v_cmp_eq_u32 vcc, 3, v104
    s_nop 1
    v_cndmask_b32 v31, 0, v121, vcc
    s_lshl_b32 s67, s7, 9
    s_add_u32 s67, s67, 3072
    v_and_b32 v104, 1, v115
    v_lshlrev_b32 v23, 8, v122
    v_lshl_add_u32 v23, v120, 4, v23
    v_lshl_add_u32 v23, v104, 7, v23
    v_add_u32 v23, 3072, v23
    v_lshlrev_b32 v23, 2, v0
    v_add_u32 v23, 3072, v23
    v_lshlrev_b32 v22, 8, v122
    v_lshl_add_u32 v22, v120, 5, v22
    v_lshl_add_u32 v22, v104, 4, v22
    v_add_u32 v22, s67, v22
    v_add_u32 v121, 7168, v1
    v_lshrrev_b32 v104, 1, v115
    v_cmp_eq_u32 vcc, v122, v104
    s_nop 1
    v_cndmask_b32 v22, v121, v22, vcc
    v_add_u32_e64 v10, s67, v1
    v_cmp_gt_u32 vcc, 32, v0
    s_nop 1
    v_cndmask_b32 v10, v121, v10, vcc
    v_lshl_add_u32 v120, v120, 2, v123
    v_lshlrev_b32 v26, 1, v120
    v_mul_u32_u24 v24, 1280, v123
    v_lshl_add_u32 v24, v114, 3, v24
    buffer_load_dwordx4 v[220:223], v117, s[28:31], s65 offen nt
    s_waitcnt vmcnt(5)
    buffer_load_dwordx4 a[0:3], v124, s[8:11], s56 offen offset:0 nt
    s_waitcnt vmcnt(5)
    s_lshl_b32 s67, s3, 5
    s_add_u32 s67, s67, s4
    s_lshl_b32 s68, s7, 8
    s_add_u32 s67, s67, s68
    v_mov_b32 v120, s75
    v_mov_b32 v121, s67
    s_waitcnt vmcnt(3)
    s_waitcnt lgkmcnt(0)
    s_mov_b32 s0, 0
    s_mov_b32 s1, 0x41b80000
    s_barrier
    s_mov_b64 exec, 1
    buffer_store_byte v120, v121, s[52:55], 0 offen sc1
    s_mov_b64 exec, -1
LS1_65:
    buffer_load_dwordx4 a[4:7], v124, s[8:11], s56 offen offset:1024 nt
    s_waitcnt vmcnt(5)
    buffer_load_dwordx4 a[8:11], v124, s[8:11], s56 offen offset:2048 nt
    s_waitcnt vmcnt(5)
    buffer_load_dwordx4 a[12:15], v124, s[8:11], s56 offen offset:3072 nt
    s_waitcnt vmcnt(5)
    buffer_load_dwordx4 a[16:19], v124, s[8:11], s57 offen offset:0 nt
    s_waitcnt vmcnt(5)
    buffer_load_dwordx4 a[20:23], v124, s[8:11], s57 offen offset:1024 nt
    s_waitcnt vmcnt(5)
    buffer_load_dwordx4 a[24:27], v124, s[8:11], s57 offen offset:2048 nt
    s_nop 0
    s_waitcnt vmcnt(5)
    buffer_load_dwordx4 a[28:31], v124, s[8:11], s57 offen offset:3072 nt
    s_waitcnt vmcnt(5)
    buffer_load_dwordx4 a[32:35], v124, s[8:11], s58 offen offset:0 nt
    s_waitcnt vmcnt(5)
    buffer_load_dwordx4 a[36:39], v124, s[8:11], s58 offen offset:1024 nt
    s_waitcnt vmcnt(5)
    buffer_load_dwordx4 a[40:43], v124, s[8:11], s58 offen offset:2048 nt
    s_waitcnt vmcnt(5)
    buffer_load_dwordx4 a[44:47], v124, s[8:11], s58 offen offset:3072 nt
    s_nop 0
    s_waitcnt vmcnt(5)
    buffer_load_dwordx4 a[48:51], v124, s[8:11], s59 offen offset:0 nt
    s_waitcnt vmcnt(5)
    buffer_load_dwordx4 a[52:55], v124, s[8:11], s59 offen offset:1024 nt
    s_waitcnt vmcnt(5)
    buffer_load_dwordx4 a[56:59], v124, s[8:11], s59 offen offset:2048 nt
    s_waitcnt vmcnt(5)
    buffer_load_dwordx4 a[60:63], v124, s[8:11], s59 offen offset:3072 nt
    s_waitcnt vmcnt(5)
    buffer_load_dwordx4 a[64:67], v124, s[8:11], s60 offen offset:0 nt
    s_nop 0
    s_waitcnt vmcnt(5)
    buffer_load_dwordx4 a[68:71], v124, s[8:11], s60 offen offset:1024 nt
    s_waitcnt vmcnt(5)
    buffer_load_dwordx4 a[72:75], v124, s[8:11], s60 offen offset:2048 nt
    s_waitcnt vmcnt(5)
    buffer_load_dwordx4 a[76:79], v124, s[8:11], s60 offen offset:3072 nt
    s_waitcnt vmcnt(5)
    buffer_load_dwordx4 a[80:83], v124, s[8:11], s61 offen offset:0 nt
    s_waitcnt vmcnt(5)
    buffer_load_dwordx4 a[84:87], v124, s[8:11], s61 offen offset:1024 nt
    s_nop 0
    s_waitcnt vmcnt(5)
    buffer_load_dwordx4 a[88:91], v124, s[8:11], s61 offen offset:2048 nt
    s_waitcnt vmcnt(5)
    buffer_load_dwordx4 a[92:95], v124, s[8:11], s61 offen offset:3072 nt
    s_waitcnt vmcnt(5)
LS3_66:
    s_lshl_b32 s77, s3, 5
    buffer_load_dword v114, v118, s[52:55], s77 offen sc1
    buffer_load_dwordx4 a[96:99], v124, s[8:11], s62 offen offset:0 nt
    s_waitcnt vmcnt(5)
    buffer_load_dwordx4 a[100:103], v124, s[8:11], s62 offen offset:1024 nt
    s_waitcnt vmcnt(5)
    s_waitcnt vmcnt(28)
    v_perm_b32 v104, v196, v192, s70
    v_accvgpr_write_b32 a160, v104
    v_perm_b32 v105, v204, v200, s70
    v_accvgpr_write_b32 a161, v105
    v_perm_b32 v104, v212, v208, s70
    v_accvgpr_write_b32 a162, v104
    v_perm_b32 v105, v220, v216, s70
    v_accvgpr_write_b32 a163, v105
    v_perm_b32 v104, v196, v192, s71
    v_accvgpr_write_b32 a164, v104
    v_perm_b32 v105, v204, v200, s71
    v_accvgpr_write_b32 a165, v105
    v_perm_b32 v104, v212, v208, s71
    v_accvgpr_write_b32 a166, v104
    v_perm_b32 v105, v220, v216, s71
    v_accvgpr_write_b32 a167, v105
    v_perm_b32 v104, v197, v193, s70
    v_accvgpr_write_b32 a168, v104
    v_perm_b32 v105, v205, v201, s70
    v_accvgpr_write_b32 a169, v105
    v_perm_b32 v104, v213, v209, s70
    v_accvgpr_write_b32 a170, v104
    v_perm_b32 v105, v221, v217, s70
    v_accvgpr_write_b32 a171, v105
    v_perm_b32 v104, v197, v193, s71
    v_accvgpr_write_b32 a172, v104
    v_perm_b32 v105, v205, v201, s71
    v_accvgpr_write_b32 a173, v105
    v_perm_b32 v104, v213, v209, s71
    v_accvgpr_write_b32 a174, v104
    v_perm_b32 v105, v221, v217, s71
    v_accvgpr_write_b32 a175, v105
    v_perm_b32 v104, v198, v194, s70
    v_accvgpr_write_b32 a176, v104
    v_perm_b32 v105, v206, v202, s70
    v_accvgpr_write_b32 a177, v105
    v_perm_b32 v104, v214, v210, s70
    v_accvgpr_write_b32 a178, v104
    v_perm_b32 v105, v222, v218, s70
    v_accvgpr_write_b32 a179, v105
    v_perm_b32 v104, v198, v194, s71
    v_accvgpr_write_b32 a180, v104
    v_perm_b32 v105, v206, v202, s71
    v_accvgpr_write_b32 a181, v105
    v_perm_b32 v104, v214, v210, s71
    v_accvgpr_write_b32 a182, v104
    v_perm_b32 v105, v222, v218, s71
    v_accvgpr_write_b32 a183, v105
    v_perm_b32 v104, v199, v195, s70
    v_accvgpr_write_b32 a184, v104
    v_perm_b32 v105, v207, v203, s70
    v_accvgpr_write_b32 a185, v105
    v_perm_b32 v104, v215, v211, s70
    v_accvgpr_write_b32 a186, v104
    v_perm_b32 v105, v223, v219, s70
    v_accvgpr_write_b32 a187, v105
    v_perm_b32 v104, v199, v195, s71
    v_accvgpr_write_b32 a188, v104
    v_perm_b32 v105, v207, v203, s71
    v_accvgpr_write_b32 a189, v105
    v_perm_b32 v104, v215, v211, s71
    v_accvgpr_write_b32 a190, v104
    v_perm_b32 v105, v223, v219, s71
    v_accvgpr_write_b32 a191, v105
    buffer_load_dwordx4 a[104:107], v124, s[8:11], s62 offen offset:2048 nt
    s_waitcnt vmcnt(5)
    buffer_load_dwordx4 a[108:111], v124, s[8:11], s62 offen offset:3072 nt
    s_waitcnt vmcnt(5)
    s_and_b32 s75, s75, 0x8f
    s_mul_i32 s75, s75, 0x01010101
    s_waitcnt vmcnt(4)
Lfc_69:
    v_and_b32 v120, 0x80808080, v114
    v_cmp_ne_u32 vcc, 0x80808080, v120
    s_cbranch_vccnz Lretry_70
Lfok_68:
    v_and_b32 v114, 0x8f8f8f8f, v114
    v_cmp_ne_u32 vcc, s75, v114
    s_nop 0
    s_or_b32 s78, vcc_lo, vcc_hi
    buffer_load_dwordx4 v[76:79], v4, s[16:19], 0 offen sc1
    buffer_load_dwordx4 v[72:75], v3, s[16:19], 0 offen sc1
LS4_71:
    buffer_load_dwordx4 a[112:115], v124, s[8:11], s63 offen offset:0 nt
    s_waitcnt vmcnt(7)
    buffer_load_dwordx4 a[116:119], v124, s[8:11], s63 offen offset:1024 nt
    s_nop 0
    s_waitcnt vmcnt(7)
    buffer_load_dwordx4 a[120:123], v124, s[8:11], s63 offen offset:2048 nt
    s_waitcnt vmcnt(7)
    s_waitcnt vmcnt(3)
Lq_72:
    v_add_f32_dpp v72, v76, v72 quad_perm:[0,1,2,3] row_mask:0xf bank_mask:0xc
    v_add_f32_dpp v73, v77, v73 quad_perm:[0,1,2,3] row_mask:0xf bank_mask:0xc
    v_add_f32_dpp v74, v78, v74 quad_perm:[0,1,2,3] row_mask:0xf bank_mask:0xc
    v_add_f32_dpp v75, v79, v75 quad_perm:[0,1,2,3] row_mask:0xf bank_mask:0xc
    v_permlane32_swap_b32 v72, v73
    s_nop 0
    v_permlane32_swap_b32 v74, v75
    v_add_f32 v72, v72, v73
    v_add_f32 v74, v74, v75
    s_nop 1
    v_permlane16_swap_b32 v72, v74
    v_add_f32_e64 v104, v72, v74
    s_nop 1
    v_add_f32_dpp v104, v104, v104 row_ror:8 row_mask:0xf bank_mask:0xf
    buffer_load_dwordx4 a[124:127], v124, s[8:11], s63 offen offset:3072 nt
    buffer_load_dwordx4 v[128:131], v1, s[12:15], s56 offen offset:0 nt
    v_cvt_pk_bf16_f32 v107, v104, v104
    v_cmp_u_f32 vcc, v104, v104
    s_cbranch_vccnz Lretry_75
Lok_74:
    ds_write_b16 v16, v107
    s_waitcnt lgkmcnt(0)
    s_barrier
LS5_76:
    buffer_load_dwordx4 v[132:135], v1, s[12:15], s56 offen offset:1024 nt
    s_waitcnt vmcnt(5)
    buffer_load_dwordx4 v[136:139], v1, s[12:15], s56 offen offset:2048 nt
    s_waitcnt vmcnt(5)
    buffer_load_dwordx4 v[140:143], v1, s[12:15], s56 offen offset:3072 nt
    s_waitcnt vmcnt(5)
    buffer_load_dwordx4 v[144:147], v1, s[12:15], s57 offen offset:0 nt
    s_waitcnt vmcnt(5)
    buffer_load_dwordx4 v[148:151], v1, s[12:15], s57 offen offset:1024 nt
    s_waitcnt vmcnt(5)
    buffer_load_dwordx4 v[152:155], v1, s[12:15], s57 offen offset:2048 nt
    s_waitcnt vmcnt(5)
    buffer_load_dwordx4 v[156:159], v1, s[12:15], s57 offen offset:3072 nt
    s_waitcnt vmcnt(5)
    s_waitcnt vmcnt(8)
    s_mov_b64 exec, s[80:81]
    ds_read_b128 v[48:51], v17
    s_mov_b64 exec, s[82:83]
    ds_read_b128 v[52:55], v17
    s_mov_b64 exec, s[84:85]
    ds_read_b128 v[56:59], v17
    s_mov_b64 exec, s[86:87]
    ds_read_b128 v[60:63], v17
    s_mov_b64 exec, -1
    s_waitcnt lgkmcnt(3)
    v_mfma_f32_16x16x32_bf16 v[72:75], a[0:3], v[48:51], 0
    v_mfma_f32_16x16x32_bf16 v[76:79], a[32:35], v[48:51], 0
    v_mfma_f32_16x16x32_bf16 v[80:83], a[64:67], v[48:51], 0
    v_mfma_f32_16x16x32_bf16 v[84:87], a[96:99], v[48:51], 0
    v_mfma_f32_16x16x32_bf16 v[88:91], a[4:7], v[48:51], 0
    v_mfma_f32_16x16x32_bf16 v[92:95], a[36:39], v[48:51], 0
    v_mfma_f32_16x16x32_bf16 v[96:99], a[68:71], v[48:51], 0
    v_mfma_f32_16x16x32_bf16 v[100:103], a[100:103], v[48:51], 0
    buffer_load_dwordx4 v[160:163], v1, s[12:15], s58 offen offset:0 nt
    s_nop 0
    s_waitcnt lgkmcnt(2)
    v_mfma_f32_16x16x32_bf16 v[72:75], a[8:11], v[52:55], v[72:75]
    v_mfma_f32_16x16x32_bf16 v[76:79], a[40:43], v[52:55], v[76:79]
    v_mfma_f32_16x16x32_bf16 v[80:83], a[72:75], v[52:55], v[80:83]
    v_mfma_f32_16x16x32_bf16 v[84:87], a[104:107], v[52:55], v[84:87]
    v_mfma_f32_16x16x32_bf16 v[88:91], a[12:15], v[52:55], v[88:91]
    v_mfma_f32_16x16x32_bf16 v[92:95], a[44:47], v[52:55], v[92:95]
    v_mfma_f32_16x16x32_bf16 v[96:99], a[76:79], v[52:55], v[96:99]
    v_mfma_f32_16x16x32_bf16 v[100:103], a[108:111], v[52:55], v[100:103]
    s_nop 0
    s_waitcnt lgkmcnt(1)
    v_mfma_f32_16x16x32_bf16 v[72:75], a[16:19], v[56:59], v[72:75]
    v_mfma_f32_16x16x32_bf16 v[76:79], a[48:51], v[56:59], v[76:79]
    v_mfma_f32_16x16x32_bf16 v[80:83], a[80:83], v[56:59], v[80:83]
    v_mfma_f32_16x16x32_bf16 v[84:87], a[112:115], v[56:59], v[84:87]
    v_mfma_f32_16x16x32_bf16 v[88:91], a[20:23], v[56:59], v[88:91]
    v_mfma_f32_16x16x32_bf16 v[92:95], a[52:55], v[56:59], v[92:95]
    v_mfma_f32_16x16x32_bf16 v[96:99], a[84:87], v[56:59], v[96:99]
    v_mfma_f32_16x16x32_bf16 v[100:103], a[116:119], v[56:59], v[100:103]
    buffer_load_dwordx4 v[164:167], v1, s[12:15], s58 offen offset:1024 nt
    s_waitcnt lgkmcnt(0)
    v_mfma_f32_16x16x32_bf16 v[72:75], a[24:27], v[60:63], v[72:75]
    v_mfma_f32_16x16x32_bf16 v[76:79], a[56:59], v[60:63], v[76:79]
    v_mfma_f32_16x16x32_bf16 v[80:83], a[88:91], v[60:63], v[80:83]
    v_mfma_f32_16x16x32_bf16 v[84:87], a[120:123], v[60:63], v[84:87]
    s_nop 4
    v_add_f32_dpp v104, v73, v72 row_ror:12 row_mask:0xf bank_mask:0x1
    v_add_f32_dpp v104, v74, v104 row_ror:8 row_mask:0xf bank_mask:0x1
    v_add_f32_dpp v104, v75, v104 row_ror:4 row_mask:0xf bank_mask:0x1
    v_mfma_f32_16x16x32_bf16 v[88:91], a[28:31], v[60:63], v[88:91]
    v_add_f32_dpp v104, v76, v77 row_ror:4 row_mask:0xf bank_mask:0x2
    v_add_f32_dpp v104, v78, v104 row_ror:12 row_mask:0xf bank_mask:0x2
    v_add_f32_dpp v104, v79, v104 row_ror:8 row_mask:0xf bank_mask:0x2
    v_mfma_f32_16x16x32_bf16 v[92:95], a[60:63], v[60:63], v[92:95]
    v_add_f32_dpp v104, v80, v82 row_ror:8 row_mask:0xf bank_mask:0x4
    v_add_f32_dpp v104, v81, v104 row_ror:4 row_mask:0xf bank_mask:0x4
    v_add_f32_dpp v104, v83, v104 row_ror:12 row_mask:0xf bank_mask:0x4
    v_mfma_f32_16x16x32_bf16 v[96:99], a[92:95], v[60:63], v[96:99]
    v_add_f32_dpp v104, v84, v87 row_ror:12 row_mask:0xf bank_mask:0x8
    v_add_f32_dpp v104, v85, v104 row_ror:8 row_mask:0xf bank_mask:0x8
    v_add_f32_dpp v104, v86, v104 row_ror:4 row_mask:0xf bank_mask:0x8
    v_mfma_f32_16x16x32_bf16 v[100:103], a[124:127], v[60:63], v[100:103]
    v_add_f32_dpp v105, v89, v88 row_ror:12 row_mask:0xf bank_mask:0x1
    v_add_f32_dpp v105, v90, v105 row_ror:8 row_mask:0xf bank_mask:0x1
    v_add_f32_dpp v105, v91, v105 row_ror:4 row_mask:0xf bank_mask:0x1
    v_add_f32_dpp v105, v92, v93 row_ror:4 row_mask:0xf bank_mask:0x2
    v_add_f32_dpp v105, v94, v105 row_ror:12 row_mask:0xf bank_mask:0x2
    v_add_f32_dpp v105, v95, v105 row_ror:8 row_mask:0xf bank_mask:0x2
    v_add_f32_dpp v105, v96, v98 row_ror:8 row_mask:0xf bank_mask:0x4
    v_add_f32_dpp v105, v97, v105 row_ror:4 row_mask:0xf bank_mask:0x4
    v_add_f32_dpp v105, v99, v105 row_ror:12 row_mask:0xf bank_mask:0x4
    v_add_f32_dpp v105, v100, v103 row_ror:12 row_mask:0xf bank_mask:0x8
    v_add_f32_dpp v105, v101, v105 row_ror:8 row_mask:0xf bank_mask:0x8
    v_add_f32_dpp v105, v102, v105 row_ror:4 row_mask:0xf bank_mask:0x8
    v_max_f32 v106, v104, v105
    s_nop 1
    v_max_f32_dpp v106, v106, v106 row_ror:1 row_mask:0xf bank_mask:0xf
    s_nop 1
    v_max_f32_dpp v106, v106, v106 row_ror:2 row_mask:0xf bank_mask:0xf
    s_nop 1
    v_max_f32_dpp v106, v106, v106 row_ror:4 row_mask:0xf bank_mask:0xf
    s_nop 1
    v_max_f32_dpp v106, v106, v106 row_ror:8 row_mask:0xf bank_mask:0xf
    s_nop 1
    v_max_f32_dpp v106, v106, v106 row_bcast:15 row_mask:0xa bank_mask:0xf
    s_nop 1
    v_max_f32_dpp v106, v106, v106 row_bcast:31 row_mask:0xc bank_mask:0xf
    buffer_load_dwordx4 v[168:171], v1, s[12:15], s58 offen offset:2048 nt
    v_mul_f32 v106, v106, v27
    s_nop 0
    v_readlane_b32 s72, v106, 63
    s_nop 1
    v_fma_f32 v104, v104, v27, -s72
    v_fma_f32 v105, v105, v27, -s72
    v_exp_f32 v104, v104
    v_exp_f32 v105, v105
    s_nop 0
    v_cvt_pk_bf16_f32 v108, v104, v105
LS6_77:
    buffer_load_dwordx4 v[172:175], v1, s[12:15], s58 offen offset:3072 nt
    buffer_load_dwordx4 v[176:179], v1, s[12:15], s59 offen offset:0 nt
    v_lshlrev_b32 v107, 16, v108
    v_and_b32 v104, 0xffff0000, v108
    v_add_f32 v107, v107, v104
    s_nop 1
    v_add_f32_dpp v107, v107, v107 row_ror:1 row_mask:0xf bank_mask:0xf
    s_nop 1
    v_add_f32_dpp v107, v107, v107 row_ror:2 row_mask:0xf bank_mask:0xf
    s_nop 1
    v_add_f32_dpp v107, v107, v107 row_ror:4 row_mask:0xf bank_mask:0xf
    s_nop 1
    v_add_f32_dpp v107, v107, v107 row_ror:8 row_mask:0xf bank_mask:0xf
    s_nop 1
    v_add_f32_dpp v107, v107, v107 row_bcast:15 row_mask:0xa bank_mask:0xf
    s_nop 0
    s_nop 0
    v_add_f32_dpp v107, v107, v107 row_bcast:31 row_mask:0xc bank_mask:0xf
    ds_write_b64 v18, v[106:107]
    s_waitcnt lgkmcnt(0)
    s_barrier
    ds_read_b64 v[110:111], v19
    s_waitcnt lgkmcnt(0)
    v_max_f32_dpp v112, v110, v110 quad_perm:[1,0,3,2] row_mask:0xf bank_mask:0xf
    s_nop 1
    v_max_f32_dpp v112, v112, v112 quad_perm:[2,3,0,1] row_mask:0xf bank_mask:0xf
    v_sub_f32 v109, v110, v112
    v_exp_f32 v109, v109
    s_nop 0
    v_mul_f32 v113, v109, v111
    s_nop 1
    v_add_f32_dpp v113, v113, v113 quad_perm:[1,0,3,2] row_mask:0xf bank_mask:0xf
    s_nop 0
    s_nop 0
    v_add_f32_dpp v113, v113, v113 quad_perm:[2,3,0,1] row_mask:0xf bank_mask:0xf
    s_cmp_lg_u32 s7, 0
    s_cbranch_scc1 Lnos_78
    s_mov_b64 exec, 0x10001
    s_cmp_eq_u32 s78, 0
    s_cbranch_scc1 Lm_79
    buffer_store_dwordx2 v[112:113], v1, s[16:19], s79 offen sc1
    s_branch Lm_80
Lm_79:
    buffer_store_dwordx2 v[112:113], v1, s[16:19], s79 offen
Lm_80:
    s_mov_b64 exec, -1
Lnos_78:
    v_mov_b32 v100, -1
    v_mov_b32 v101, -1
    v_mov_b32 v102, -1
    v_mov_b32 v103, -1
    s_lshl_b32 s67, s4, 2
    s_add_u32 s67, s67, s7
    s_sub_u32 s67, s67, 48
    s_lshl_b32 s68, s67, 10
    s_cmp_ge_u32 s67, 48
    s_cbranch_scc1 Lnc_81
    s_add_u32 s68, s68, s76
    s_add_u32 s68, s68, 0x74000
    s_cmp_lg_u32 s78, 0
    s_cbranch_scc1 Lsl_83
    buffer_store_dwordx4 v[100:103], v1, s[16:19], s68 offen
    s_branch Lnc_81
Lsl_83:
    buffer_store_dwordx4 v[100:103], v1, s[16:19], s68 offen sc1
Lnc_81:
LS7_84:
    v_mov_b32_dpp v64, v108 row_newbcast:0 row_mask:0xf bank_mask:0x1
    v_mov_b32_dpp v65, v108 row_newbcast:0 row_mask:0xf bank_mask:0x2
    v_mov_b32_dpp v66, v108 row_newbcast:0 row_mask:0xf bank_mask:0x4
    v_mov_b32_dpp v67, v108 row_newbcast:0 row_mask:0xf bank_mask:0x8
    s_waitcnt vmcnt(11)
    v_perm_b32 v126, v132, v128, s70
    v_perm_b32 v127, v132, v128, s71
    v_perm_b32 v128, v133, v129, s70
    v_perm_b32 v129, v133, v129, s71
    v_perm_b32 v132, v135, v131, s70
    v_perm_b32 v133, v135, v131, s71
    v_perm_b32 v131, v134, v130, s71
    v_perm_b32 v130, v134, v130, s70
    v_mfma_f32_16x16x32_bf16 v[72:75], v[64:67], v[126:129], 0
    v_mov_b32_dpp v68, v108 row_newbcast:1 row_mask:0xf bank_mask:0x1
    v_mov_b32_dpp v69, v108 row_newbcast:1 row_mask:0xf bank_mask:0x2
    v_mov_b32_dpp v70, v108 row_newbcast:1 row_mask:0xf bank_mask:0x4
    v_mfma_f32_16x16x32_bf16 v[76:79], v[64:67], v[130:133], 0
    v_mov_b32_dpp v71, v108 row_newbcast:1 row_mask:0xf bank_mask:0x8
    s_nop 0
    s_waitcnt vmcnt(9)
    v_perm_b32 v134, v140, v136, s70
    v_perm_b32 v135, v140, v136, s71
    v_perm_b32 v136, v141, v137, s70
    v_perm_b32 v137, v141, v137, s71
    v_perm_b32 v140, v143, v139, s70
    v_perm_b32 v141, v143, v139, s71
    v_perm_b32 v139, v142, v138, s71
    v_perm_b32 v138, v142, v138, s70
    v_mfma_f32_16x16x32_bf16 v[72:75], v[68:71], v[134:137], v[72:75]
    v_mov_b32_dpp v64, v108 row_newbcast:2 row_mask:0xf bank_mask:0x1
    v_mov_b32_dpp v65, v108 row_newbcast:2 row_mask:0xf bank_mask:0x2
    v_mov_b32_dpp v66, v108 row_newbcast:2 row_mask:0xf bank_mask:0x4
    v_mfma_f32_16x16x32_bf16 v[76:79], v[68:71], v[138:141], v[76:79]
    v_mov_b32_dpp v67, v108 row_newbcast:2 row_mask:0xf bank_mask:0x8
    s_nop 0
    s_waitcnt vmcnt(7)
    v_perm_b32 v142, v148, v144, s70
    v_perm_b32 v143, v148, v144, s71
    v_perm_b32 v144, v149, v145, s70
    v_perm_b32 v145, v149, v145, s71
    v_perm_b32 v148, v151, v147, s70
    v_perm_b32 v149, v151, v147, s71
    v_perm_b32 v147, v150, v146, s71
    v_perm_b32 v146, v150, v146, s70
    v_mfma_f32_16x16x32_bf16 v[72:75], v[64:67], v[142:145], v[72:75]
    v_mov_b32_dpp v68, v108 row_newbcast:3 row_mask:0xf bank_mask:0x1
    v_mov_b32_dpp v69, v108 row_newbcast:3 row_mask:0xf bank_mask:0x2
    v_mov_b32_dpp v70, v108 row_newbcast:3 row_mask:0xf bank_mask:0x4
    v_mfma_f32_16x16x32_bf16 v[76:79], v[64:67], v[146:149], v[76:79]
    v_mov_b32_dpp v71, v108 row_newbcast:3 row_mask:0xf bank_mask:0x8
    buffer_load_dwordx4 v[180:183], v1, s[12:15], s59 offen offset:1024 nt
    s_nop 0
    s_waitcnt vmcnt(6)
    v_perm_b32 v150, v156, v152, s70
    v_perm_b32 v151, v156, v152, s71
    v_perm_b32 v152, v157, v153, s70
    v_perm_b32 v153, v157, v153, s71
    v_perm_b32 v156, v159, v155, s70
    v_perm_b32 v157, v159, v155, s71
    v_perm_b32 v155, v158, v154, s71
    v_perm_b32 v154, v158, v154, s70
    v_mfma_f32_16x16x32_bf16 v[72:75], v[68:71], v[150:153], v[72:75]
    v_mov_b32_dpp v64, v108 row_newbcast:4 row_mask:0xf bank_mask:0x1
    v_mov_b32_dpp v65, v108 row_newbcast:4 row_mask:0xf bank_mask:0x2
    v_mov_b32_dpp v66, v108 row_newbcast:4 row_mask:0xf bank_mask:0x4
    v_mfma_f32_16x16x32_bf16 v[76:79], v[68:71], v[154:157], v[76:79]
    v_mov_b32_dpp v67, v108 row_newbcast:4 row_mask:0xf bank_mask:0x8
    buffer_load_dwordx4 v[184:187], v1, s[12:15], s59 offen offset:2048 nt
    buffer_load_dwordx4 v[188:191], v1, s[12:15], s59 offen offset:3072 nt
    s_nop 0
    s_waitcnt vmcnt(6)
    v_perm_b32 v158, v164, v160, s70
    v_perm_b32 v159, v164, v160, s71
    v_perm_b32 v160, v165, v161, s70
    v_perm_b32 v161, v165, v161, s71
    v_perm_b32 v164, v167, v163, s70
    v_perm_b32 v165, v167, v163, s71
    v_perm_b32 v163, v166, v162, s71
    v_perm_b32 v162, v166, v162, s70
    v_mfma_f32_16x16x32_bf16 v[72:75], v[64:67], v[158:161], v[72:75]
    v_mov_b32_dpp v68, v108 row_newbcast:5 row_mask:0xf bank_mask:0x1
    v_mov_b32_dpp v69, v108 row_newbcast:5 row_mask:0xf bank_mask:0x2
    v_mov_b32_dpp v70, v108 row_newbcast:5 row_mask:0xf bank_mask:0x4
    v_mfma_f32_16x16x32_bf16 v[76:79], v[64:67], v[162:165], v[76:79]
    v_mov_b32_dpp v71, v108 row_newbcast:5 row_mask:0xf bank_mask:0x8
    buffer_load_dwordx4 v[192:195], v1, s[12:15], s60 offen offset:0 nt
    buffer_load_dwordx4 v[196:199], v1, s[12:15], s60 offen offset:1024 nt
    s_nop 0
    s_waitcnt vmcnt(6)
    v_perm_b32 v166, v172, v168, s70
    v_perm_b32 v167, v172, v168, s71
    v_perm_b32 v168, v173, v169, s70
    v_perm_b32 v169, v173, v169, s71
    v_perm_b32 v172, v175, v171, s70
    v_perm_b32 v173, v175, v171, s71
    v_perm_b32 v171, v174, v170, s71
    v_perm_b32 v170, v174, v170, s70
    v_mfma_f32_16x16x32_bf16 v[72:75], v[68:71], v[166:169], v[72:75]
    v_mov_b32_dpp v64, v108 row_newbcast:6 row_mask:0xf bank_mask:0x1
    v_mov_b32_dpp v65, v108 row_newbcast:6 row_mask:0xf bank_mask:0x2
    v_mov_b32_dpp v66, v108 row_newbcast:6 row_mask:0xf bank_mask:0x4
    v_mfma_f32_16x16x32_bf16 v[76:79], v[68:71], v[170:173], v[76:79]
    v_mov_b32_dpp v67, v108 row_newbcast:6 row_mask:0xf bank_mask:0x8
    buffer_load_dwordx4 v[200:203], v1, s[12:15], s60 offen offset:2048 nt
    buffer_load_dwordx4 v[204:207], v1, s[12:15], s60 offen offset:3072 nt
    s_nop 0
    s_waitcnt vmcnt(6)
    v_perm_b32 v174, v180, v176, s70
    v_perm_b32 v175, v180, v176, s71
    v_perm_b32 v176, v181, v177, s70
    v_perm_b32 v177, v181, v177, s71
    v_perm_b32 v180, v183, v179, s70
    v_perm_b32 v181, v183, v179, s71
    v_perm_b32 v179, v182, v178, s71
    v_perm_b32 v178, v182, v178, s70
    v_mfma_f32_16x16x32_bf16 v[72:75], v[64:67], v[174:177], v[72:75]
    v_mov_b32_dpp v68, v108 row_newbcast:7 row_mask:0xf bank_mask:0x1
    v_mov_b32_dpp v69, v108 row_newbcast:7 row_mask:0xf bank_mask:0x2
    v_mov_b32_dpp v70, v108 row_newbcast:7 row_mask:0xf bank_mask:0x4
    v_mfma_f32_16x16x32_bf16 v[76:79], v[64:67], v[178:181], v[76:79]
    v_mov_b32_dpp v71, v108 row_newbcast:7 row_mask:0xf bank_mask:0x8
    buffer_load_dwordx4 v[208:211], v1, s[12:15], s61 offen offset:0 nt
    buffer_load_dwordx4 v[212:215], v1, s[12:15], s61 offen offset:1024 nt
    s_nop 0
    s_waitcnt vmcnt(6)
    v_perm_b32 v182, v188, v184, s70
    v_perm_b32 v183, v188, v184, s71
    v_perm_b32 v184, v189, v185, s70
    v_perm_b32 v185, v189, v185, s71
    v_perm_b32 v188, v191, v187, s70
    v_perm_b32 v189, v191, v187, s71
    v_perm_b32 v187, v190, v186, s71
    v_perm_b32 v186, v190, v186, s70
    v_mfma_f32_16x16x32_bf16 v[72:75], v[68:71], v[182:185], v[72:75]
    v_mov_b32_dpp v64, v108 row_newbcast:8 row_mask:0xf bank_mask:0x1
    v_mov_b32_dpp v65, v108 row_newbcast:8 row_mask:0xf bank_mask:0x2
    v_mov_b32_dpp v66, v108 row_newbcast:8 row_mask:0xf bank_mask:0x4
    v_mfma_f32_16x16x32_bf16 v[76:79], v[68:71], v[186:189], v[76:79]
    v_mov_b32_dpp v67, v108 row_newbcast:8 row_mask:0xf bank_mask:0x8
    buffer_load_dwordx4 v[216:219], v1, s[12:15], s61 offen offset:2048 nt
    buffer_load_dwordx4 v[220:223], v1, s[12:15], s61 offen offset:3072 nt
    s_nop 0
    s_waitcnt vmcnt(6)
    v_perm_b32 v190, v196, v192, s70
    v_perm_b32 v191, v196, v192, s71
    v_perm_b32 v192, v197, v193, s70
    v_perm_b32 v193, v197, v193, s71
    v_perm_b32 v196, v199, v195, s70
    v_perm_b32 v197, v199, v195, s71
    v_perm_b32 v195, v198, v194, s71
    v_perm_b32 v194, v198, v194, s70
    v_mfma_f32_16x16x32_bf16 v[72:75], v[64:67], v[190:193], v[72:75]
    v_mov_b32_dpp v68, v108 row_newbcast:9 row_mask:0xf bank_mask:0x1
    v_mov_b32_dpp v69, v108 row_newbcast:9 row_mask:0xf bank_mask:0x2
    v_mov_b32_dpp v70, v108 row_newbcast:9 row_mask:0xf bank_mask:0x4
    v_mfma_f32_16x16x32_bf16 v[76:79], v[64:67], v[194:197], v[76:79]
    v_mov_b32_dpp v71, v108 row_newbcast:9 row_mask:0xf bank_mask:0x8
    buffer_load_dwordx4 v[224:227], v1, s[12:15], s62 offen offset:0 nt
    buffer_load_dwordx4 v[228:231], v1, s[12:15], s62 offen offset:1024 nt
    s_nop 0
    s_waitcnt vmcnt(6)
    v_perm_b32 v198, v204, v200, s70
    v_perm_b32 v199, v204, v200, s71
    v_perm_b32 v200, v205, v201, s70
    v_perm_b32 v201, v205, v201, s71
    v_perm_b32 v204, v207, v203, s70
    v_perm_b32 v205, v207, v203, s71
    v_perm_b32 v203, v206, v202, s71
    v_perm_b32 v202, v206, v202, s70
    v_mfma_f32_16x16x32_bf16 v[72:75], v[68:71], v[198:201], v[72:75]
    v_mov_b32_dpp v64, v108 row_newbcast:10 row_mask:0xf bank_mask:0x1
    v_mov_b32_dpp v65, v108 row_newbcast:10 row_mask:0xf bank_mask:0x2
    v_mov_b32_dpp v66, v108 row_newbcast:10 row_mask:0xf bank_mask:0x4
    v_mfma_f32_16x16x32_bf16 v[76:79], v[68:71], v[202:205], v[76:79]
    v_mov_b32_dpp v67, v108 row_newbcast:10 row_mask:0xf bank_mask:0x8
    buffer_load_dword v114, v119, s[52:55], 0 offen sc1
    buffer_load_dwordx4 v[232:235], v1, s[12:15], s62 offen offset:2048 nt
    s_nop 0
    s_waitcnt vmcnt(6)
    v_perm_b32 v206, v212, v208, s70
    v_perm_b32 v207, v212, v208, s71
    v_perm_b32 v208, v213, v209, s70
    v_perm_b32 v209, v213, v209, s71
    v_perm_b32 v212, v215, v211, s70
    v_perm_b32 v213, v215, v211, s71
    v_perm_b32 v211, v214, v210, s71
    v_perm_b32 v210, v214, v210, s70
    v_mfma_f32_16x16x32_bf16 v[72:75], v[64:67], v[206:209], v[72:75]
    v_mov_b32_dpp v68, v108 row_newbcast:11 row_mask:0xf bank_mask:0x1
    v_mov_b32_dpp v69, v108 row_newbcast:11 row_mask:0xf bank_mask:0x2
    v_mov_b32_dpp v70, v108 row_newbcast:11 row_mask:0xf bank_mask:0x4
    v_mfma_f32_16x16x32_bf16 v[76:79], v[64:67], v[210:213], v[76:79]
    v_mov_b32_dpp v71, v108 row_newbcast:11 row_mask:0xf bank_mask:0x8
    buffer_load_dwordx4 v[236:239], v1, s[12:15], s62 offen offset:3072 nt
    buffer_load_dwordx4 v[240:243], v1, s[12:15], s63 offen offset:0 nt
    s_nop 0
    s_waitcnt vmcnt(6)
    v_perm_b32 v214, v220, v216, s70
    v_perm_b32 v215, v220, v216, s71
    v_perm_b32 v216, v221, v217, s70
    v_perm_b32 v217, v221, v217, s71
    v_perm_b32 v220, v223, v219, s70
    v_perm_b32 v221, v223, v219, s71
    v_perm_b32 v219, v222, v218, s71
    v_perm_b32 v218, v222, v218, s70
    v_mfma_f32_16x16x32_bf16 v[72:75], v[68:71], v[214:217], v[72:75]
    v_mov_b32_dpp v64, v108 row_newbcast:12 row_mask:0xf bank_mask:0x1
    v_mov_b32_dpp v65, v108 row_newbcast:12 row_mask:0xf bank_mask:0x2
    v_mov_b32_dpp v66, v108 row_newbcast:12 row_mask:0xf bank_mask:0x4
    v_mfma_f32_16x16x32_bf16 v[76:79], v[68:71], v[218:221], v[76:79]
    v_mov_b32_dpp v67, v108 row_newbcast:12 row_mask:0xf bank_mask:0x8
    buffer_load_dwordx4 v[244:247], v1, s[12:15], s63 offen offset:1024 nt
    buffer_load_dwordx4 v[248:251], v1, s[12:15], s63 offen offset:2048 nt
    s_nop 0
    s_waitcnt vmcnt(6)
    v_perm_b32 v222, v228, v224, s70
    v_perm_b32 v223, v228, v224, s71
    v_perm_b32 v224, v229, v225, s70
    v_perm_b32 v225, v229, v225, s71
    v_perm_b32 v228, v231, v227, s70
    v_perm_b32 v229, v231, v227, s71
    v_perm_b32 v227, v230, v226, s71
    v_perm_b32 v226, v230, v226, s70
    v_mfma_f32_16x16x32_bf16 v[72:75], v[64:67], v[222:225], v[72:75]
    v_mov_b32_dpp v68, v108 row_newbcast:13 row_mask:0xf bank_mask:0x1
    v_mov_b32_dpp v69, v108 row_newbcast:13 row_mask:0xf bank_mask:0x2
    v_mov_b32_dpp v70, v108 row_newbcast:13 row_mask:0xf bank_mask:0x4
    v_mfma_f32_16x16x32_bf16 v[76:79], v[64:67], v[226:229], v[76:79]
    v_mov_b32_dpp v71, v108 row_newbcast:13 row_mask:0xf bank_mask:0x8
    buffer_load_dwordx4 v[252:255], v1, s[12:15], s63 offen offset:3072 nt
    s_nop 0
    s_waitcnt vmcnt(4)
    v_perm_b32 v230, v236, v232, s70
    v_perm_b32 v231, v236, v232, s71
    v_perm_b32 v232, v237, v233, s70
    v_perm_b32 v233, v237, v233, s71
    v_perm_b32 v236, v239, v235, s70
    v_perm_b32 v237, v239, v235, s71
    v_perm_b32 v235, v238, v234, s71
    v_perm_b32 v234, v238, v234, s70
    v_mfma_f32_16x16x32_bf16 v[72:75], v[68:71], v[230:233], v[72:75]
    v_mov_b32_dpp v64, v108 row_newbcast:14 row_mask:0xf bank_mask:0x1
    v_mov_b32_dpp v65, v108 row_newbcast:14 row_mask:0xf bank_mask:0x2
    v_mov_b32_dpp v66, v108 row_newbcast:14 row_mask:0xf bank_mask:0x4
    v_mfma_f32_16x16x32_bf16 v[76:79], v[68:71], v[234:237], v[76:79]
    v_mov_b32_dpp v67, v108 row_newbcast:14 row_mask:0xf bank_mask:0x8
    s_nop 0
    s_waitcnt vmcnt(2)
    v_perm_b32 v238, v244, v240, s70
    v_perm_b32 v239, v244, v240, s71
    v_perm_b32 v240, v245, v241, s70
    v_perm_b32 v241, v245, v241, s71
    v_perm_b32 v244, v247, v243, s70
    v_perm_b32 v245, v247, v243, s71
    v_perm_b32 v243, v246, v242, s71
    v_perm_b32 v242, v246, v242, s70
    v_mfma_f32_16x16x32_bf16 v[72:75], v[64:67], v[238:241], v[72:75]
    v_mov_b32_dpp v68, v108 row_newbcast:15 row_mask:0xf bank_mask:0x1
    v_mov_b32_dpp v69, v108 row_newbcast:15 row_mask:0xf bank_mask:0x2
    v_mov_b32_dpp v70, v108 row_newbcast:15 row_mask:0xf bank_mask:0x4
    v_mfma_f32_16x16x32_bf16 v[76:79], v[64:67], v[242:245], v[76:79]
    v_mov_b32_dpp v71, v108 row_newbcast:15 row_mask:0xf bank_mask:0x8
    s_nop 0
    s_waitcnt vmcnt(0)
    v_perm_b32 v246, v252, v248, s70
    v_perm_b32 v247, v252, v248, s71
    v_perm_b32 v248, v253, v249, s70
    v_perm_b32 v249, v253, v249, s71
    v_perm_b32 v252, v255, v251, s70
    v_perm_b32 v253, v255, v251, s71
    v_perm_b32 v251, v254, v250, s71
    v_perm_b32 v250, v254, v250, s70
    v_mfma_f32_16x16x32_bf16 v[72:75], v[68:71], v[246:249], v[72:75]
    s_nop 0
    v_mfma_f32_16x16x32_bf16 v[76:79], v[68:71], v[250:253], v[76:79]
    s_waitcnt vmcnt(20)
    s_mov_b32 s64, 0x0
    s_add_u32 s65, s79, 0x0
    s_movk_i32 s66, 0x2000
    s_cmp_lg_u32 s78, 0
    s_cbranch_scc1 L_loopB_slow
L_loopB_fast:
LS10_85:
    v_mul_f32_dpp v104, v109, v72 quad_perm:[0,0,0,0] row_mask:0xf bank_mask:0xf
    s_nop 0
    v_mul_f32_dpp v105, v109, v76 quad_perm:[0,0,0,0] row_mask:0xf bank_mask:0xf
    ds_write2_b32 v20, v104, v105 offset0:0 offset1:64
    s_cmp_lg_u32 s7, 0
    s_waitcnt lgkmcnt(0)
    s_barrier
    s_cbranch_scc1 Lsk_86
    ds_read2_b64 v[72:75], v21 offset0:0 offset1:64
    ds_read2_b64 v[76:79], v21 offset0:128 offset1:192
    s_waitcnt lgkmcnt(1)
    v_pk_add_f32 v[72:73], v[72:73], v[74:75]
    s_waitcnt lgkmcnt(0)
    v_pk_add_f32 v[76:77], v[76:77], v[78:79]
    v_pk_add_f32 v[72:73], v[72:73], v[76:77]
    v_cvt_pk_bf16_f32 v72, v72, v73
    buffer_store_dword v72, v8, s[16:19], s64 offen
Lsk_86:
LS11_87:
    s_waitcnt vmcnt(6)
Lfc_90:
    v_and_b32 v120, 0x80808080, v114
    v_cmp_ne_u32 vcc, 0x80808080, v120
    s_cbranch_vccnz Lretry_91
Lfok_89:
Lp_92:
    buffer_load_dwordx2 v[108:109], v11, s[16:19], s64 offen sc1
    buffer_load_dwordx4 v[104:107], v9, s[16:19], s64 offen sc1
    s_sub_u32 s69, s69, 1
    s_cbranch_scc1 Lgive_94
    s_nop 0
    s_waitcnt vmcnt(0)
    v_max3_u32 v113, v104, v105, v106
    v_max3_u32 v113, v113, v107, v108
    v_mfma_f32_16x16x32_bf16 v[72:75], v[104:107], a[160:163], 0
    v_max_u32 v113, v113, v109
    v_cmp_eq_u32 vcc, -1, v113
    v_max_f32_dpp v110, v108, v108 quad_perm:[1,0,3,2] row_mask:0xf bank_mask:0xf
    s_cbranch_vccnz Lp_92
Lok_93:
    v_mfma_f32_16x16x32_bf16 v[76:79], v[104:107], a[164:167], 0
    v_max_f32_dpp v110, v110, v110 quad_perm:[2,3,0,1] row_mask:0xf bank_mask:0xf
    v_mfma_f32_16x16x32_bf16 v[80:83], v[104:107], a[168:171], 0
    s_nop 0
    v_max_f32_dpp v110, v110, v110 row_half_mirror row_mask:0xf bank_mask:0xf
    v_mfma_f32_16x16x32_bf16 v[84:87], v[104:107], a[172:175], 0
    v_sub_f32 v111, v108, v110
    v_exp_f32 v111, v111
    v_mfma_f32_16x16x32_bf16 v[88:91], v[104:107], a[176:179], 0
    v_mul_f32 v112, v111, v109
    v_mfma_f32_16x16x32_bf16 v[92:95], v[104:107], a[180:183], 0
    s_nop 0
    v_add_f32_dpp v112, v112, v112 quad_perm:[1,0,3,2] row_mask:0xf bank_mask:0xf
    v_mfma_f32_16x16x32_bf16 v[96:99], v[104:107], a[184:187], 0
    s_nop 0
    v_add_f32_dpp v112, v112, v112 quad_perm:[2,3,0,1] row_mask:0xf bank_mask:0xf
    v_mfma_f32_16x16x32_bf16 v[100:103], v[104:107], a[188:191], 0
    s_nop 0
    v_add_f32_dpp v112, v112, v112 row_half_mirror row_mask:0xf bank_mask:0xf
    v_rcp_f32 v112, v112
    s_nop 0
    v_mul_f32 v111, v111, v112
    s_nop 1
    v_mul_f32_dpp v116, v111, v72 row_newbcast:0 row_mask:0xf bank_mask:0xf
    v_mul_f32_dpp v117, v111, v76 row_newbcast:0 row_mask:0xf bank_mask:0xf
    v_mul_f32_dpp v118, v111, v80 row_newbcast:0 row_mask:0xf bank_mask:0xf
    v_mul_f32_dpp v119, v111, v84 row_newbcast:0 row_mask:0xf bank_mask:0xf
    v_mul_f32_dpp v120, v111, v88 row_newbcast:0 row_mask:0xf bank_mask:0xf
    v_mul_f32_dpp v121, v111, v92 row_newbcast:0 row_mask:0xf bank_mask:0xf
    v_mul_f32_dpp v122, v111, v96 row_newbcast:0 row_mask:0xf bank_mask:0xf
    v_mul_f32_dpp v123, v111, v100 row_newbcast:0 row_mask:0xf bank_mask:0xf
    v_fmac_f32_dpp v116, v111, v73 row_newbcast:1 row_mask:0xf bank_mask:0xf
    v_fmac_f32_dpp v117, v111, v77 row_newbcast:1 row_mask:0xf bank_mask:0xf
    v_fmac_f32_dpp v118, v111, v81 row_newbcast:1 row_mask:0xf bank_mask:0xf
    v_fmac_f32_dpp v119, v111, v85 row_newbcast:1 row_mask:0xf bank_mask:0xf
    v_fmac_f32_dpp v120, v111, v89 row_newbcast:1 row_mask:0xf bank_mask:0xf
    v_fmac_f32_dpp v121, v111, v93 row_newbcast:1 row_mask:0xf bank_mask:0xf
    v_fmac_f32_dpp v122, v111, v97 row_newbcast:1 row_mask:0xf bank_mask:0xf
    v_fmac_f32_dpp v123, v111, v101 row_newbcast:1 row_mask:0xf bank_mask:0xf
    v_fmac_f32_dpp v116, v111, v74 row_newbcast:2 row_mask:0xf bank_mask:0xf
    v_fmac_f32_dpp v117, v111, v78 row_newbcast:2 row_mask:0xf bank_mask:0xf
    v_fmac_f32_dpp v118, v111, v82 row_newbcast:2 row_mask:0xf bank_mask:0xf
    v_fmac_f32_dpp v119, v111, v86 row_newbcast:2 row_mask:0xf bank_mask:0xf
    v_fmac_f32_dpp v120, v111, v90 row_newbcast:2 row_mask:0xf bank_mask:0xf
    v_fmac_f32_dpp v121, v111, v94 row_newbcast:2 row_mask:0xf bank_mask:0xf
    v_fmac_f32_dpp v122, v111, v98 row_newbcast:2 row_mask:0xf bank_mask:0xf
    v_fmac_f32_dpp v123, v111, v102 row_newbcast:2 row_mask:0xf bank_mask:0xf
    v_fmac_f32_dpp v116, v111, v75 row_newbcast:3 row_mask:0xf bank_mask:0xf
    v_fmac_f32_dpp v117, v111, v79 row_newbcast:3 row_mask:0xf bank_mask:0xf
    v_fmac_f32_dpp v118, v111, v83 row_newbcast:3 row_mask:0xf bank_mask:0xf
    v_fmac_f32_dpp v119, v111, v87 row_newbcast:3 row_mask:0xf bank_mask:0xf
    v_fmac_f32_dpp v120, v111, v91 row_newbcast:3 row_mask:0xf bank_mask:0xf
    v_fmac_f32_dpp v121, v111, v95 row_newbcast:3 row_mask:0xf bank_mask:0xf
    v_fmac_f32_dpp v122, v111, v99 row_newbcast:3 row_mask:0xf bank_mask:0xf
    v_fmac_f32_dpp v123, v111, v103 row_newbcast:3 row_mask:0xf bank_mask:0xf
    v_permlane16_swap_b32 v116, v120
    v_permlane16_swap_b32 v117, v121
    v_permlane16_swap_b32 v118, v122
    v_permlane16_swap_b32 v119, v123
    v_pk_add_f32 v[116:117], v[116:117], v[120:121]
    v_pk_add_f32 v[118:119], v[118:119], v[122:123]
    ds_write_b128 v22, v[116:119] offset:0
    s_cmp_lg_u32 s7, 0
    s_waitcnt lgkmcnt(0)
    s_barrier
    s_cbranch_scc1 Lsk_95
    ds_read2st64_b32 v[72:73], v23 offset0:0 offset1:1
    ds_read2st64_b32 v[74:75], v23 offset0:2 offset1:3
    ds_read2st64_b32 v[76:77], v23 offset0:4 offset1:5
    ds_read2st64_b32 v[78:79], v23 offset0:6 offset1:7
    s_waitcnt lgkmcnt(2)
    v_pk_add_f32 v[72:73], v[72:73], v[74:75]
    s_waitcnt lgkmcnt(0)
    v_pk_add_f32 v[76:77], v[76:77], v[78:79]
    v_pk_add_f32 v[72:73], v[72:73], v[76:77]
    v_add_f32 v72, v72, v73
    v_cvt_f64_f32 v[74:75], v72
    v_add_f64 v[74:75], v[74:75], s[0:1]
    v_add_u32 v75, 0xbf480000, v75
    buffer_atomic_add_x2 v[74:75], v12, s[16:19], 0 offen offset:0 sc1
    buffer_atomic_add_x2 v[74:75], v12, s[16:19], s66 offen offset:0 sc1
Lsk_95:
LS12_96:
    s_barrier
    s_mul_i32 s90, s3, 216
    s_and_b32 s91, s74, 1
    s_mul_i32 s91, s91, 108
    s_add_u32 s90, s90, s91
    s_mul_i32 s91, s7, 28
    s_add_u32 s90, s90, s91
    s_lshl_b32 s91, s90, 1
    buffer_load_ushort a228, v26, s[36:39], s91 offen
    s_mul_i32 s90, s90, 1280
    s_lshr_b32 s91, s74, 1
    s_lshl_b32 s91, s91, 7
    s_add_u32 s90, s90, s91
    buffer_load_dwordx2 v[84:85], v24, s[40:43], s90 offen
    s_add_u32 s90, s90, 5120
    buffer_load_dwordx2 v[86:87], v24, s[40:43], s90 offen
    s_add_u32 s90, s90, 5120
    buffer_load_dwordx2 v[88:89], v24, s[40:43], s90 offen
    s_add_u32 s90, s90, 5120
    buffer_load_dwordx2 v[90:91], v24, s[40:43], s90 offen
    s_add_u32 s90, s90, 5120
    buffer_load_dwordx2 v[92:93], v24, s[40:43], s90 offen
    s_add_u32 s90, s90, 5120
    buffer_load_dwordx2 v[94:95], v24, s[40:43], s90 offen
    s_add_u32 s90, s90, 5120
    buffer_load_dwordx2 v[96:97], v24, s[40:43], s90 offen
    s_add_u32 s90, s90, 5120
    buffer_load_dwordx2 v[98:99], v24, s[40:43], s90 offen
    s_waitcnt vmcnt(4)
    s_mov_b32 s68, 0xe8000
    buffer_load_dwordx4 v[116:119], v7, s[16:19], s68 offen sc1
    buffer_load_dwordx4 v[112:115], v15, s[16:19], s68 offen sc1
    buffer_load_dwordx4 v[76:79], v7, s[16:19], s64 offen sc1
    buffer_load_dwordx4 v[72:75], v15, s[16:19], s64 offen sc1
    s_nop 0
    s_waitcnt vmcnt(4)
    v_accvgpr_read_b32 v26, a228
    v_lshlrev_b32_e64 v26, 16, v26
    v_perm_b32 v100, v86, v84, s70
    v_accvgpr_write_b32 a208, v100
    v_perm_b32 v101, v90, v88, s70
    v_accvgpr_write_b32 a209, v101
    v_perm_b32 v100, v94, v92, s70
    v_accvgpr_write_b32 a210, v100
    v_perm_b32 v101, v98, v96, s70
    v_accvgpr_write_b32 a211, v101
    v_perm_b32 v100, v86, v84, s71
    v_accvgpr_write_b32 a212, v100
    v_perm_b32 v101, v90, v88, s71
    v_accvgpr_write_b32 a213, v101
    v_perm_b32 v100, v94, v92, s71
    v_accvgpr_write_b32 a214, v100
    v_perm_b32 v101, v98, v96, s71
    v_accvgpr_write_b32 a215, v101
    v_perm_b32 v100, v87, v85, s70
    v_accvgpr_write_b32 a216, v100
    v_perm_b32 v101, v91, v89, s70
    v_accvgpr_write_b32 a217, v101
    v_perm_b32 v100, v95, v93, s70
    v_accvgpr_write_b32 a218, v100
    v_perm_b32 v101, v99, v97, s70
    v_accvgpr_write_b32 a219, v101
    v_perm_b32 v100, v87, v85, s71
    v_accvgpr_write_b32 a220, v100
    v_perm_b32 v101, v91, v89, s71
    v_accvgpr_write_b32 a221, v101
    v_perm_b32 v100, v95, v93, s71
    v_accvgpr_write_b32 a222, v100
    v_perm_b32 v101, v99, v97, s71
    v_accvgpr_write_b32 a223, v101
    s_branch Lc_98
Lcp_99:
    buffer_load_dwordx4 v[116:119], v7, s[16:19], s68 offen sc1
    buffer_load_dwordx4 v[112:115], v15, s[16:19], s68 offen sc1
    buffer_load_dwordx4 v[76:79], v7, s[16:19], s64 offen sc1
    buffer_load_dwordx4 v[72:75], v15, s[16:19], s64 offen sc1
    s_sub_u32 s69, s69, 1
    s_cbranch_scc1 Lgive_102
Lc_98:
    s_waitcnt vmcnt(2)
    v_add_f32_dpp v112, v116, v112 quad_perm:[0,1,2,3] row_mask:0xf bank_mask:0xc
    v_add_f32_dpp v113, v117, v113 quad_perm:[0,1,2,3] row_mask:0xf bank_mask:0xc
    v_add_f32_dpp v114, v118, v114 quad_perm:[0,1,2,3] row_mask:0xf bank_mask:0xc
    v_add_f32_dpp v115, v119, v115 quad_perm:[0,1,2,3] row_mask:0xf bank_mask:0xc
    v_permlane32_swap_b32 v112, v113
    s_nop 0
    v_permlane32_swap_b32 v114, v115
    v_add_f32 v112, v112, v113
    v_add_f32 v114, v114, v115
    s_nop 1
    v_permlane16_swap_b32 v112, v114
    v_add_f32 v25, v112, v114
    s_nop 1
    v_add_f32_dpp v25, v25, v25 row_ror:8 row_mask:0xf bank_mask:0xf
    v_cmp_u_f32 vcc, v25, v25
    s_cbranch_vccnz Lcp_99
Lok_101:
    s_branch Lp_97w
Lp_97:
    buffer_load_dwordx4 v[76:79], v7, s[16:19], s64 offen sc1
    buffer_load_dwordx4 v[72:75], v15, s[16:19], s64 offen sc1
    s_sub_u32 s69, s69, 1
    s_cbranch_scc1 Lgive_104
Lp_97w:
    s_waitcnt vmcnt(1)
    v_pk_add_f32 v[80:81], v[76:77], v[78:79]
    s_nop 1
    v_add_f32_dpp v6, v80, v81 quad_perm:[0,1,2,3] row_mask:0xf bank_mask:0x3
    s_nop 0
    s_waitcnt vmcnt(0)
    v_add_f32_dpp v72, v76, v72 quad_perm:[0,1,2,3] row_mask:0xf bank_mask:0xc
    v_add_f32_dpp v73, v77, v73 quad_perm:[0,1,2,3] row_mask:0xf bank_mask:0xc
    v_add_f32_dpp v105, v6, v6 row_ror:2 row_mask:0xf bank_mask:0xf
    v_cmp_u_f32 vcc, v72, v6
    v_add_f32_dpp v74, v78, v74 quad_perm:[0,1,2,3] row_mask:0xf bank_mask:0xc
    v_add_f32_dpp v75, v79, v75 quad_perm:[0,1,2,3] row_mask:0xf bank_mask:0xc
    s_cbranch_vccnz Lp_97
    v_add_f32_dpp v105, v105, v105 row_ror:4 row_mask:0xf bank_mask:0xf
    v_permlane32_swap_b32 v72, v73
    s_nop 0
    v_add_f32_dpp v105, v105, v105 row_ror:8 row_mask:0xf bank_mask:0xf
    v_permlane32_swap_b32 v74, v75
    v_mul_f32 v105, 0x3acccccd, v105
    v_add_f32 v72, v72, v73
    s_nop 0
    v_mov_b32_dpp v106, v105 quad_perm:[0,0,2,2] row_mask:0xf bank_mask:0xf
    v_add_f32 v74, v74, v75
    v_mov_b32_dpp v107, v105 quad_perm:[1,1,3,3] row_mask:0xf bank_mask:0xf
    s_nop 0
    v_permlane16_swap_b32 v72, v74
    v_fma_f32 v107, -v106, v106, v107
    v_add_f32 v104, v72, v74
    v_max_f32 v107, 0, v107
    s_nop 0
    v_add_f32_dpp v104, v104, v104 row_ror:8 row_mask:0xf bank_mask:0xf
    v_mul_f32 v107, 0x3f800054, v107
    v_add_f32 v107, 0x2edbe6ff, v107
    v_rsq_f32 v107, v107
    v_fma_f32 v104, -v106, v25, v104
    v_fma_f32 v104, v104, v107, v26
    v_mul_f32 v108, v104, v104
    v_cmp_u_f32 vcc, v104, v105
    v_mul_f32 v108, 0xbdd2d3e8, v108
    v_add_f32 v108, 0xc0135761, v108
    s_cbranch_vccnz Lp_97
Lok_103:
    v_mul_f32 v108, v108, v104
    v_exp_f32 v109, v108
    s_nop 0
    v_add_f32 v109, 1.0, v109
    v_rcp_f32 v109, v109
    s_nop 0
    v_mul_f32 v104, v104, v109
    v_cvt_pk_bf16_f32 v104, v104, v104
    v_and_b32 v112, v104, v28
    v_and_b32 v113, v104, v29
    v_and_b32 v114, v104, v30
    v_and_b32 v115, v104, v31
    s_nop 1
    v_mfma_f32_16x16x32_bf16 v[72:75], v[112:115], a[208:211], 0
    v_mfma_f32_16x16x32_bf16 v[76:79], v[112:115], a[212:215], 0
    v_mfma_f32_16x16x32_bf16 v[80:83], v[112:115], a[216:219], 0
    v_mfma_f32_16x16x32_bf16 v[84:87], v[112:115], a[220:223], 0
    s_nop 4
    v_pk_add_f32 v[72:73], v[72:73], v[74:75]
    v_add_f32 v116, v72, v73
    v_pk_add_f32 v[76:77], v[76:77], v[78:79]
    v_add_f32 v117, v76, v77
    v_pk_add_f32 v[80:81], v[80:81], v[82:83]
    v_add_f32 v118, v80, v81
    v_pk_add_f32 v[84:85], v[84:85], v[86:87]
    v_add_f32 v119, v84, v85
    ds_write_b128 v10, v[116:119] offset:2048
    s_cmp_lg_u32 s7, 0
    s_waitcnt lgkmcnt(0)
    s_barrier
    s_cbranch_scc1 Lsk_105
    ds_read2st64_b32 v[72:73], v23 offset0:8 offset1:9
    ds_read2st64_b32 v[74:75], v23 offset0:10 offset1:11
    ds_read2st64_b32 v[76:77], v23 offset0:12 offset1:13
    ds_read2st64_b32 v[78:79], v23 offset0:14 offset1:15
    s_waitcnt lgkmcnt(2)
    v_pk_add_f32 v[72:73], v[72:73], v[74:75]
    s_waitcnt lgkmcnt(0)
    v_pk_add_f32 v[76:77], v[76:77], v[78:79]
    v_pk_add_f32 v[72:73], v[72:73], v[76:77]
    v_add_f32 v72, v72, v73
    v_cvt_f64_f32 v[74:75], v72
    v_add_f64 v[74:75], v[74:75], s[0:1]
    v_add_u32 v75, 0xbf480000, v75
    buffer_atomic_add_x2 v[74:75], v12, s[16:19], 0 offen offset:64 sc1
    buffer_atomic_add_x2 v[74:75], v12, s[16:19], s66 offen offset:64 sc1
Lsk_105:
LS15_106:
    s_mov_b32 s68, 0xe8000
    buffer_load_dwordx4 a[248:251], v4, s[16:19], s68 offen sc1
    buffer_load_dwordx4 a[244:247], v3, s[16:19], s68 offen sc1
    s_nop 0
    s_waitcnt vmcnt(0)
    v_accvgpr_read_b32 v72, a244
    v_accvgpr_read_b32 v73, a245
    v_accvgpr_read_b32 v74, a246
    v_accvgpr_read_b32 v75, a247
    v_accvgpr_read_b32 v76, a248
    v_accvgpr_read_b32 v77, a249
    v_accvgpr_read_b32 v78, a250
    v_accvgpr_read_b32 v79, a251
    v_add_f32_dpp v72, v76, v72 quad_perm:[0,1,2,3] row_mask:0xf bank_mask:0xc
    v_add_f32_dpp v73, v77, v73 quad_perm:[0,1,2,3] row_mask:0xf bank_mask:0xc
    v_add_f32_dpp v74, v78, v74 quad_perm:[0,1,2,3] row_mask:0xf bank_mask:0xc
    v_add_f32_dpp v75, v79, v75 quad_perm:[0,1,2,3] row_mask:0xf bank_mask:0xc
    v_permlane32_swap_b32 v72, v73
    s_nop 0
    v_permlane32_swap_b32 v74, v75
    v_add_f32 v72, v72, v73
    v_add_f32 v74, v74, v75
    s_nop 1
    v_permlane16_swap_b32 v72, v74
    v_add_f32_e64 v24, v72, v74
    s_nop 1
    v_add_f32_dpp v24, v24, v24 row_ror:8 row_mask:0xf bank_mask:0xf
    s_mov_b32 s64, 0x74000
    s_add_u32 s65, s79, 0x74000
    buffer_load_dwordx2 a[232:233], v11, s[16:19], s64 offen sc1
    buffer_load_dwordx4 a[236:239], v9, s[16:19], s64 offen sc1
Lp_107:
    buffer_load_dwordx4 v[76:79], v4, s[16:19], s64 offen sc1
    buffer_load_dwordx4 v[72:75], v3, s[16:19], s64 offen sc1
    s_sub_u32 s69, s69, 1
    s_cbranch_scc1 Lgive_109
    s_waitcnt vmcnt(1)
    v_pk_add_f32 v[80:81], v[76:77], v[78:79]
    s_nop 0
    s_nop 0
    v_add_f32_dpp v6, v80, v81 quad_perm:[0,1,2,3] row_mask:0xf bank_mask:0x3
    s_waitcnt vmcnt(0)
    v_add_f32_dpp v72, v76, v72 quad_perm:[0,1,2,3] row_mask:0xf bank_mask:0xc
    v_add_f32_dpp v73, v77, v73 quad_perm:[0,1,2,3] row_mask:0xf bank_mask:0xc
    v_add_f32_dpp v105, v6, v6 row_ror:2 row_mask:0xf bank_mask:0xf
    v_cmp_u_f32 vcc, v72, v6
    v_add_f32_dpp v74, v78, v74 quad_perm:[0,1,2,3] row_mask:0xf bank_mask:0xc
    v_add_f32_dpp v75, v79, v75 quad_perm:[0,1,2,3] row_mask:0xf bank_mask:0xc
    s_cbranch_vccnz Lp_107
    v_add_f32_dpp v105, v105, v105 row_ror:4 row_mask:0xf bank_mask:0xf
    v_permlane32_swap_b32 v72, v73
    s_nop 0
    v_add_f32_dpp v105, v105, v105 row_ror:8 row_mask:0xf bank_mask:0xf
    v_permlane32_swap_b32 v74, v75
    v_mul_f32 v105, 0x3acccccd, v105
    v_add_f32 v72, v72, v73
    s_nop 0
    v_mov_b32_dpp v106, v105 quad_perm:[0,0,2,2] row_mask:0xf bank_mask:0xf
    v_add_f32 v74, v74, v75
    v_mov_b32_dpp v107, v105 quad_perm:[1,1,3,3] row_mask:0xf bank_mask:0xf
    s_nop 0
    v_permlane16_swap_b32 v72, v74
    v_fma_f32 v107, -v106, v106, v107
    v_add_f32 v104, v72, v74
    v_max_f32 v107, 0, v107
    s_nop 0
    v_add_f32_dpp v104, v104, v104 row_ror:8 row_mask:0xf bank_mask:0xf
    v_add_f32 v107, 0x3727c5ac, v107
    v_rsq_f32 v107, v107
    v_fma_f32 v104, -v106, v24, v104
    v_mul_f32 v104, v104, v107
    v_cvt_pk_bf16_f32 v107, v104, v104
    v_cmp_u_f32 vcc, v104, v105
    s_cbranch_vccnz Lp_107
Lok_108:
    ds_write_b16 v16, v107
    s_waitcnt lgkmcnt(0)
    s_barrier
LS18_110:
    s_mov_b64 exec, s[80:81]
    ds_read_b128 v[48:51], v17
    s_mov_b64 exec, s[82:83]
    ds_read_b128 v[52:55], v17
    s_mov_b64 exec, s[84:85]
    ds_read_b128 v[56:59], v17
    s_mov_b64 exec, s[86:87]
    ds_read_b128 v[60:63], v17
    s_mov_b64 exec, -1
    s_nop 0
    s_waitcnt lgkmcnt(3)
    v_mfma_f32_16x16x32_bf16 v[72:75], a[0:3], v[48:51], 0
    v_mfma_f32_16x16x32_bf16 v[76:79], a[32:35], v[48:51], 0
    s_waitcnt lgkmcnt(2)
    v_mfma_f32_16x16x32_bf16 v[72:75], a[8:11], v[52:55], v[72:75]
    v_mfma_f32_16x16x32_bf16 v[76:79], a[40:43], v[52:55], v[76:79]
    s_waitcnt lgkmcnt(1)
    v_mfma_f32_16x16x32_bf16 v[72:75], a[16:19], v[56:59], v[72:75]
    v_mfma_f32_16x16x32_bf16 v[76:79], a[48:51], v[56:59], v[76:79]
    s_nop 0
    s_waitcnt lgkmcnt(0)
    v_mfma_f32_16x16x32_bf16 v[72:75], a[24:27], v[60:63], v[72:75]
    v_mfma_f32_16x16x32_bf16 v[76:79], a[56:59], v[60:63], v[76:79]
    v_mfma_f32_16x16x32_bf16 v[80:83], a[64:67], v[48:51], 0
    v_mfma_f32_16x16x32_bf16 v[84:87], a[96:99], v[48:51], 0
    v_mfma_f32_16x16x32_bf16 v[80:83], a[72:75], v[52:55], v[80:83]
    v_mfma_f32_16x16x32_bf16 v[84:87], a[104:107], v[52:55], v[84:87]
    v_mfma_f32_16x16x32_bf16 v[80:83], a[80:83], v[56:59], v[80:83]
    v_mfma_f32_16x16x32_bf16 v[84:87], a[112:115], v[56:59], v[84:87]
    v_mfma_f32_16x16x32_bf16 v[80:83], a[88:91], v[60:63], v[80:83]
    v_add_f32_dpp v104, v73, v72 row_ror:12 row_mask:0xf bank_mask:0x1
    v_add_f32_dpp v104, v74, v104 row_ror:8 row_mask:0xf bank_mask:0x1
    v_mfma_f32_16x16x32_bf16 v[84:87], a[120:123], v[60:63], v[84:87]
    v_add_f32_dpp v104, v75, v104 row_ror:4 row_mask:0xf bank_mask:0x1
    v_add_f32_dpp v104, v76, v77 row_ror:4 row_mask:0xf bank_mask:0x2
    v_mfma_f32_16x16x32_bf16 v[88:91], a[4:7], v[48:51], 0
    v_add_f32_dpp v104, v78, v104 row_ror:12 row_mask:0xf bank_mask:0x2
    v_add_f32_dpp v104, v79, v104 row_ror:8 row_mask:0xf bank_mask:0x2
    v_mfma_f32_16x16x32_bf16 v[92:95], a[36:39], v[48:51], 0
    v_add_f32_dpp v104, v80, v82 row_ror:8 row_mask:0xf bank_mask:0x4
    v_add_f32_dpp v104, v81, v104 row_ror:4 row_mask:0xf bank_mask:0x4
    v_mfma_f32_16x16x32_bf16 v[88:91], a[12:15], v[52:55], v[88:91]
    v_add_f32_dpp v104, v83, v104 row_ror:12 row_mask:0xf bank_mask:0x4
    v_add_f32_dpp v104, v84, v87 row_ror:12 row_mask:0xf bank_mask:0x8
    v_mfma_f32_16x16x32_bf16 v[92:95], a[44:47], v[52:55], v[92:95]
    v_add_f32_dpp v104, v85, v104 row_ror:8 row_mask:0xf bank_mask:0x8
    v_add_f32_dpp v104, v86, v104 row_ror:4 row_mask:0xf bank_mask:0x8
    v_mfma_f32_16x16x32_bf16 v[88:91], a[20:23], v[56:59], v[88:91]
    v_mfma_f32_16x16x32_bf16 v[92:95], a[52:55], v[56:59], v[92:95]
    v_mfma_f32_16x16x32_bf16 v[88:91], a[28:31], v[60:63], v[88:91]
    v_mfma_f32_16x16x32_bf16 v[92:95], a[60:63], v[60:63], v[92:95]
    v_mfma_f32_16x16x32_bf16 v[96:99], a[68:71], v[48:51], 0
    v_mfma_f32_16x16x32_bf16 v[100:103], a[100:103], v[48:51], 0
    v_mfma_f32_16x16x32_bf16 v[96:99], a[76:79], v[52:55], v[96:99]
    v_mfma_f32_16x16x32_bf16 v[100:103], a[108:111], v[52:55], v[100:103]
    v_mfma_f32_16x16x32_bf16 v[96:99], a[84:87], v[56:59], v[96:99]
    v_mfma_f32_16x16x32_bf16 v[100:103], a[116:119], v[56:59], v[100:103]
    v_mfma_f32_16x16x32_bf16 v[96:99], a[92:95], v[60:63], v[96:99]
    v_add_f32_dpp v105, v89, v88 row_ror:12 row_mask:0xf bank_mask:0x1
    v_add_f32_dpp v105, v90, v105 row_ror:8 row_mask:0xf bank_mask:0x1
    v_mfma_f32_16x16x32_bf16 v[100:103], a[124:127], v[60:63], v[100:103]
    v_add_f32_dpp v105, v91, v105 row_ror:4 row_mask:0xf bank_mask:0x1
    v_add_f32_dpp v105, v92, v93 row_ror:4 row_mask:0xf bank_mask:0x2
    v_add_f32_dpp v105, v94, v105 row_ror:12 row_mask:0xf bank_mask:0x2
    v_add_f32_dpp v105, v95, v105 row_ror:8 row_mask:0xf bank_mask:0x2
    s_nop 0
    v_add_f32_dpp v105, v96, v98 row_ror:8 row_mask:0xf bank_mask:0x4
    v_add_f32_dpp v105, v97, v105 row_ror:4 row_mask:0xf bank_mask:0x4
    v_add_f32_dpp v105, v99, v105 row_ror:12 row_mask:0xf bank_mask:0x4
    v_add_f32_dpp v105, v100, v103 row_ror:12 row_mask:0xf bank_mask:0x8
    v_add_f32_dpp v105, v101, v105 row_ror:8 row_mask:0xf bank_mask:0x8
    v_add_f32_dpp v105, v102, v105 row_ror:4 row_mask:0xf bank_mask:0x8
    v_max_f32 v106, v104, v105
    s_nop 1
    v_max_f32_dpp v106, v106, v106 row_ror:1 row_mask:0xf bank_mask:0xf
    s_nop 1
    v_max_f32_dpp v106, v106, v106 row_ror:2 row_mask:0xf bank_mask:0xf
    s_nop 1
    v_max_f32_dpp v106, v106, v106 row_ror:4 row_mask:0xf bank_mask:0xf
    s_nop 1
    v_max_f32_dpp v106, v106, v106 row_ror:8 row_mask:0xf bank_mask:0xf
    s_nop 1
    v_max_f32_dpp v106, v106, v106 row_bcast:15 row_mask:0xa bank_mask:0xf
    s_nop 1
    v_max_f32_dpp v106, v106, v106 row_bcast:31 row_mask:0xc bank_mask:0xf
    v_mul_f32_e64 v106, v106, v27
    s_nop 0
    v_readlane_b32 s72, v106, 63
    s_nop 1
    v_fma_f32 v104, v104, v27, -s72
    v_fma_f32 v105, v105, v27, -s72
    v_exp_f32 v104, v104
    v_exp_f32 v105, v105
    s_nop 0
    v_cvt_pk_bf16_f32 v108, v104, v105
LS19_111:
    s_nop 1
    v_mov_b32_dpp v64, v108 row_newbcast:0 row_mask:0xf bank_mask:0x1
    v_mov_b32_dpp v65, v108 row_newbcast:0 row_mask:0xf bank_mask:0x2
    v_mov_b32_dpp v66, v108 row_newbcast:0 row_mask:0xf bank_mask:0x4
    v_mov_b32_dpp v67, v108 row_newbcast:0 row_mask:0xf bank_mask:0x8
    s_nop 1
    v_mfma_f32_16x16x32_bf16 v[72:75], v[64:67], v[126:129], 0
    v_mov_b32_dpp v68, v108 row_newbcast:1 row_mask:0xf bank_mask:0x1
    v_mov_b32_dpp v69, v108 row_newbcast:1 row_mask:0xf bank_mask:0x2
    v_mov_b32_dpp v70, v108 row_newbcast:1 row_mask:0xf bank_mask:0x4
    v_mfma_f32_16x16x32_bf16 v[76:79], v[64:67], v[130:133], 0
    v_mov_b32_dpp v71, v108 row_newbcast:1 row_mask:0xf bank_mask:0x8
    v_lshlrev_b32 v107, 16, v108
    v_and_b32 v104, 0xffff0000, v108
    v_mfma_f32_16x16x32_bf16 v[72:75], v[68:71], v[134:137], v[72:75]
    v_mov_b32_dpp v64, v108 row_newbcast:2 row_mask:0xf bank_mask:0x1
    v_mov_b32_dpp v65, v108 row_newbcast:2 row_mask:0xf bank_mask:0x2
    v_mov_b32_dpp v66, v108 row_newbcast:2 row_mask:0xf bank_mask:0x4
    v_mfma_f32_16x16x32_bf16 v[76:79], v[68:71], v[138:141], v[76:79]
    v_mov_b32_dpp v67, v108 row_newbcast:2 row_mask:0xf bank_mask:0x8
    v_add_f32 v107, v107, v104
    s_nop 1
    v_add_f32_dpp v107, v107, v107 row_ror:1 row_mask:0xf bank_mask:0xf
    v_mfma_f32_16x16x32_bf16 v[72:75], v[64:67], v[142:145], v[72:75]
    v_mov_b32_dpp v68, v108 row_newbcast:3 row_mask:0xf bank_mask:0x1
    v_mov_b32_dpp v69, v108 row_newbcast:3 row_mask:0xf bank_mask:0x2
    v_mov_b32_dpp v70, v108 row_newbcast:3 row_mask:0xf bank_mask:0x4
    v_mfma_f32_16x16x32_bf16 v[76:79], v[64:67], v[146:149], v[76:79]
    v_mov_b32_dpp v71, v108 row_newbcast:3 row_mask:0xf bank_mask:0x8
    v_add_f32_dpp v107, v107, v107 row_ror:2 row_mask:0xf bank_mask:0xf
    s_nop 0
    v_mfma_f32_16x16x32_bf16 v[72:75], v[68:71], v[150:153], v[72:75]
    v_mov_b32_dpp v64, v108 row_newbcast:4 row_mask:0xf bank_mask:0x1
    v_mov_b32_dpp v65, v108 row_newbcast:4 row_mask:0xf bank_mask:0x2
    v_mov_b32_dpp v66, v108 row_newbcast:4 row_mask:0xf bank_mask:0x4
    v_mfma_f32_16x16x32_bf16 v[76:79], v[68:71], v[154:157], v[76:79]
    v_mov_b32_dpp v67, v108 row_newbcast:4 row_mask:0xf bank_mask:0x8
    v_add_f32_dpp v107, v107, v107 row_ror:4 row_mask:0xf bank_mask:0xf
    s_nop 0
    v_mfma_f32_16x16x32_bf16 v[72:75], v[64:67], v[158:161], v[72:75]
    v_mov_b32_dpp v68, v108 row_newbcast:5 row_mask:0xf bank_mask:0x1
    v_mov_b32_dpp v69, v108 row_newbcast:5 row_mask:0xf bank_mask:0x2
    v_mov_b32_dpp v70, v108 row_newbcast:5 row_mask:0xf bank_mask:0x4
    v_mfma_f32_16x16x32_bf16 v[76:79], v[64:67], v[162:165], v[76:79]
    v_mov_b32_dpp v71, v108 row_newbcast:5 row_mask:0xf bank_mask:0x8
    v_add_f32_dpp v107, v107, v107 row_ror:8 row_mask:0xf bank_mask:0xf
    s_nop 0
    v_mfma_f32_16x16x32_bf16 v[72:75], v[68:71], v[166:169], v[72:75]
    v_mov_b32_dpp v64, v108 row_newbcast:6 row_mask:0xf bank_mask:0x1
    v_mov_b32_dpp v65, v108 row_newbcast:6 row_mask:0xf bank_mask:0x2
    v_mov_b32_dpp v66, v108 row_newbcast:6 row_mask:0xf bank_mask:0x4
    v_mfma_f32_16x16x32_bf16 v[76:79], v[68:71], v[170:173], v[76:79]
    v_mov_b32_dpp v67, v108 row_newbcast:6 row_mask:0xf bank_mask:0x8
    v_add_f32_dpp v107, v107, v107 row_bcast:15 row_mask:0xa bank_mask:0xf
    s_nop 0
    v_mfma_f32_16x16x32_bf16 v[72:75], v[64:67], v[174:177], v[72:75]
    v_mov_b32_dpp v68, v108 row_newbcast:7 row_mask:0xf bank_mask:0x1
    v_mov_b32_dpp v69, v108 row_newbcast:7 row_mask:0xf bank_mask:0x2
    v_mov_b32_dpp v70, v108 row_newbcast:7 row_mask:0xf bank_mask:0x4
    v_mfma_f32_16x16x32_bf16 v[76:79], v[64:67], v[178:181], v[76:79]
    v_mov_b32_dpp v71, v108 row_newbcast:7 row_mask:0xf bank_mask:0x8
    v_add_f32_dpp v107, v107, v107 row_bcast:31 row_mask:0xc bank_mask:0xf
    s_nop 0
    v_mfma_f32_16x16x32_bf16 v[72:75], v[68:71], v[182:185], v[72:75]
    v_mov_b32_dpp v64, v108 row_newbcast:8 row_mask:0xf bank_mask:0x1
    v_mov_b32_dpp v65, v108 row_newbcast:8 row_mask:0xf bank_mask:0x2
    v_mov_b32_dpp v66, v108 row_newbcast:8 row_mask:0xf bank_mask:0x4
    v_mfma_f32_16x16x32_bf16 v[76:79], v[68:71], v[186:189], v[76:79]
    v_mov_b32_dpp v67, v108 row_newbcast:8 row_mask:0xf bank_mask:0x8
    ds_write_b64 v18, v[106:107]
    s_nop 0
    v_mfma_f32_16x16x32_bf16 v[72:75], v[64:67], v[190:193], v[72:75]
    v_mov_b32_dpp v68, v108 row_newbcast:9 row_mask:0xf bank_mask:0x1
    v_mov_b32_dpp v69, v108 row_newbcast:9 row_mask:0xf bank_mask:0x2
    v_mov_b32_dpp v70, v108 row_newbcast:9 row_mask:0xf bank_mask:0x4
    v_mfma_f32_16x16x32_bf16 v[76:79], v[64:67], v[194:197], v[76:79]
    v_mov_b32_dpp v71, v108 row_newbcast:9 row_mask:0xf bank_mask:0x8
    s_waitcnt lgkmcnt(0)
    s_barrier
    ds_read_b64 v[110:111], v19
    v_mfma_f32_16x16x32_bf16 v[72:75], v[68:71], v[198:201], v[72:75]
    v_mov_b32_dpp v64, v108 row_newbcast:10 row_mask:0xf bank_mask:0x1
    v_mov_b32_dpp v65, v108 row_newbcast:10 row_mask:0xf bank_mask:0x2
    v_mov_b32_dpp v66, v108 row_newbcast:10 row_mask:0xf bank_mask:0x4
    v_mfma_f32_16x16x32_bf16 v[76:79], v[68:71], v[202:205], v[76:79]
    v_mov_b32_dpp v67, v108 row_newbcast:10 row_mask:0xf bank_mask:0x8
    s_nop 0
    s_nop 0
    v_mfma_f32_16x16x32_bf16 v[72:75], v[64:67], v[206:209], v[72:75]
    v_mov_b32_dpp v68, v108 row_newbcast:11 row_mask:0xf bank_mask:0x1
    v_mov_b32_dpp v69, v108 row_newbcast:11 row_mask:0xf bank_mask:0x2
    v_mov_b32_dpp v70, v108 row_newbcast:11 row_mask:0xf bank_mask:0x4
    v_mfma_f32_16x16x32_bf16 v[76:79], v[64:67], v[210:213], v[76:79]
    v_mov_b32_dpp v71, v108 row_newbcast:11 row_mask:0xf bank_mask:0x8
    s_waitcnt lgkmcnt(0)
    s_nop 0
    v_mfma_f32_16x16x32_bf16 v[72:75], v[68:71], v[214:217], v[72:75]
    v_mov_b32_dpp v64, v108 row_newbcast:12 row_mask:0xf bank_mask:0x1
    v_mov_b32_dpp v65, v108 row_newbcast:12 row_mask:0xf bank_mask:0x2
    v_mov_b32_dpp v66, v108 row_newbcast:12 row_mask:0xf bank_mask:0x4
    v_mfma_f32_16x16x32_bf16 v[76:79], v[68:71], v[218:221], v[76:79]
    v_mov_b32_dpp v67, v108 row_newbcast:12 row_mask:0xf bank_mask:0x8
    v_max_f32_dpp v112, v110, v110 quad_perm:[1,0,3,2] row_mask:0xf bank_mask:0xf
    s_nop 0
    v_mfma_f32_16x16x32_bf16 v[72:75], v[64:67], v[222:225], v[72:75]
    v_mov_b32_dpp v68, v108 row_newbcast:13 row_mask:0xf bank_mask:0x1
    v_mov_b32_dpp v69, v108 row_newbcast:13 row_mask:0xf bank_mask:0x2
    v_mov_b32_dpp v70, v108 row_newbcast:13 row_mask:0xf bank_mask:0x4
    v_mfma_f32_16x16x32_bf16 v[76:79], v[64:67], v[226:229], v[76:79]
    v_mov_b32_dpp v71, v108 row_newbcast:13 row_mask:0xf bank_mask:0x8
    v_max_f32_dpp v112, v112, v112 quad_perm:[2,3,0,1] row_mask:0xf bank_mask:0xf
    v_sub_f32 v109, v110, v112
    v_mfma_f32_16x16x32_bf16 v[72:75], v[68:71], v[230:233], v[72:75]
    v_mov_b32_dpp v64, v108 row_newbcast:14 row_mask:0xf bank_mask:0x1
    v_mov_b32_dpp v65, v108 row_newbcast:14 row_mask:0xf bank_mask:0x2
    v_mov_b32_dpp v66, v108 row_newbcast:14 row_mask:0xf bank_mask:0x4
    v_mfma_f32_16x16x32_bf16 v[76:79], v[68:71], v[234:237], v[76:79]
    v_mov_b32_dpp v67, v108 row_newbcast:14 row_mask:0xf bank_mask:0x8
    v_exp_f32 v109, v109
    s_nop 0
    v_mfma_f32_16x16x32_bf16 v[72:75], v[64:67], v[238:241], v[72:75]
    v_mov_b32_dpp v68, v108 row_newbcast:15 row_mask:0xf bank_mask:0x1
    v_mov_b32_dpp v69, v108 row_newbcast:15 row_mask:0xf bank_mask:0x2
    v_mov_b32_dpp v70, v108 row_newbcast:15 row_mask:0xf bank_mask:0x4
    v_mfma_f32_16x16x32_bf16 v[76:79], v[64:67], v[242:245], v[76:79]
    v_mov_b32_dpp v71, v108 row_newbcast:15 row_mask:0xf bank_mask:0x8
    v_mul_f32 v113, v109, v111
    s_nop 0
    v_mfma_f32_16x16x32_bf16 v[72:75], v[68:71], v[246:249], v[72:75]
    v_mfma_f32_16x16x32_bf16 v[76:79], v[68:71], v[250:253], v[76:79]
    v_add_f32_dpp v113, v113, v113 quad_perm:[1,0,3,2] row_mask:0xf bank_mask:0xf
    s_nop 1
    v_add_f32_dpp v113, v113, v113 quad_perm:[2,3,0,1] row_mask:0xf bank_mask:0xf
    s_cmp_lg_u32 s7, 0
    s_cbranch_scc1 Lnos_112
    s_mov_b64 exec, 0x10001
    buffer_store_dwordx2 v[112:113], v1, s[16:19], s65 offen
    s_mov_b64 exec, -1
Lnos_112:
LS20_113:
    s_nop 0
    v_mul_f32_dpp v104, v109, v72 quad_perm:[0,0,0,0] row_mask:0xf bank_mask:0xf
    v_mul_f32_dpp v105, v109, v76 quad_perm:[0,0,0,0] row_mask:0xf bank_mask:0xf
    ds_write2_b32 v20, v104, v105 offset0:0 offset1:64
    s_cmp_lg_u32 s7, 0
    s_waitcnt lgkmcnt(0)
    s_barrier
    s_cbranch_scc1 Lsk_114
    ds_read2_b64 v[72:75], v21 offset0:0 offset1:64
    ds_read2_b64 v[76:79], v21 offset0:128 offset1:192
    s_waitcnt lgkmcnt(1)
    v_pk_add_f32 v[72:73], v[72:73], v[74:75]
    s_waitcnt lgkmcnt(0)
    v_pk_add_f32 v[76:77], v[76:77], v[78:79]
    v_pk_add_f32 v[72:73], v[72:73], v[76:77]
    v_cvt_pk_bf16_f32 v72, v72, v73
    buffer_store_dword v72, v8, s[16:19], s64 offen
Lsk_114:
LS21_115:
Lp_116:
    buffer_load_dwordx2 v[108:109], v11, s[16:19], s64 offen sc1
    buffer_load_dwordx4 v[104:107], v9, s[16:19], s64 offen sc1
    s_sub_u32 s69, s69, 1
    s_cbranch_scc1 Lgive_118
    s_waitcnt vmcnt(0)
    v_max3_u32 v113, v104, v105, v106
    v_max3_u32 v113, v113, v107, v108
    v_mfma_f32_16x16x32_bf16 v[72:75], v[104:107], a[160:163], 0
    v_max_u32_e64 v113, v113, v109
    v_cmp_eq_u32 vcc, -1, v113
    v_max_f32_dpp v110, v108, v108 quad_perm:[1,0,3,2] row_mask:0xf bank_mask:0xf
    s_cbranch_vccnz Lp_116
Lok_117:
    v_mfma_f32_16x16x32_bf16 v[76:79], v[104:107], a[164:167], 0
    v_max_f32_dpp v110, v110, v110 quad_perm:[2,3,0,1] row_mask:0xf bank_mask:0xf
    v_mfma_f32_16x16x32_bf16 v[80:83], v[104:107], a[168:171], 0
    s_nop 0
    v_max_f32_dpp v110, v110, v110 row_half_mirror row_mask:0xf bank_mask:0xf
    v_mfma_f32_16x16x32_bf16 v[84:87], v[104:107], a[172:175], 0
    v_sub_f32 v111, v108, v110
    v_exp_f32 v111, v111
    v_mfma_f32_16x16x32_bf16 v[88:91], v[104:107], a[176:179], 0
    v_mul_f32 v112, v111, v109
    v_mfma_f32_16x16x32_bf16 v[92:95], v[104:107], a[180:183], 0
    s_nop 0
    v_add_f32_dpp v112, v112, v112 quad_perm:[1,0,3,2] row_mask:0xf bank_mask:0xf
    v_mfma_f32_16x16x32_bf16 v[96:99], v[104:107], a[184:187], 0
    s_nop 0
    v_add_f32_dpp v112, v112, v112 quad_perm:[2,3,0,1] row_mask:0xf bank_mask:0xf
    v_mfma_f32_16x16x32_bf16 v[100:103], v[104:107], a[188:191], 0
    s_nop 0
    v_add_f32_dpp v112, v112, v112 row_half_mirror row_mask:0xf bank_mask:0xf
    v_rcp_f32 v112, v112
    s_nop 0
    v_mul_f32 v111, v111, v112
    s_nop 0
    s_nop 0
    v_mul_f32_dpp v116, v111, v72 row_newbcast:0 row_mask:0xf bank_mask:0xf
    v_mul_f32_dpp v117, v111, v76 row_newbcast:0 row_mask:0xf bank_mask:0xf
    v_mul_f32_dpp v118, v111, v80 row_newbcast:0 row_mask:0xf bank_mask:0xf
    v_mul_f32_dpp v119, v111, v84 row_newbcast:0 row_mask:0xf bank_mask:0xf
    v_mul_f32_dpp v120, v111, v88 row_newbcast:0 row_mask:0xf bank_mask:0xf
    v_mul_f32_dpp v121, v111, v92 row_newbcast:0 row_mask:0xf bank_mask:0xf
    v_mul_f32_dpp v122, v111, v96 row_newbcast:0 row_mask:0xf bank_mask:0xf
    v_mul_f32_dpp v123, v111, v100 row_newbcast:0 row_mask:0xf bank_mask:0xf
    v_fmac_f32_dpp v116, v111, v73 row_newbcast:1 row_mask:0xf bank_mask:0xf
    v_fmac_f32_dpp v117, v111, v77 row_newbcast:1 row_mask:0xf bank_mask:0xf
    v_fmac_f32_dpp v118, v111, v81 row_newbcast:1 row_mask:0xf bank_mask:0xf
    v_fmac_f32_dpp v119, v111, v85 row_newbcast:1 row_mask:0xf bank_mask:0xf
    v_fmac_f32_dpp v120, v111, v89 row_newbcast:1 row_mask:0xf bank_mask:0xf
    v_fmac_f32_dpp v121, v111, v93 row_newbcast:1 row_mask:0xf bank_mask:0xf
    v_fmac_f32_dpp v122, v111, v97 row_newbcast:1 row_mask:0xf bank_mask:0xf
    v_fmac_f32_dpp v123, v111, v101 row_newbcast:1 row_mask:0xf bank_mask:0xf
    v_fmac_f32_dpp v116, v111, v74 row_newbcast:2 row_mask:0xf bank_mask:0xf
    v_fmac_f32_dpp v117, v111, v78 row_newbcast:2 row_mask:0xf bank_mask:0xf
    v_fmac_f32_dpp v118, v111, v82 row_newbcast:2 row_mask:0xf bank_mask:0xf
    v_fmac_f32_dpp v119, v111, v86 row_newbcast:2 row_mask:0xf bank_mask:0xf
    v_fmac_f32_dpp v120, v111, v90 row_newbcast:2 row_mask:0xf bank_mask:0xf
    v_fmac_f32_dpp v121, v111, v94 row_newbcast:2 row_mask:0xf bank_mask:0xf
    v_fmac_f32_dpp v122, v111, v98 row_newbcast:2 row_mask:0xf bank_mask:0xf
    v_fmac_f32_dpp v123, v111, v102 row_newbcast:2 row_mask:0xf bank_mask:0xf
    v_fmac_f32_dpp v116, v111, v75 row_newbcast:3 row_mask:0xf bank_mask:0xf
    v_fmac_f32_dpp v117, v111, v79 row_newbcast:3 row_mask:0xf bank_mask:0xf
    v_fmac_f32_dpp v118, v111, v83 row_newbcast:3 row_mask:0xf bank_mask:0xf
    v_fmac_f32_dpp v119, v111, v87 row_newbcast:3 row_mask:0xf bank_mask:0xf
    v_fmac_f32_dpp v120, v111, v91 row_newbcast:3 row_mask:0xf bank_mask:0xf
    v_fmac_f32_dpp v121, v111, v95 row_newbcast:3 row_mask:0xf bank_mask:0xf
    v_fmac_f32_dpp v122, v111, v99 row_newbcast:3 row_mask:0xf bank_mask:0xf
    v_fmac_f32_dpp v123, v111, v103 row_newbcast:3 row_mask:0xf bank_mask:0xf
    v_permlane16_swap_b32 v116, v120
    v_permlane16_swap_b32 v117, v121
    v_permlane16_swap_b32 v118, v122
    v_permlane16_swap_b32 v119, v123
    v_pk_add_f32 v[116:117], v[116:117], v[120:121]
    v_pk_add_f32 v[118:119], v[118:119], v[122:123]
    ds_write_b128 v22, v[116:119] offset:0
    s_cmp_lg_u32 s7, 0
    s_waitcnt lgkmcnt(0)
    s_barrier
    s_cbranch_scc1 Lsk_119
    ds_read2st64_b32 v[72:73], v23 offset0:0 offset1:1
    ds_read2st64_b32 v[74:75], v23 offset0:2 offset1:3
    ds_read2st64_b32 v[76:77], v23 offset0:4 offset1:5
    ds_read2st64_b32 v[78:79], v23 offset0:6 offset1:7
    s_waitcnt lgkmcnt(2)
    v_pk_add_f32 v[72:73], v[72:73], v[74:75]
    s_waitcnt lgkmcnt(0)
    v_pk_add_f32 v[76:77], v[76:77], v[78:79]
    v_pk_add_f32 v[72:73], v[72:73], v[76:77]
    v_add_f32 v72, v72, v73
    v_cvt_f64_f32 v[74:75], v72
    v_add_f64 v[74:75], v[74:75], s[0:1]
    v_add_u32 v75, 0xbf480000, v75
    buffer_atomic_add_x2 v[74:75], v12, s[16:19], 0 offen offset:128 sc1
    buffer_atomic_add_x2 v[74:75], v12, s[16:19], s66 offen offset:128 sc1
Lsk_119:
LS22_120:
Lp_121:
    buffer_load_dwordx4 v[76:79], v7, s[16:19], s64 offen sc1
    buffer_load_dwordx4 v[72:75], v15, s[16:19], s64 offen sc1
    s_sub_u32 s69, s69, 1
    s_cbranch_scc1 Lgive_123
    s_waitcnt vmcnt(1)
    v_pk_add_f32 v[80:81], v[76:77], v[78:79]
    s_nop 1
    v_add_f32_dpp v6, v80, v81 quad_perm:[0,1,2,3] row_mask:0xf bank_mask:0x3
    s_waitcnt vmcnt(0)
    v_add_f32_dpp v72, v76, v72 quad_perm:[0,1,2,3] row_mask:0xf bank_mask:0xc
    v_add_f32_dpp v73, v77, v73 quad_perm:[0,1,2,3] row_mask:0xf bank_mask:0xc
    v_add_f32_dpp v105, v6, v6 row_ror:2 row_mask:0xf bank_mask:0xf
    v_cmp_u_f32 vcc, v72, v6
    v_add_f32_dpp v74, v78, v74 quad_perm:[0,1,2,3] row_mask:0xf bank_mask:0xc
    v_add_f32_dpp v75, v79, v75 quad_perm:[0,1,2,3] row_mask:0xf bank_mask:0xc
    s_cbranch_vccnz Lp_121
    v_add_f32_dpp v105, v105, v105 row_ror:4 row_mask:0xf bank_mask:0xf
    v_permlane32_swap_b32 v72, v73
    s_nop 0
    v_add_f32_dpp v105, v105, v105 row_ror:8 row_mask:0xf bank_mask:0xf
    v_permlane32_swap_b32 v74, v75
    v_mul_f32 v105, 0x3acccccd, v105
    v_add_f32 v72, v72, v73
    s_nop 0
    v_mov_b32_dpp v106, v105 quad_perm:[0,0,2,2] row_mask:0xf bank_mask:0xf
    v_add_f32 v74, v74, v75
    v_mov_b32_dpp v107, v105 quad_perm:[1,1,3,3] row_mask:0xf bank_mask:0xf
    s_nop 0
    v_permlane16_swap_b32 v72, v74
    v_fma_f32 v107, -v106, v106, v107
    v_add_f32 v104, v72, v74
    v_max_f32 v107, 0, v107
    s_nop 0
    v_add_f32_dpp v104, v104, v104 row_ror:8 row_mask:0xf bank_mask:0xf
    v_mul_f32 v107, 0x3f800054, v107
    v_add_f32 v107, 0x2edbe6ff, v107
    v_rsq_f32 v107, v107
    v_fma_f32 v104, -v106, v25, v104
    v_fma_f32 v104, v104, v107, v26
    v_mul_f32 v108, v104, v104
    v_cmp_u_f32 vcc, v104, v105
    v_mul_f32 v108, 0xbdd2d3e8, v108
    v_add_f32 v108, 0xc0135761, v108
    s_cbranch_vccnz Lp_121
Lok_122:
    v_mul_f32 v108, v108, v104
    v_exp_f32 v109, v108
    s_nop 0
    v_add_f32 v109, 1.0, v109
    v_rcp_f32 v109, v109
    s_nop 0
    v_mul_f32 v104, v104, v109
    v_cvt_pk_bf16_f32 v104, v104, v104
    v_and_b32 v112, v104, v28
    v_and_b32 v113, v104, v29
    v_and_b32 v114, v104, v30
    v_and_b32 v115, v104, v31
    s_nop 1
    v_mfma_f32_16x16x32_bf16 v[72:75], v[112:115], a[208:211], 0
    v_mfma_f32_16x16x32_bf16 v[76:79], v[112:115], a[212:215], 0
    v_mfma_f32_16x16x32_bf16 v[80:83], v[112:115], a[216:219], 0
    v_mfma_f32_16x16x32_bf16 v[84:87], v[112:115], a[220:223], 0
    s_nop 4
    v_pk_add_f32 v[72:73], v[72:73], v[74:75]
    v_add_f32 v116, v72, v73
    v_pk_add_f32 v[76:77], v[76:77], v[78:79]
    v_add_f32 v117, v76, v77
    v_pk_add_f32 v[80:81], v[80:81], v[82:83]
    v_add_f32 v118, v80, v81
    v_pk_add_f32 v[84:85], v[84:85], v[86:87]
    v_add_f32_e64 v119, v84, v85
    ds_write_b128 v10, v[116:119] offset:2048
    s_cmp_lg_u32 s7, 0
    s_waitcnt lgkmcnt(0)
    s_barrier
    s_cbranch_scc1 Lsk_124
    ds_read2st64_b32 v[72:73], v23 offset0:8 offset1:9
    ds_read2st64_b32 v[74:75], v23 offset0:10 offset1:11
    ds_read2st64_b32 v[76:77], v23 offset0:12 offset1:13
    ds_read2st64_b32 v[78:79], v23 offset0:14 offset1:15
    s_nop 0
    s_waitcnt lgkmcnt(2)
    v_pk_add_f32 v[72:73], v[72:73], v[74:75]
    s_waitcnt lgkmcnt(0)
    v_pk_add_f32 v[76:77], v[76:77], v[78:79]
    v_pk_add_f32 v[72:73], v[72:73], v[76:77]
    v_add_f32 v72, v72, v73
    v_cvt_f64_f32_e64 v[74:75], v72
    v_add_f64 v[74:75], v[74:75], s[0:1]
    v_add_u32 v75, 0xbf480000, v75
    buffer_atomic_add_x2 v[74:75], v12, s[16:19], 0 offen offset:192 sc1
    buffer_atomic_add_x2 v[74:75], v12, s[16:19], s66 offen offset:192 sc1
Lsk_124:
LS25_125:
    s_endpgm
Lretry_70:
    s_cmp_eq_u32 s69, 0
    s_cbranch_scc1 Lfok_68
    s_sub_u32 s69, s69, 1
    s_branch Lfp_67
Lfp_67:
    buffer_load_dword v114, v118, s[52:55], s77 offen sc1
    s_waitcnt vmcnt(0)
    s_branch Lfc_69
Lqp_73:
    buffer_load_dwordx4 v[76:79], v4, s[16:19], 0 offen sc1
    buffer_load_dwordx4 v[72:75], v3, s[16:19], 0 offen sc1
    s_waitcnt vmcnt(0)
    s_branch Lq_72
Lretry_75:
    s_cmp_eq_u32 s69, 0
    s_cbranch_scc1 Lok_74
    s_sub_u32 s69, s69, 1
    s_branch Lqp_73
Lretry_91:
    s_cmp_eq_u32 s69, 0
    s_cbranch_scc1 Lfok_89
    s_sub_u32 s69, s69, 1
    s_branch Lfp_88
Lfp_88:
    buffer_load_dword v114, v119, s[52:55], 0 offen sc1
    s_waitcnt vmcnt(0)
    s_branch Lfc_90
Lgive_94:
    s_mov_b32 s69, 0
    s_waitcnt vmcnt(0)
    s_branch Lok_93
Lgive_102:
    s_mov_b32 s69, 0
    s_waitcnt vmcnt(0)
    s_branch Lok_101
Lgive_104:
    s_mov_b32 s69, 0
    s_waitcnt vmcnt(0)
    s_branch Lok_103
Lgive_109:
    s_mov_b32 s69, 0
    s_waitcnt vmcnt(0)
    s_branch Lok_108
Lgive_118:
    s_mov_b32 s69, 0
    s_waitcnt vmcnt(0)
    s_branch Lok_117
Lgive_123:
    s_mov_b32 s69, 0
    s_waitcnt vmcnt(0)
    s_branch Lok_122
    s_nop 0
    s_nop 0
    s_nop 0
    s_nop 0
    s_nop 0
    s_nop 0
    s_nop 0
    s_nop 0
    s_nop 0
    s_nop 0
    s_nop 0
    s_nop 0
    s_nop 0
    s_nop 0
    s_nop 0
    s_nop 0
    s_nop 0
    s_nop 0
    s_nop 0
    s_nop 0
    s_nop 0
    s_nop 0
    s_nop 0
    s_nop 0
    s_nop 0
    s_nop 0
    s_nop 0
    s_nop 0
    s_nop 0
    s_nop 0
    s_nop 0
    s_nop 0
    s_nop 0
    s_nop 0
    s_nop 0
    s_nop 0
    s_nop 0
    s_nop 0
    s_nop 0
    s_nop 0
    s_nop 0
    s_nop 0
    s_nop 0
    s_nop 0
    s_nop 0
    s_nop 0
    s_nop 0
    s_nop 0
    s_nop 0
    s_nop 0
    s_nop 0
    s_nop 0
    s_nop 0
    s_nop 0
    s_nop 0
    s_nop 0
    s_nop 0
    s_nop 0
    s_nop 0
    s_nop 0
    s_nop 0
    s_nop 0
    s_nop 0
    s_nop 0
    s_nop 0
    s_nop 0
    s_nop 0
    s_nop 0
    s_nop 0
    s_nop 0
    s_nop 0
    s_nop 0
    s_nop 0
    s_nop 0
    s_nop 0
    s_nop 0
    s_nop 0
    s_nop 0
    s_nop 0
    s_nop 0
    s_nop 0
    s_nop 0
    s_nop 0
    s_nop 0
    s_nop 0
    s_nop 0
    s_nop 0
    s_nop 0
    s_nop 0
    s_nop 0
    s_nop 0
    s_nop 0
    s_nop 0
    s_nop 0
    s_nop 0
    s_nop 0
    s_nop 0
    s_nop 0
    s_nop 0
    s_nop 0
    s_nop 0
    s_nop 0
    s_nop 0
    s_nop 0
    s_nop 0
    s_nop 0
    s_nop 0
    s_nop 0
    s_nop 0
    s_nop 0
    s_nop 0
    s_nop 0
    s_nop 0
    s_nop 0
    s_nop 0
    s_nop 0
    s_nop 0
    s_nop 0
    s_nop 0
    s_nop 0
    s_nop 0
    s_nop 0
    s_nop 0
    s_nop 0
    s_nop 0
    s_nop 0
    s_nop 0
    s_nop 0
    s_nop 0
    s_nop 0
    s_nop 0
    s_nop 0
    s_nop 0
    s_nop 0
    s_nop 0
    s_nop 0
    s_nop 0
    s_nop 0
    s_nop 0
    s_nop 0
    s_nop 0
    s_nop 0
    s_nop 0
    s_nop 0
    s_nop 0
    s_nop 0
    s_nop 0
    s_nop 0
    s_nop 0
    s_nop 0
    s_nop 0
    s_nop 0
    s_nop 0
    s_nop 0
    s_nop 0
    s_nop 0
    s_nop 0
    s_nop 0
    s_nop 0
    s_nop 0
    s_nop 0
    s_nop 0
    s_nop 0
    s_nop 0
    s_nop 0
    s_nop 0
    s_nop 0
    s_nop 0
    s_nop 0
    s_nop 0
    s_nop 0
    s_nop 0
    s_nop 0
    s_nop 0
    s_nop 0
    s_nop 0
    s_nop 0
    s_nop 0
    s_nop 0
    s_nop 0
    s_nop 0
    s_nop 0
    s_nop 0
    s_nop 0
    s_nop 0
    s_nop 0
    s_nop 0
    s_nop 0
    s_nop 0
    s_nop 0
    s_nop 0
    s_nop 0
    s_nop 0
    s_nop 0
    s_nop 0
    s_nop 0
    s_nop 0
    s_nop 0
    s_nop 0
    s_nop 0
    s_nop 0
    s_nop 0
    s_nop 0
    s_nop 0
    s_nop 0
    s_nop 0
    s_nop 0
    s_nop 0
    s_nop 0
    s_nop 0
    s_nop 0
    s_nop 0
    s_nop 0
    s_nop 0
    s_nop 0
    s_nop 0
    s_nop 0
    s_nop 0
    s_nop 0
    s_nop 0
    s_nop 0
    s_nop 0
    s_nop 0
    s_nop 0
    s_nop 0
L_roleC:
    s_mov_b32 s10, 0x2000000
    s_mov_b32 s11, 0x00020000
    s_mov_b32 s14, 0x2000000
    s_mov_b32 s15, 0x00020000
    s_mov_b32 s18, 0x10000000
    s_mov_b32 s19, 0x00020000
    s_mov_b32 s34, 0x21c000
    s_mov_b32 s35, 0x00020000
    s_mov_b32 s38, 0xd80
    s_mov_b32 s39, 0x00020000
    s_mov_b32 s42, 0x21c000
    s_mov_b32 s43, 0x00020000
    s_mov_b32 s46, 0x500
    s_mov_b32 s47, 0x00020000
    s_mov_b32 s50, 0x500
    s_mov_b32 s51, 0x00020000
    s_mov_b32 s54, 0x100
    s_mov_b32 s55, 0x00020000
    v_mov_b32 v100, -1
    v_mov_b32 v101, -1
    v_mov_b32 v102, -1
    v_mov_b32 v103, -1
    s_mul_i32 s76, s3, 0xc000
    s_lshl_b32 s68, s5, 0
    s_xor_b32 s68, s68, s75
    s_lshl_b32 s56, s68, 20
    s_lshl_b32 s68, s6, 17
    s_add_u32 s56, s56, s68
    s_lshl_b32 s68, s6, 14
    s_add_u32 s56, s56, s68
    s_lshl_b32 s68, s7, 12
    s_add_u32 s56, s56, s68
    s_xor_b32 s57, s56, 0x80000
    s_xor_b32 s58, s56, 0x40000
    s_xor_b32 s59, s56, 0xc0000
    s_xor_b32 s60, s56, 0x20000
    s_xor_b32 s61, s56, 0xa0000
    s_xor_b32 s62, s56, 0x60000
    s_xor_b32 s63, s56, 0xe0000
    v_bfe_u32 v121, v0, 2, 2
    v_lshlrev_b32 v124, 8, v121
    v_lshl_add_u32 v124, v115, 6, v124
    v_and_b32 v121, 3, v0
    v_lshl_add_u32 v124, v121, 4, v124
    v_and_b32 v120, 1, v115
    v_lshrrev_b32_e64 v123, 1, v115
    v_lshl_add_u32 v123, v120, 1, v123
    s_mov_b32 s70, 0x05040100
    s_mov_b32 s71, 0x07060302
    v_lshrrev_b32 v120, 2, v114
    v_mul_u32_u24 v2, 1536, v120
    v_and_b32 v120, 3, v114
    v_lshl_add_u32 v2, v120, 5, v2
    v_lshl_add_u32 v2, v115, 4, v2
    s_mul_i32 s67, s7, 6144
    s_lshl_b32 s68, s73, 7
    s_add_u32 s68, s68, s76
    s_add_u32 s67, s67, s68
    v_add_u32 v2, s67, v2
    s_mov_b32 exec_hi, 0
    buffer_store_dwordx4 v[100:103], v2, s[16:19], 0 offen sc1
    s_mov_b64 exec, -1
    s_lshl_b32 s67, s7, 4
    v_add_u32 v120, s67, v114
    v_subrev_u32 v121, 27, v120
    v_cmp_le_u32 vcc, 27, v120
    s_nop 1
    v_cndmask_b32 v121, v120, v121, vcc
    v_cndmask_b32 v122, 0, 4, vcc
    v_mul_u32_u24 v14, 37, v121
    v_lshrrev_b32 v14, 8, v14
    v_add_u32 v122, v122, v14
    v_mul_u32_u24 v14, 7, v14
    v_sub_u32 v121, v121, v14
    v_mul_u32_u24 v14, 1536, v122
    v_lshl_add_u32 v14, v121, 4, v14
    s_add_u32 s68, s68, 0x8000
    v_add_u32_e64 v14, s68, v14
    v_mov_b32 v121, 0x80000000
    v_cmp_gt_u32 vcc, 54, v120
    s_nop 1
    v_cndmask_b32 v14, v121, v14, vcc
    s_mov_b32 s68, 0xe8000
    s_mov_b64 exec, 0xffff
    buffer_store_dwordx4 v[100:103], v14, s[16:19], s68 offen sc1
    s_mov_b64 exec, -1
    s_mov_b64 s[8:9], s[82:83]
    s_mov_b64 s[12:13], s[84:85]
    s_getreg_b32 s75, hwreg(HW_REG_XCC_ID)
    s_and_b32 s75, s75, 15
    s_or_b32 s75, s75, 0x80
    buffer_load_dwordx4 a[0:3], v124, s[8:11], s56 offen offset:0 nt
    buffer_load_dwordx4 a[4:7], v124, s[8:11], s56 offen offset:1024 nt
    buffer_load_dwordx4 a[8:11], v124, s[8:11], s56 offen offset:2048 nt
    buffer_load_dwordx4 a[12:15], v124, s[8:11], s56 offen offset:3072 nt
    buffer_load_dwordx4 a[16:19], v124, s[8:11], s57 offen offset:0 nt
    buffer_load_dwordx4 a[20:23], v124, s[8:11], s57 offen offset:1024 nt
    s_mov_b64 s[32:33], s[92:93]
    s_mov_b64 s[36:37], s[94:95]
    s_load_dwordx2 s[52:53], s[0:1], 88
    s_load_dwordx2 s[44:45], s[0:1], 72
    s_load_dwordx2 s[40:41], s[0:1], 64
    s_load_dwordx2 s[48:49], s[0:1], 80
    s_lshl_b32 s67, s7, 9
    s_add_u32 s67, s67, s76
    s_add_u32 s67, s67, 0xb000
    s_lshl_b32 s68, s73, 2
    s_add_u32 s77, s67, s68
    v_mov_b32 v5, s77
    s_add_u32 s77, s77, 48
    v_writelane_b32 v5, s77, 0
    s_add_u32 s74, s73, 8
    v_bfe_u32 v120, v0, 3, 1
    v_lshlrev_b32_e64 v13, 10, v120
    v_lshl_add_u32 v13, v115, 8, v13
    v_and_b32 v120, 7, v0
    v_lshl_add_u32 v13, v120, 3, v13
    s_lshl_b32 s67, s74, 11
    s_add_u32 s67, s67, 0x60000
    s_lshr_b32 s68, s74, 2
    s_lshl_b32 s68, s68, 13
    s_add_u32 s67, s67, s68
    v_add_u32 v13, s67, v13
    v_mov_b32 v36, 0x3f803f80
    v_mov_b32 v37, 0x3f803f80
    v_mov_b32 v38, 0x3f803f80
    v_mov_b32 v39, 0x3f803f80
    v_mul_u32_u24 v25, 27648, v115
    v_lshl_add_u32 v25, v114, 3, v25
    s_waitcnt vmcnt(16)
LS8_126:
    v_mov_b32 v120, 0
    v_mov_b32_e64 v121, 0
    v_mov_b32 v122, 0x3f803f80
    v_dot2_f32_bf16 v120, v40, v122, v120
    v_dot2_f32_bf16 v121, v40, v40, v121
    v_dot2_f32_bf16 v120, v41, v122, v120
    v_dot2_f32_bf16 v121, v41, v41, v121
    v_dot2_f32_bf16 v120, v42, v122, v120
    v_dot2_f32_bf16 v121, v42, v42, v121
    v_dot2_f32_bf16 v120, v43, v122, v120
    v_dot2_f32_bf16 v121, v43, v43, v121
    v_dot2_f32_bf16 v120, v44, v122, v120
    v_dot2_f32_bf16 v121, v44, v44, v121
    v_dot2_f32_bf16 v120, v45, v122, v120
    v_dot2_f32_bf16 v121, v45, v45, v121
    v_dot2_f32_bf16 v120, v46, v122, v120
    v_dot2_f32_bf16 v121, v46, v46, v121
    v_dot2_f32_bf16 v120, v47, v122, v120
    v_dot2_f32_bf16 v121, v47, v47, v121
    v_lshlrev_b32_e64 v40, 16, v32
    v_and_b32 v41, 0xffff0000, v32
    v_lshlrev_b32 v42, 16, v33
    v_and_b32 v43, 0xffff0000, v33
    v_permlane32_swap_b32 v120, v121
    v_add_f32 v120, v120, v121
    s_nop 1
    v_add_f32_dpp v120, v120, v120 row_ror:1 row_mask:0xf bank_mask:0xf
    s_nop 1
    v_add_f32_dpp v120, v120, v120 row_ror:2 row_mask:0xf bank_mask:0xf
    s_nop 1
    v_add_f32_dpp v120, v120, v120 row_ror:4 row_mask:0xf bank_mask:0xf
    s_nop 1
    v_add_f32_dpp v120, v120, v120 row_ror:8 row_mask:0xf bank_mask:0xf
    s_nop 1
    v_add_f32_dpp v120, v120, v120 row_bcast:15 row_mask:0xa bank_mask:0xf
    v_mul_f32 v120, 0x3acccccd, v120
    s_nop 0
    v_readlane_b32 s64, v120, 31
    v_readlane_b32 s66, v120, 63
    s_nop 0
    v_mov_b32 v120, s64
    v_mov_b32 v121, s66
    v_fma_f32 v121, -v120, v120, v121
    v_max_f32 v121, 0, v121
    v_add_f32 v121, 0x3727c5ac, v121
    v_rsq_f32 v121, v121
    s_nop 0
    v_mul_f32 v120, v120, v121
    v_fma_f32 v104, v40, v121, -v120
    v_fma_f32 v105, v41, v121, -v120
    v_fma_f32 v106, v42, v121, -v120
    v_fma_f32 v107, v43, v121, -v120
    v_cvt_pk_bf16_f32 v32, v104, v105
    v_cvt_pk_bf16_f32 v33, v106, v107
    s_nop 0
    v_mov_b32_dpp v34, v32 row_ror:8 row_mask:0xf bank_mask:0xf
    v_mov_b32_dpp v35, v33 row_ror:8 row_mask:0xf bank_mask:0xf
    s_waitcnt lgkmcnt(0)
    s_lshl_b32 s67, s74, 6
    v_and_b32 v120, 7, v0
    v_and_b32_e64 v121, 0x30, v0
    v_lshl_add_u32 v120, v120, 1, v121
    buffer_load_ushort a226, v120, s[44:47], s67 offen
    buffer_load_ushort a227, v120, s[20:23], s67 offen
    buffer_load_dwordx4 a[24:27], v124, s[8:11], s57 offen offset:2048 nt
    buffer_load_dwordx4 a[28:31], v124, s[8:11], s57 offen offset:3072 nt
    buffer_load_dwordx4 a[32:35], v124, s[8:11], s58 offen offset:0 nt
    buffer_load_dwordx4 a[36:39], v124, s[8:11], s58 offen offset:1024 nt
LS29_127:
    s_nop 0
    s_waitcnt vmcnt(14)
LS9_128:
    v_perm_b32 v160, v132, v128, s70
    v_perm_b32 v161, v140, v136, s70
    v_perm_b32 v162, v148, v144, s70
    v_perm_b32 v163, v156, v152, s70
    s_nop 0
    s_nop 0
    v_mfma_f32_16x16x32_bf16 v[72:75], v[32:35], v[160:163], 0
    v_perm_b32 v176, v134, v130, s70
    v_perm_b32 v177, v142, v138, s70
    v_perm_b32 v178, v150, v146, s70
    v_perm_b32 v179, v158, v154, s70
    s_nop 1
    v_mfma_f32_16x16x32_bf16 v[88:91], v[32:35], v[176:179], 0
    v_perm_b32 v164, v132, v128, s71
    v_perm_b32 v165, v140, v136, s71
    v_perm_b32 v166, v148, v144, s71
    v_perm_b32 v167, v156, v152, s71
    s_nop 1
    v_mfma_f32_16x16x32_bf16 v[76:79], v[32:35], v[164:167], 0
    v_perm_b32 v180, v134, v130, s71
    v_perm_b32 v181, v142, v138, s71
    v_perm_b32 v182, v150, v146, s71
    v_perm_b32 v183, v158, v154, s71
    s_nop 0
    s_nop 0
    v_mfma_f32_16x16x32_bf16 v[92:95], v[32:35], v[180:183], 0
    v_perm_b32 v168, v133, v129, s70
    v_perm_b32 v169, v141, v137, s70
    v_perm_b32 v170, v149, v145, s70
    v_perm_b32 v171, v157, v153, s70
    s_nop 1
    v_mfma_f32_16x16x32_bf16 v[80:83], v[32:35], v[168:171], 0
    v_perm_b32 v184, v135, v131, s70
    v_perm_b32 v185, v143, v139, s70
    v_perm_b32 v186, v151, v147, s70
    v_perm_b32 v187, v159, v155, s70
    s_nop 1
    v_mfma_f32_16x16x32_bf16 v[96:99], v[32:35], v[184:187], 0
    v_perm_b32 v172, v133, v129, s71
    v_perm_b32 v173, v141, v137, s71
    v_perm_b32 v174, v149, v145, s71
    v_perm_b32 v175, v157, v153, s71
    s_nop 0
    s_nop 0
    v_mfma_f32_16x16x32_bf16 v[84:87], v[32:35], v[172:175], 0
    v_perm_b32 v188, v135, v131, s71
    v_perm_b32 v189, v143, v139, s71
    v_perm_b32 v190, v151, v147, s71
    v_perm_b32 v191, v159, v155, s71
    s_nop 1
    v_mfma_f32_16x16x32_bf16 v[100:103], v[32:35], v[188:191], 0
    s_mov_b32 exec_hi, 0
    v_mov_b32_dpp v72, v88 quad_perm:[0,1,2,3] row_mask:0x2 bank_mask:0xf
    v_mov_b32_dpp v73, v76 quad_perm:[0,1,2,3] row_mask:0x1 bank_mask:0xf
    v_mov_b32_dpp v73, v92 quad_perm:[0,1,2,3] row_mask:0x2 bank_mask:0xf
    v_mov_b32_dpp v74, v80 quad_perm:[0,1,2,3] row_mask:0x1 bank_mask:0xf
    v_mov_b32_dpp v74, v96 quad_perm:[0,1,2,3] row_mask:0x2 bank_mask:0xf
    v_mov_b32_dpp v75, v84 quad_perm:[0,1,2,3] row_mask:0x1 bank_mask:0xf
    s_nop 0
    v_mov_b32_dpp v75, v100 quad_perm:[0,1,2,3] row_mask:0x2 bank_mask:0xf
    s_waitcnt vmcnt(12)
    buffer_store_dwordx4 v[72:75], v2, s[16:19], 0 offen sc1
    s_mov_b64 exec, -1
LS2_129:
    s_lshl_b32 s67, s3, 5
    s_add_u32 s67, s67, s4
    s_lshl_b32 s68, s7, 8
    s_add_u32 s67, s67, s68
    v_mov_b32 v120, s75
    v_mov_b32_e64 v121, s67
    s_waitcnt vmcnt(13)
    s_waitcnt lgkmcnt(0)
    s_mov_b32 s0, 0
    s_mov_b32 s1, 0x41b80000
    s_barrier
    s_mov_b64 exec, 1
    buffer_store_byte v120, v121, s[52:55], 0 offen sc1
    s_mov_b64 exec, -1
LS1_130:
    buffer_load_dwordx4 a[40:43], v124, s[8:11], s58 offen offset:2048 nt
    buffer_load_dwordx4 a[44:47], v124, s[8:11], s58 offen offset:3072 nt
    s_mov_b32 s68, 0xe8000
    v_mfma_f32_16x16x32_bf16 v[72:75], v[36:39], v[160:163], 0
    v_mfma_f32_16x16x32_bf16 v[88:91], v[36:39], v[176:179], 0
    v_mfma_f32_16x16x32_bf16 v[76:79], v[36:39], v[164:167], 0
    v_mfma_f32_16x16x32_bf16 v[92:95], v[36:39], v[180:183], 0
    v_mfma_f32_16x16x32_bf16 v[80:83], v[36:39], v[168:171], 0
    v_mfma_f32_16x16x32_bf16 v[96:99], v[36:39], v[184:187], 0
    v_mfma_f32_16x16x32_bf16 v[84:87], v[36:39], v[172:175], 0
    v_mfma_f32_16x16x32_bf16 v[100:103], v[36:39], v[188:191], 0
    s_mov_b32 exec_hi, 0
    s_nop 0
    v_mov_b32_dpp v72, v88 quad_perm:[0,1,2,3] row_mask:0x2 bank_mask:0xf
    v_mov_b32_dpp v73, v76 quad_perm:[0,1,2,3] row_mask:0x1 bank_mask:0xf
    v_mov_b32_dpp v73, v92 quad_perm:[0,1,2,3] row_mask:0x2 bank_mask:0xf
    v_mov_b32_dpp v74, v80 quad_perm:[0,1,2,3] row_mask:0x1 bank_mask:0xf
    v_mov_b32_dpp v74, v96 quad_perm:[0,1,2,3] row_mask:0x2 bank_mask:0xf
    v_mov_b32_dpp v75, v84 quad_perm:[0,1,2,3] row_mask:0x1 bank_mask:0xf
    v_mov_b32_dpp v75, v100 quad_perm:[0,1,2,3] row_mask:0x2 bank_mask:0xf
    buffer_store_dwordx4 v[72:75], v2, s[16:19], s68 offen sc1
    s_mov_b64 exec, -1
    buffer_load_dwordx4 a[48:51], v124, s[8:11], s59 offen offset:0 nt
    s_waitcnt vmcnt(6)
    v_accvgpr_write_b32 a128, v160
    v_accvgpr_write_b32 a129, v161
    v_accvgpr_write_b32 a130, v162
    v_accvgpr_write_b32 a131, v163
    v_accvgpr_write_b32 a132, v164
    v_accvgpr_write_b32 a133, v165
    v_accvgpr_write_b32 a134, v166
    v_accvgpr_write_b32 a135, v167
    v_accvgpr_write_b32 a136, v168
    v_accvgpr_write_b32 a137, v169
    v_accvgpr_write_b32 a138, v170
    v_accvgpr_write_b32 a139, v171
    v_accvgpr_write_b32 a140, v172
    v_accvgpr_write_b32 a141, v173
    v_accvgpr_write_b32 a142, v174
    v_accvgpr_write_b32 a143, v175
    v_accvgpr_write_b32 a144, v176
    v_accvgpr_write_b32 a145, v177
    v_accvgpr_write_b32 a146, v178
    v_accvgpr_write_b32 a147, v179
    v_accvgpr_write_b32 a148, v180
    v_accvgpr_write_b32 a149, v181
    v_accvgpr_write_b32 a150, v182
    v_accvgpr_write_b32 a151, v183
    v_accvgpr_write_b32 a152, v184
    v_accvgpr_write_b32 a153, v185
    v_accvgpr_write_b32 a154, v186
    v_accvgpr_write_b32 a155, v187
    v_accvgpr_write_b32 a156, v188
    v_accvgpr_write_b32 a157, v189
    v_accvgpr_write_b32 a158, v190
    v_accvgpr_write_b32 a159, v191
    buffer_load_dwordx4 a[52:55], v124, s[8:11], s59 offen offset:1024 nt
    s_nop 0
    s_waitcnt vmcnt(6)
    s_mov_b32 s69, 100000
    s_mov_b32 s80, 0x11111111
    s_mov_b32 s81, 0x11111111
    s_mov_b32 s82, 0x22222222
    s_mov_b32 s83, 0x22222222
    s_mov_b32 s84, 0x44444444
    s_mov_b32 s85, 0x44444444
    s_mov_b32 s86, 0x88888888
    s_mov_b32 s87, 0x88888888
    s_mov_b32 s88, 0x01010101
    s_mov_b32 s89, 0x01010101
    s_lshl_b32 s67, s5, 3
    s_add_u32 s67, s67, s6
    s_lshl_b32 s68, s67, 8
    s_add_u32 s68, s68, s76
    s_add_u32 s68, s68, 0x6000
    s_lshl_b32 s68, s5, 11
    s_lshl_b32 s77, s6, 4
    s_add_u32 s68, s68, s77
    s_add_u32 s68, s68, s76
    s_add_u32 s68, s68, 0x6000
    v_lshrrev_b32 v120, 2, v0
    v_lshlrev_b32 v8, 7, v120
    v_and_b32 v120, 3, v0
    v_lshl_add_u32 v8, v120, 2, v8
    v_add_u32 v8, s68, v8
    s_lshl_b32 s79, s5, 9
    s_lshl_b32 s68, s6, 3
    s_add_u32 s79, s79, s68
    s_add_u32 s79, s79, s76
    s_add_u32 s79, s79, 0xb800
    s_mul_i32 s67, s5, 6144
    s_mul_i32 s68, s7, 1536
    s_add_u32 s67, s67, s68
    s_add_u32 s67, s67, s76
    v_add_u32 v3, s67, v1
    v_lshlrev_b32 v120, 7, v115
    v_sub_u32 v4, v3, v120
    v_add_u32 v4, 896, v4
    v_mov_b32 v121, 0x80000000
    v_and_b32 v120, 1, v114
    v_mul_u32_u24 v120, 48, v120
    v_lshrrev_b32 v122, 1, v114
    v_lshl_add_u32 v120, v122, 4, v120
    s_lshl_b32 s67, s7, 9
    s_add_u32 s67, s67, s76
    s_add_u32 s67, s67, 0xb000
    v_add_u32 v120, s67, v120
    v_cmp_gt_u32 vcc, 6, v114
    s_nop 1
    v_cndmask_b32 v120, v121, v120, vcc
    v_cmp_gt_u32 vcc, 8, v114
    s_nop 1
    v_cndmask_b32 v4, v4, v120, vcc
    v_mov_b32 v6, 0
    v_and_b32 v120, 7, v0
    v_lshl_add_u32 v120, v120, 2, v123
    s_lshl_b32 s67, s7, 5
    v_add_u32 v120, s67, v120
    v_lshlrev_b32 v16, 1, v120
    v_lshrrev_b32 v120, 2, v0
    v_lshlrev_b32 v17, 4, v120
    v_lshlrev_b32 v18, 3, v0
    v_add_u32 v18, 512, v18
    s_lshl_b32 s67, s7, 3
    s_add_u32 s67, s67, 256
    v_writelane_b32 v18, s67, 63
    v_add_u32 v120, s7, v0
    v_and_b32 v120, 3, v120
    v_lshlrev_b32 v120, 3, v120
    v_add_u32 v19, 256, v120
    s_lshl_b32 s67, s7, 9
    s_add_u32 s67, s67, 1024
    v_lshlrev_b32 v20, 2, v0
    v_add_u32 v20, s67, v20
    v_lshlrev_b32 v21, 3, v0
    v_add_u32 v21, 1024, v21
    v_mov_b32 v27, 0x3e0293ee
    v_mov_b32 v48, 0
    v_mov_b32 v49, 0
    v_mov_b32 v50, 0
    v_mov_b32 v51, 0
    v_mov_b32 v52, 0
    v_mov_b32 v53, 0
    v_mov_b32 v54, 0
    v_mov_b32 v55, 0
    v_mov_b32 v56, 0
    v_mov_b32 v57, 0
    v_mov_b32 v58, 0
    v_mov_b32 v59, 0
    v_mov_b32 v60, 0
    v_mov_b32 v61, 0
    v_mov_b32 v62, 0
    v_mov_b32 v63, 0
    v_mov_b32 v64, 0
    v_mov_b32 v65, 0
    v_mov_b32 v66, 0
    v_mov_b32 v67, 0
    v_mov_b32 v68, 0
    v_mov_b32 v69, 0
    v_mov_b32 v70, 0
    v_mov_b32 v71, 0
    v_lshlrev_b32 v119, 2, v0
    v_and_b32 v118, 28, v119
    s_waitcnt vmcnt(11)
    v_mov_b32 v40, 0
    v_mov_b32 v41, 0xc1b80000
    v_accvgpr_read_b32 v121, a227
    s_mov_b32 exec_lo, 0x00ff00ff
    s_mov_b32 exec_hi, 0x00ff00ff
    v_lshlrev_b32 v112, 16, v121
    v_cvt_f64_f32_e64 v[40:41], v112
    v_add_f64 v[40:41], v[40:41], -s[0:1]
    s_mov_b64 exec, -1
    buffer_load_dwordx4 a[56:59], v124, s[8:11], s59 offen offset:2048 nt
    s_waitcnt vmcnt(6)
    buffer_load_dwordx4 a[60:63], v124, s[8:11], s59 offen offset:3072 nt
    s_waitcnt vmcnt(6)
    buffer_load_dwordx4 a[64:67], v124, s[8:11], s60 offen offset:0 nt
    s_waitcnt vmcnt(6)
    buffer_load_dwordx4 a[68:71], v124, s[8:11], s60 offen offset:1024 nt
    s_nop 0
    s_waitcnt vmcnt(6)
    buffer_load_dwordx4 a[72:75], v124, s[8:11], s60 offen offset:2048 nt
    s_waitcnt vmcnt(6)
    buffer_load_dwordx4 a[76:79], v124, s[8:11], s60 offen offset:3072 nt
    s_waitcnt vmcnt(6)
    buffer_load_dwordx4 a[80:83], v124, s[8:11], s61 offen offset:0 nt
    s_waitcnt vmcnt(6)
    buffer_load_dwordx4 a[84:87], v124, s[8:11], s61 offen offset:1024 nt
    s_waitcnt vmcnt(6)
    buffer_load_dwordx4 a[88:91], v124, s[8:11], s61 offen offset:2048 nt
    s_nop 0
    s_waitcnt vmcnt(6)
    buffer_load_dwordx4 a[92:95], v124, s[8:11], s61 offen offset:3072 nt
    s_waitcnt vmcnt(6)
LS3_131:
    s_lshl_b32 s77, s3, 5
    buffer_load_dword v114, v118, s[52:55], s77 offen sc1
    buffer_load_dwordx4 a[96:99], v124, s[8:11], s62 offen offset:0 nt
    s_waitcnt vmcnt(6)
    buffer_load_dwordx4 a[100:103], v124, s[8:11], s62 offen offset:1024 nt
    s_waitcnt vmcnt(6)
    buffer_load_dwordx4 a[104:107], v124, s[8:11], s62 offen offset:2048 nt
    s_nop 0
    s_waitcnt vmcnt(6)
    buffer_load_dwordx4 a[108:111], v124, s[8:11], s62 offen offset:3072 nt
    s_waitcnt vmcnt(6)
    buffer_load_dwordx4 a[112:115], v124, s[8:11], s63 offen offset:0 nt
    s_waitcnt vmcnt(6)
    s_mul_i32 s75, s75, 0x01010101
    s_waitcnt vmcnt(5)
Lfc_134:
    v_and_b32 v120, 0x80808080, v114
    v_cmp_ne_u32 vcc, 0x80808080, v120
    s_cbranch_vccnz Lretry_135
Lfok_133:
    v_and_b32 v114, 0x8f8f8f8f, v114
    v_cmp_ne_u32 vcc, s75, v114
    s_nop 0
    s_or_b32 s78, vcc_lo, vcc_hi
    buffer_load_dwordx4 v[76:79], v4, s[16:19], 0 offen sc1
    buffer_load_dwordx4 v[72:75], v3, s[16:19], 0 offen sc1
LS4_136:
    buffer_load_dwordx4 a[116:119], v124, s[8:11], s63 offen offset:1024 nt
    s_waitcnt vmcnt(8)
    buffer_load_dwordx4 a[120:123], v124, s[8:11], s63 offen offset:2048 nt
    s_waitcnt vmcnt(8)
    buffer_load_dwordx4 a[124:127], v124, s[8:11], s63 offen offset:3072 nt
    s_waitcnt vmcnt(8)
    buffer_load_dwordx4 v[128:131], v1, s[12:15], s56 offen offset:0 nt
    s_waitcnt vmcnt(8)
    s_waitcnt vmcnt(4)
Lq_137:
    v_add_f32_dpp v72, v76, v72 quad_perm:[0,1,2,3] row_mask:0xf bank_mask:0xc
    v_add_f32_dpp v73, v77, v73 quad_perm:[0,1,2,3] row_mask:0xf bank_mask:0xc
    v_add_f32_dpp v74, v78, v74 quad_perm:[0,1,2,3] row_mask:0xf bank_mask:0xc
    v_add_f32_dpp v75, v79, v75 quad_perm:[0,1,2,3] row_mask:0xf bank_mask:0xc
    v_permlane32_swap_b32 v72, v73
    s_nop 0
    v_permlane32_swap_b32 v74, v75
    v_add_f32 v72, v72, v73
    v_add_f32 v74, v74, v75
    s_nop 1
    v_permlane16_swap_b32 v72, v74
    v_add_f32_e64 v104, v72, v74
    s_nop 1
    v_add_f32_dpp v104, v104, v104 row_ror:8 row_mask:0xf bank_mask:0xf
    buffer_load_dwordx4 v[132:135], v1, s[12:15], s56 offen offset:1024 nt
    buffer_load_dwordx4 v[136:139], v1, s[12:15], s56 offen offset:2048 nt
    v_cvt_pk_bf16_f32 v107, v104, v104
    v_cmp_u_f32 vcc, v104, v104
    s_cbranch_vccnz Lretry_140
Lok_139:
    ds_write_b16 v16, v107
    s_waitcnt lgkmcnt(0)
    s_barrier
LS5_141:
    buffer_load_dwordx4 v[140:143], v1, s[12:15], s56 offen offset:3072 nt
    s_waitcnt vmcnt(6)
    buffer_load_dwordx4 v[144:147], v1, s[12:15], s57 offen offset:0 nt
    s_waitcnt vmcnt(6)
    buffer_load_dwordx4 v[148:151], v1, s[12:15], s57 offen offset:1024 nt
    s_waitcnt vmcnt(6)
    buffer_load_dwordx4 v[152:155], v1, s[12:15], s57 offen offset:2048 nt
    s_waitcnt vmcnt(6)
    buffer_load_dwordx4 v[156:159], v1, s[12:15], s57 offen offset:3072 nt
    s_waitcnt vmcnt(6)
    s_waitcnt vmcnt(8)
    s_mov_b64 exec, s[80:81]
    ds_read_b128 v[48:51], v17
    s_mov_b64 exec, s[82:83]
    ds_read_b128 v[52:55], v17
    s_mov_b64 exec, s[84:85]
    ds_read_b128 v[56:59], v17
    s_mov_b64 exec, s[86:87]
    ds_read_b128 v[60:63], v17
    s_mov_b64 exec, -1
    s_waitcnt lgkmcnt(3)
    v_mfma_f32_16x16x32_bf16 v[72:75], a[0:3], v[48:51], 0
    v_mfma_f32_16x16x32_bf16 v[76:79], a[32:35], v[48:51], 0
    v_mfma_f32_16x16x32_bf16 v[80:83], a[64:67], v[48:51], 0
    v_mfma_f32_16x16x32_bf16 v[84:87], a[96:99], v[48:51], 0
    v_mfma_f32_16x16x32_bf16 v[88:91], a[4:7], v[48:51], 0
    v_mfma_f32_16x16x32_bf16 v[92:95], a[36:39], v[48:51], 0
    v_mfma_f32_16x16x32_bf16 v[96:99], a[68:71], v[48:51], 0
    v_mfma_f32_16x16x32_bf16 v[100:103], a[100:103], v[48:51], 0
    buffer_load_dwordx4 v[160:163], v1, s[12:15], s58 offen offset:0 nt
    s_nop 0
    s_waitcnt lgkmcnt(2)
    v_mfma_f32_16x16x32_bf16 v[72:75], a[8:11], v[52:55], v[72:75]
    v_mfma_f32_16x16x32_bf16 v[76:79], a[40:43], v[52:55], v[76:79]
    v_mfma_f32_16x16x32_bf16 v[80:83], a[72:75], v[52:55], v[80:83]
    v_mfma_f32_16x16x32_bf16 v[84:87], a[104:107], v[52:55], v[84:87]
    v_mfma_f32_16x16x32_bf16 v[88:91], a[12:15], v[52:55], v[88:91]
    v_mfma_f32_16x16x32_bf16 v[92:95], a[44:47], v[52:55], v[92:95]
    v_mfma_f32_16x16x32_bf16 v[96:99], a[76:79], v[52:55], v[96:99]
    v_mfma_f32_16x16x32_bf16 v[100:103], a[108:111], v[52:55], v[100:103]
    s_nop 0
    s_waitcnt lgkmcnt(1)
    v_mfma_f32_16x16x32_bf16 v[72:75], a[16:19], v[56:59], v[72:75]
    v_mfma_f32_16x16x32_bf16 v[76:79], a[48:51], v[56:59], v[76:79]
    v_mfma_f32_16x16x32_bf16 v[80:83], a[80:83], v[56:59], v[80:83]
    v_mfma_f32_16x16x32_bf16 v[84:87], a[112:115], v[56:59], v[84:87]
    v_mfma_f32_16x16x32_bf16 v[88:91], a[20:23], v[56:59], v[88:91]
    v_mfma_f32_16x16x32_bf16 v[92:95], a[52:55], v[56:59], v[92:95]
    v_mfma_f32_16x16x32_bf16 v[96:99], a[84:87], v[56:59], v[96:99]
    v_mfma_f32_16x16x32_bf16 v[100:103], a[116:119], v[56:59], v[100:103]
    buffer_load_dwordx4 v[164:167], v1, s[12:15], s58 offen offset:1024 nt
    s_nop 0
    s_waitcnt lgkmcnt(0)
    v_mfma_f32_16x16x32_bf16 v[72:75], a[24:27], v[60:63], v[72:75]
    v_mfma_f32_16x16x32_bf16 v[76:79], a[56:59], v[60:63], v[76:79]
    v_mfma_f32_16x16x32_bf16 v[80:83], a[88:91], v[60:63], v[80:83]
    v_mfma_f32_16x16x32_bf16 v[84:87], a[120:123], v[60:63], v[84:87]
    s_nop 0
    s_nop 3
    v_add_f32_dpp v104, v73, v72 row_ror:12 row_mask:0xf bank_mask:0x1
    v_add_f32_dpp v104, v74, v104 row_ror:8 row_mask:0xf bank_mask:0x1
    v_add_f32_dpp v104, v75, v104 row_ror:4 row_mask:0xf bank_mask:0x1
    v_mfma_f32_16x16x32_bf16 v[88:91], a[28:31], v[60:63], v[88:91]
    v_add_f32_dpp v104, v76, v77 row_ror:4 row_mask:0xf bank_mask:0x2
    v_add_f32_dpp v104, v78, v104 row_ror:12 row_mask:0xf bank_mask:0x2
    v_add_f32_dpp v104, v79, v104 row_ror:8 row_mask:0xf bank_mask:0x2
    v_mfma_f32_16x16x32_bf16 v[92:95], a[60:63], v[60:63], v[92:95]
    v_add_f32_dpp v104, v80, v82 row_ror:8 row_mask:0xf bank_mask:0x4
    v_add_f32_dpp v104, v81, v104 row_ror:4 row_mask:0xf bank_mask:0x4
    v_add_f32_dpp v104, v83, v104 row_ror:12 row_mask:0xf bank_mask:0x4
    v_mfma_f32_16x16x32_bf16 v[96:99], a[92:95], v[60:63], v[96:99]
    v_add_f32_dpp v104, v84, v87 row_ror:12 row_mask:0xf bank_mask:0x8
    v_add_f32_dpp v104, v85, v104 row_ror:8 row_mask:0xf bank_mask:0x8
    v_add_f32_dpp v104, v86, v104 row_ror:4 row_mask:0xf bank_mask:0x8
    v_mfma_f32_16x16x32_bf16 v[100:103], a[124:127], v[60:63], v[100:103]
    v_add_f32_dpp v105, v89, v88 row_ror:12 row_mask:0xf bank_mask:0x1
    v_add_f32_dpp v105, v90, v105 row_ror:8 row_mask:0xf bank_mask:0x1
    v_add_f32_dpp v105, v91, v105 row_ror:4 row_mask:0xf bank_mask:0x1
    v_add_f32_dpp v105, v92, v93 row_ror:4 row_mask:0xf bank_mask:0x2
    v_add_f32_dpp v105, v94, v105 row_ror:12 row_mask:0xf bank_mask:0x2
    v_add_f32_dpp v105, v95, v105 row_ror:8 row_mask:0xf bank_mask:0x2
    v_add_f32_dpp v105, v96, v98 row_ror:8 row_mask:0xf bank_mask:0x4
    v_add_f32_dpp v105, v97, v105 row_ror:4 row_mask:0xf bank_mask:0x4
    v_add_f32_dpp v105, v99, v105 row_ror:12 row_mask:0xf bank_mask:0x4
    v_add_f32_dpp v105, v100, v103 row_ror:12 row_mask:0xf bank_mask:0x8
    v_add_f32_dpp v105, v101, v105 row_ror:8 row_mask:0xf bank_mask:0x8
    v_add_f32_dpp v105, v102, v105 row_ror:4 row_mask:0xf bank_mask:0x8
    v_max_f32 v106, v104, v105
    s_nop 1
    v_max_f32_dpp v106, v106, v106 row_ror:1 row_mask:0xf bank_mask:0xf
    s_nop 1
    v_max_f32_dpp v106, v106, v106 row_ror:2 row_mask:0xf bank_mask:0xf
    s_nop 1
    v_max_f32_dpp v106, v106, v106 row_ror:4 row_mask:0xf bank_mask:0xf
    s_nop 1
    v_max_f32_dpp v106, v106, v106 row_ror:8 row_mask:0xf bank_mask:0xf
    s_nop 1
    v_max_f32_dpp v106, v106, v106 row_bcast:15 row_mask:0xa bank_mask:0xf
    s_nop 0
    s_nop 0
    v_max_f32_dpp v106, v106, v106 row_bcast:31 row_mask:0xc bank_mask:0xf
    buffer_load_dwordx4 v[168:171], v1, s[12:15], s58 offen offset:2048 nt
    v_mul_f32 v106, v106, v27
    s_nop 0
    v_readlane_b32 s72, v106, 63
    s_nop 1
    v_fma_f32 v104, v104, v27, -s72
    v_fma_f32 v105, v105, v27, -s72
    v_exp_f32 v104, v104
    v_exp_f32 v105, v105
    s_nop 0
    v_cvt_pk_bf16_f32 v108, v104, v105
LS6_142:
    buffer_load_dwordx4 v[172:175], v1, s[12:15], s58 offen offset:3072 nt
    buffer_load_dwordx4 v[176:179], v1, s[12:15], s59 offen offset:0 nt
    v_lshlrev_b32 v107, 16, v108
    v_and_b32 v104, 0xffff0000, v108
    v_add_f32 v107, v107, v104
    s_nop 1
    v_add_f32_dpp v107, v107, v107 row_ror:1 row_mask:0xf bank_mask:0xf
    s_nop 1
    v_add_f32_dpp v107, v107, v107 row_ror:2 row_mask:0xf bank_mask:0xf
    s_nop 1
    v_add_f32_dpp v107, v107, v107 row_ror:4 row_mask:0xf bank_mask:0xf
    s_nop 1
    v_add_f32_dpp v107, v107, v107 row_ror:8 row_mask:0xf bank_mask:0xf
    s_nop 1
    v_add_f32_dpp v107, v107, v107 row_bcast:15 row_mask:0xa bank_mask:0xf
    s_nop 1
    v_add_f32_dpp v107, v107, v107 row_bcast:31 row_mask:0xc bank_mask:0xf
    ds_write_b64 v18, v[106:107]
    s_waitcnt lgkmcnt(0)
    s_barrier
    ds_read_b64 v[110:111], v19
    s_waitcnt lgkmcnt(0)
    v_max_f32_dpp v112, v110, v110 quad_perm:[1,0,3,2] row_mask:0xf bank_mask:0xf
    s_nop 1
    v_max_f32_dpp v112, v112, v112 quad_perm:[2,3,0,1] row_mask:0xf bank_mask:0xf
    v_sub_f32 v109, v110, v112
    v_exp_f32 v109, v109
    s_nop 0
    v_mul_f32 v113, v109, v111
    s_nop 1
    v_add_f32_dpp v113, v113, v113 quad_perm:[1,0,3,2] row_mask:0xf bank_mask:0xf
    s_nop 1
    v_add_f32_dpp v113, v113, v113 quad_perm:[2,3,0,1] row_mask:0xf bank_mask:0xf
    s_cmp_lg_u32 s7, 0
    s_cbranch_scc1 Lnos_143
    s_mov_b64 exec, 0x10001
    s_cmp_eq_u32 s78, 0
    s_cbranch_scc1 Lm_144
    buffer_store_dwordx2 v[112:113], v1, s[16:19], s79 offen sc1
    s_branch Lm_145
Lm_144:
    buffer_store_dwordx2 v[112:113], v1, s[16:19], s79 offen
Lm_145:
    s_mov_b64 exec, -1
Lnos_143:
LS7_146:
    v_mov_b32_dpp v64, v108 row_newbcast:0 row_mask:0xf bank_mask:0x1
    v_mov_b32_dpp v65, v108 row_newbcast:0 row_mask:0xf bank_mask:0x2
    v_mov_b32_dpp v66, v108 row_newbcast:0 row_mask:0xf bank_mask:0x4
    v_mov_b32_dpp v67, v108 row_newbcast:0 row_mask:0xf bank_mask:0x8
    s_nop 0
    s_waitcnt vmcnt(11)
    v_perm_b32 v126, v132, v128, s70
    v_perm_b32 v127, v132, v128, s71
    v_perm_b32 v128, v133, v129, s70
    v_perm_b32 v129, v133, v129, s71
    v_perm_b32 v132, v135, v131, s70
    v_perm_b32 v133, v135, v131, s71
    v_perm_b32 v131, v134, v130, s71
    v_perm_b32 v130, v134, v130, s70
    v_mfma_f32_16x16x32_bf16 v[72:75], v[64:67], v[126:129], 0
    v_mov_b32_dpp v68, v108 row_newbcast:1 row_mask:0xf bank_mask:0x1
    v_mov_b32_dpp v69, v108 row_newbcast:1 row_mask:0xf bank_mask:0x2
    v_mov_b32_dpp v70, v108 row_newbcast:1 row_mask:0xf bank_mask:0x4
    v_mfma_f32_16x16x32_bf16 v[76:79], v[64:67], v[130:133], 0
    v_mov_b32_dpp v71, v108 row_newbcast:1 row_mask:0xf bank_mask:0x8
    s_nop 0
    s_waitcnt vmcnt(9)
    v_perm_b32 v134, v140, v136, s70
    v_perm_b32 v135, v140, v136, s71
    v_perm_b32 v136, v141, v137, s70
    v_perm_b32 v137, v141, v137, s71
    v_perm_b32 v140, v143, v139, s70
    v_perm_b32 v141, v143, v139, s71
    v_perm_b32 v139, v142, v138, s71
    v_perm_b32 v138, v142, v138, s70
    v_mfma_f32_16x16x32_bf16 v[72:75], v[68:71], v[134:137], v[72:75]
    v_mov_b32_dpp v64, v108 row_newbcast:2 row_mask:0xf bank_mask:0x1
    v_mov_b32_dpp v65, v108 row_newbcast:2 row_mask:0xf bank_mask:0x2
    v_mov_b32_dpp v66, v108 row_newbcast:2 row_mask:0xf bank_mask:0x4
    v_mfma_f32_16x16x32_bf16 v[76:79], v[68:71], v[138:141], v[76:79]
    v_mov_b32_dpp v67, v108 row_newbcast:2 row_mask:0xf bank_mask:0x8
    s_nop 0
    s_waitcnt vmcnt(7)
    v_perm_b32 v142, v148, v144, s70
    v_perm_b32 v143, v148, v144, s71
    v_perm_b32 v144, v149, v145, s70
    v_perm_b32 v145, v149, v145, s71
    v_perm_b32 v148, v151, v147, s70
    v_perm_b32 v149, v151, v147, s71
    v_perm_b32 v147, v150, v146, s71
    v_perm_b32 v146, v150, v146, s70
    v_mfma_f32_16x16x32_bf16 v[72:75], v[64:67], v[142:145], v[72:75]
    v_mov_b32_dpp v68, v108 row_newbcast:3 row_mask:0xf bank_mask:0x1
    v_mov_b32_dpp v69, v108 row_newbcast:3 row_mask:0xf bank_mask:0x2
    v_mov_b32_dpp v70, v108 row_newbcast:3 row_mask:0xf bank_mask:0x4
    v_mfma_f32_16x16x32_bf16 v[76:79], v[64:67], v[146:149], v[76:79]
    v_mov_b32_dpp v71, v108 row_newbcast:3 row_mask:0xf bank_mask:0x8
    buffer_load_dwordx4 v[180:183], v1, s[12:15], s59 offen offset:1024 nt
    s_nop 0
    s_waitcnt vmcnt(6)
    v_perm_b32 v150, v156, v152, s70
    v_perm_b32 v151, v156, v152, s71
    v_perm_b32 v152, v157, v153, s70
    v_perm_b32 v153, v157, v153, s71
    v_perm_b32 v156, v159, v155, s70
    v_perm_b32 v157, v159, v155, s71
    v_perm_b32 v155, v158, v154, s71
    v_perm_b32 v154, v158, v154, s70
    v_mfma_f32_16x16x32_bf16 v[72:75], v[68:71], v[150:153], v[72:75]
    v_mov_b32_dpp v64, v108 row_newbcast:4 row_mask:0xf bank_mask:0x1
    v_mov_b32_dpp v65, v108 row_newbcast:4 row_mask:0xf bank_mask:0x2
    v_mov_b32_dpp v66, v108 row_newbcast:4 row_mask:0xf bank_mask:0x4
    v_mfma_f32_16x16x32_bf16 v[76:79], v[68:71], v[154:157], v[76:79]
    v_mov_b32_dpp v67, v108 row_newbcast:4 row_mask:0xf bank_mask:0x8
    buffer_load_dwordx4 v[184:187], v1, s[12:15], s59 offen offset:2048 nt
    buffer_load_dwordx4 v[188:191], v1, s[12:15], s59 offen offset:3072 nt
    s_nop 0
    s_waitcnt vmcnt(6)
    v_perm_b32 v158, v164, v160, s70
    v_perm_b32 v159, v164, v160, s71
    v_perm_b32 v160, v165, v161, s70
    v_perm_b32 v161, v165, v161, s71
    v_perm_b32 v164, v167, v163, s70
    v_perm_b32 v165, v167, v163, s71
    v_perm_b32 v163, v166, v162, s71
    v_perm_b32 v162, v166, v162, s70
    v_mfma_f32_16x16x32_bf16 v[72:75], v[64:67], v[158:161], v[72:75]
    v_mov_b32_dpp v68, v108 row_newbcast:5 row_mask:0xf bank_mask:0x1
    v_mov_b32_dpp v69, v108 row_newbcast:5 row_mask:0xf bank_mask:0x2
    v_mov_b32_dpp v70, v108 row_newbcast:5 row_mask:0xf bank_mask:0x4
    v_mfma_f32_16x16x32_bf16 v[76:79], v[64:67], v[162:165], v[76:79]
    v_mov_b32_dpp v71, v108 row_newbcast:5 row_mask:0xf bank_mask:0x8
    buffer_load_dwordx4 v[192:195], v1, s[12:15], s60 offen offset:0 nt
    buffer_load_dwordx4 v[196:199], v1, s[12:15], s60 offen offset:1024 nt
    s_nop 0
    s_waitcnt vmcnt(6)
    v_perm_b32 v166, v172, v168, s70
    v_perm_b32 v167, v172, v168, s71
    v_perm_b32 v168, v173, v169, s70
    v_perm_b32 v169, v173, v169, s71
    v_perm_b32 v172, v175, v171, s70
    v_perm_b32 v173, v175, v171, s71
    v_perm_b32 v171, v174, v170, s71
    v_perm_b32 v170, v174, v170, s70
    v_mfma_f32_16x16x32_bf16 v[72:75], v[68:71], v[166:169], v[72:75]
    v_mov_b32_dpp v64, v108 row_newbcast:6 row_mask:0xf bank_mask:0x1
    v_mov_b32_dpp v65, v108 row_newbcast:6 row_mask:0xf bank_mask:0x2
    v_mov_b32_dpp v66, v108 row_newbcast:6 row_mask:0xf bank_mask:0x4
    v_mfma_f32_16x16x32_bf16 v[76:79], v[68:71], v[170:173], v[76:79]
    v_mov_b32_dpp v67, v108 row_newbcast:6 row_mask:0xf bank_mask:0x8
    buffer_load_dwordx4 v[200:203], v1, s[12:15], s60 offen offset:2048 nt
    buffer_load_dwordx4 v[204:207], v1, s[12:15], s60 offen offset:3072 nt
    s_nop 0
    s_waitcnt vmcnt(6)
    v_perm_b32 v174, v180, v176, s70
    v_perm_b32 v175, v180, v176, s71
    v_perm_b32 v176, v181, v177, s70
    v_perm_b32 v177, v181, v177, s71
    v_perm_b32 v180, v183, v179, s70
    v_perm_b32 v181, v183, v179, s71
    v_perm_b32 v179, v182, v178, s71
    v_perm_b32 v178, v182, v178, s70
    v_mfma_f32_16x16x32_bf16 v[72:75], v[64:67], v[174:177], v[72:75]
    v_mov_b32_dpp v68, v108 row_newbcast:7 row_mask:0xf bank_mask:0x1
    v_mov_b32_dpp v69, v108 row_newbcast:7 row_mask:0xf bank_mask:0x2
    v_mov_b32_dpp v70, v108 row_newbcast:7 row_mask:0xf bank_mask:0x4
    v_mfma_f32_16x16x32_bf16 v[76:79], v[64:67], v[178:181], v[76:79]
    v_mov_b32_dpp v71, v108 row_newbcast:7 row_mask:0xf bank_mask:0x8
    buffer_load_dwordx4 v[208:211], v1, s[12:15], s61 offen offset:0 nt
    buffer_load_dwordx4 v[212:215], v1, s[12:15], s61 offen offset:1024 nt
    s_nop 0
    s_waitcnt vmcnt(6)
    v_perm_b32 v182, v188, v184, s70
    v_perm_b32 v183, v188, v184, s71
    v_perm_b32 v184, v189, v185, s70
    v_perm_b32 v185, v189, v185, s71
    v_perm_b32 v188, v191, v187, s70
    v_perm_b32 v189, v191, v187, s71
    v_perm_b32 v187, v190, v186, s71
    v_perm_b32 v186, v190, v186, s70
    v_mfma_f32_16x16x32_bf16 v[72:75], v[68:71], v[182:185], v[72:75]
    v_mov_b32_dpp v64, v108 row_newbcast:8 row_mask:0xf bank_mask:0x1
    v_mov_b32_dpp v65, v108 row_newbcast:8 row_mask:0xf bank_mask:0x2
    v_mov_b32_dpp v66, v108 row_newbcast:8 row_mask:0xf bank_mask:0x4
    v_mfma_f32_16x16x32_bf16 v[76:79], v[68:71], v[186:189], v[76:79]
    v_mov_b32_dpp v67, v108 row_newbcast:8 row_mask:0xf bank_mask:0x8
    buffer_load_dwordx4 v[216:219], v1, s[12:15], s61 offen offset:2048 nt
    buffer_load_dwordx4 v[220:223], v1, s[12:15], s61 offen offset:3072 nt
    s_nop 0
    s_waitcnt vmcnt(6)
    v_perm_b32 v190, v196, v192, s70
    v_perm_b32 v191, v196, v192, s71
    v_perm_b32 v192, v197, v193, s70
    v_perm_b32 v193, v197, v193, s71
    v_perm_b32 v196, v199, v195, s70
    v_perm_b32 v197, v199, v195, s71
    v_perm_b32 v195, v198, v194, s71
    v_perm_b32 v194, v198, v194, s70
    v_mfma_f32_16x16x32_bf16 v[72:75], v[64:67], v[190:193], v[72:75]
    v_mov_b32_dpp v68, v108 row_newbcast:9 row_mask:0xf bank_mask:0x1
    v_mov_b32_dpp v69, v108 row_newbcast:9 row_mask:0xf bank_mask:0x2
    v_mov_b32_dpp v70, v108 row_newbcast:9 row_mask:0xf bank_mask:0x4
    v_mfma_f32_16x16x32_bf16 v[76:79], v[64:67], v[194:197], v[76:79]
    v_mov_b32_dpp v71, v108 row_newbcast:9 row_mask:0xf bank_mask:0x8
    buffer_load_dwordx4 v[224:227], v1, s[12:15], s62 offen offset:0 nt
    buffer_load_dwordx4 v[228:231], v1, s[12:15], s62 offen offset:1024 nt
    s_nop 0
    s_waitcnt vmcnt(6)
    v_perm_b32 v198, v204, v200, s70
    v_perm_b32 v199, v204, v200, s71
    v_perm_b32 v200, v205, v201, s70
    v_perm_b32 v201, v205, v201, s71
    v_perm_b32 v204, v207, v203, s70
    v_perm_b32 v205, v207, v203, s71
    v_perm_b32 v203, v206, v202, s71
    v_perm_b32 v202, v206, v202, s70
    v_mfma_f32_16x16x32_bf16 v[72:75], v[68:71], v[198:201], v[72:75]
    v_mov_b32_dpp v64, v108 row_newbcast:10 row_mask:0xf bank_mask:0x1
    v_mov_b32_dpp v65, v108 row_newbcast:10 row_mask:0xf bank_mask:0x2
    v_mov_b32_dpp v66, v108 row_newbcast:10 row_mask:0xf bank_mask:0x4
    v_mfma_f32_16x16x32_bf16 v[76:79], v[68:71], v[202:205], v[76:79]
    v_mov_b32_dpp v67, v108 row_newbcast:10 row_mask:0xf bank_mask:0x8
    buffer_load_dword v114, v119, s[52:55], 0 offen sc1
    buffer_load_dwordx4 v[232:235], v1, s[12:15], s62 offen offset:2048 nt
    s_nop 0
    s_waitcnt vmcnt(6)
    v_perm_b32 v206, v212, v208, s70
    v_perm_b32 v207, v212, v208, s71
    v_perm_b32 v208, v213, v209, s70
    v_perm_b32 v209, v213, v209, s71
    v_perm_b32 v212, v215, v211, s70
    v_perm_b32 v213, v215, v211, s71
    v_perm_b32 v211, v214, v210, s71
    v_perm_b32 v210, v214, v210, s70
    v_mfma_f32_16x16x32_bf16 v[72:75], v[64:67], v[206:209], v[72:75]
    v_mov_b32_dpp v68, v108 row_newbcast:11 row_mask:0xf bank_mask:0x1
    v_mov_b32_dpp v69, v108 row_newbcast:11 row_mask:0xf bank_mask:0x2
    v_mov_b32_dpp v70, v108 row_newbcast:11 row_mask:0xf bank_mask:0x4
    v_mfma_f32_16x16x32_bf16 v[76:79], v[64:67], v[210:213], v[76:79]
    v_mov_b32_dpp v71, v108 row_newbcast:11 row_mask:0xf bank_mask:0x8
    buffer_load_dwordx4 v[236:239], v1, s[12:15], s62 offen offset:3072 nt
    buffer_load_dwordx4 v[240:243], v1, s[12:15], s63 offen offset:0 nt
    s_nop 0
    s_waitcnt vmcnt(6)
    v_perm_b32 v214, v220, v216, s70
    v_perm_b32 v215, v220, v216, s71
    v_perm_b32 v216, v221, v217, s70
    v_perm_b32 v217, v221, v217, s71
    v_perm_b32 v220, v223, v219, s70
    v_perm_b32 v221, v223, v219, s71
    v_perm_b32 v219, v222, v218, s71
    v_perm_b32 v218, v222, v218, s70
    v_mfma_f32_16x16x32_bf16 v[72:75], v[68:71], v[214:217], v[72:75]
    v_mov_b32_dpp v64, v108 row_newbcast:12 row_mask:0xf bank_mask:0x1
    v_mov_b32_dpp v65, v108 row_newbcast:12 row_mask:0xf bank_mask:0x2
    v_mov_b32_dpp v66, v108 row_newbcast:12 row_mask:0xf bank_mask:0x4
    v_mfma_f32_16x16x32_bf16 v[76:79], v[68:71], v[218:221], v[76:79]
    v_mov_b32_dpp v67, v108 row_newbcast:12 row_mask:0xf bank_mask:0x8
    buffer_load_dwordx4 v[244:247], v1, s[12:15], s63 offen offset:1024 nt
    buffer_load_dwordx4 v[248:251], v1, s[12:15], s63 offen offset:2048 nt
    s_nop 0
    s_waitcnt vmcnt(6)
    v_perm_b32 v222, v228, v224, s70
    v_perm_b32 v223, v228, v224, s71
    v_perm_b32 v224, v229, v225, s70
    v_perm_b32 v225, v229, v225, s71
    v_perm_b32 v228, v231, v227, s70
    v_perm_b32 v229, v231, v227, s71
    v_perm_b32 v227, v230, v226, s71
    v_perm_b32 v226, v230, v226, s70
    v_mfma_f32_16x16x32_bf16 v[72:75], v[64:67], v[222:225], v[72:75]
    v_mov_b32_dpp v68, v108 row_newbcast:13 row_mask:0xf bank_mask:0x1
    v_mov_b32_dpp v69, v108 row_newbcast:13 row_mask:0xf bank_mask:0x2
    v_mov_b32_dpp v70, v108 row_newbcast:13 row_mask:0xf bank_mask:0x4
    v_mfma_f32_16x16x32_bf16 v[76:79], v[64:67], v[226:229], v[76:79]
    v_mov_b32_dpp v71, v108 row_newbcast:13 row_mask:0xf bank_mask:0x8
    buffer_load_dwordx4 v[252:255], v1, s[12:15], s63 offen offset:3072 nt
    s_mul_i32 s90, s74, 110592
    s_mul_i32 s91, s3, 432
    s_add_u32 s90, s90, s91
    s_lshl_b32 s91, s7, 7
    s_add_u32 s90, s90, s91
    buffer_load_dwordx2 a[192:193], v25, s[32:35], s90 offen
    s_add_u32 s90, s90, 3456
    buffer_load_dwordx2 a[194:195], v25, s[32:35], s90 offen
    s_add_u32 s90, s90, 3456
    buffer_load_dwordx2 a[196:197], v25, s[32:35], s90 offen
    s_add_u32 s90, s90, 3456
    buffer_load_dwordx2 a[198:199], v25, s[32:35], s90 offen
    s_add_u32 s90, s90, 3456
    buffer_load_dwordx2 a[200:201], v25, s[32:35], s90 offen
    s_add_u32 s90, s90, 3456
    buffer_load_dwordx2 a[202:203], v25, s[32:35], s90 offen
    s_add_u32 s90, s90, 3456
    buffer_load_dwordx2 a[204:205], v25, s[32:35], s90 offen
    s_add_u32 s90, s90, 3456
    buffer_load_dwordx2 a[206:207], v25, s[32:35], s90 offen
    s_waitcnt vmcnt(12)
    v_perm_b32 v230, v236, v232, s70
    v_perm_b32 v231, v236, v232, s71
    v_perm_b32 v232, v237, v233, s70
    v_perm_b32 v233, v237, v233, s71
    v_perm_b32 v236, v239, v235, s70
    v_perm_b32 v237, v239, v235, s71
    v_perm_b32 v235, v238, v234, s71
    v_perm_b32 v234, v238, v234, s70
    v_mfma_f32_16x16x32_bf16 v[72:75], v[68:71], v[230:233], v[72:75]
    v_mov_b32_dpp v64, v108 row_newbcast:14 row_mask:0xf bank_mask:0x1
    v_mov_b32_dpp v65, v108 row_newbcast:14 row_mask:0xf bank_mask:0x2
    v_mov_b32_dpp v66, v108 row_newbcast:14 row_mask:0xf bank_mask:0x4
    v_mfma_f32_16x16x32_bf16 v[76:79], v[68:71], v[234:237], v[76:79]
    v_mov_b32_dpp v67, v108 row_newbcast:14 row_mask:0xf bank_mask:0x8
    s_nop 0
    s_waitcnt vmcnt(10)
    v_perm_b32 v238, v244, v240, s70
    v_perm_b32 v239, v244, v240, s71
    v_perm_b32 v240, v245, v241, s70
    v_perm_b32 v241, v245, v241, s71
    v_perm_b32 v244, v247, v243, s70
    v_perm_b32 v245, v247, v243, s71
    v_perm_b32 v243, v246, v242, s71
    v_perm_b32 v242, v246, v242, s70
    v_mfma_f32_16x16x32_bf16 v[72:75], v[64:67], v[238:241], v[72:75]
    v_mov_b32_dpp v68, v108 row_newbcast:15 row_mask:0xf bank_mask:0x1
    v_mov_b32_dpp v69, v108 row_newbcast:15 row_mask:0xf bank_mask:0x2
    v_mov_b32_dpp v70, v108 row_newbcast:15 row_mask:0xf bank_mask:0x4
    v_mfma_f32_16x16x32_bf16 v[76:79], v[64:67], v[242:245], v[76:79]
    v_mov_b32_dpp v71, v108 row_newbcast:15 row_mask:0xf bank_mask:0x8
    s_nop 0
    s_waitcnt vmcnt(8)
    v_perm_b32 v246, v252, v248, s70
    v_perm_b32 v247, v252, v248, s71
    v_perm_b32 v248, v253, v249, s70
    v_perm_b32 v249, v253, v249, s71
    v_perm_b32 v252, v255, v251, s70
    v_perm_b32 v253, v255, v251, s71
    v_perm_b32 v251, v254, v250, s71
    v_perm_b32 v250, v254, v250, s70
    v_mfma_f32_16x16x32_bf16 v[72:75], v[68:71], v[246:249], v[72:75]
    s_nop 0
    v_mfma_f32_16x16x32_bf16 v[76:79], v[68:71], v[250:253], v[76:79]
    s_mov_b32 s64, 0x0
    s_add_u32 s65, s79, 0x0
    s_movk_i32 s66, 0x2000
    s_cmp_lg_u32 s78, 0
    s_cbranch_scc1 L_loopC_slow
L_loopC_fast:
LS10_147:
    s_nop 0
    v_mul_f32_dpp v104, v109, v72 quad_perm:[0,0,0,0] row_mask:0xf bank_mask:0xf
    s_nop 0
    v_mul_f32_dpp v105, v109, v76 quad_perm:[0,0,0,0] row_mask:0xf bank_mask:0xf
    ds_write2_b32 v20, v104, v105 offset0:0 offset1:64
    s_cmp_lg_u32 s7, 0
    s_waitcnt lgkmcnt(0)
    s_barrier
    s_cbranch_scc1 Lsk_148
    ds_read2_b64 v[72:75], v21 offset0:0 offset1:64
    ds_read2_b64 v[76:79], v21 offset0:128 offset1:192
    s_waitcnt lgkmcnt(1)
    v_pk_add_f32 v[72:73], v[72:73], v[74:75]
    s_waitcnt lgkmcnt(0)
    v_pk_add_f32 v[76:77], v[76:77], v[78:79]
    v_pk_add_f32 v[72:73], v[72:73], v[76:77]
    v_cvt_pk_bf16_f32 v72, v72, v73
    buffer_store_dword v72, v8, s[16:19], s64 offen
Lsk_148:
LS11_149:
    s_barrier
    s_waitcnt vmcnt(14)
Lfc_152:
    v_and_b32 v120, 0x80808080, v114
    v_cmp_ne_u32 vcc, 0x80808080, v120
    s_cbranch_vccnz Lretry_153
Lfok_151:
    v_and_b32 v120, 0x40404040, v114
    v_bcnt_u32_b32 v120, v120, 0
    s_nop 1
    v_add_u32_dpp v120, v120, v120 row_ror:1 row_mask:0xf bank_mask:0xf
    s_nop 1
    v_add_u32_dpp v120, v120, v120 row_ror:2 row_mask:0xf bank_mask:0xf
    s_nop 1
    v_add_u32_dpp v120, v120, v120 row_ror:4 row_mask:0xf bank_mask:0xf
    s_nop 1
    v_add_u32_dpp v120, v120, v120 row_ror:8 row_mask:0xf bank_mask:0xf
    s_nop 1
    v_add_u32_dpp v120, v120, v120 row_bcast:15 row_mask:0xa bank_mask:0xf
    s_nop 1
    v_add_u32_dpp v120, v120, v120 row_bcast:31 row_mask:0xc bank_mask:0xf
    s_nop 0
    v_readlane_b32 s67, v120, 63
    s_nop 0
    s_cmp_gt_u32 s67, 16
    s_cselect_b32 s67, 0, 0x2000
    s_lshl_b32 s68, s75, 11
    s_and_b32 s68, s68, 0x2000
    s_xor_b32 s66, s67, s68
    v_bfe_u32 v105, v0, 3, 2
    v_lshlrev_b32 v105, 11, v105
    v_and_b32 v104, 7, v0
    v_lshl_add_u32 v105, v104, 4, v105
    s_add_u32 s67, s76, 0x6000
Lp_154:
    buffer_load_dword v104, v105, s[16:19], s67 offen sc1
    s_sub_u32 s69, s69, 1
    s_cbranch_scc1 Lgive_155
    s_waitcnt vmcnt(0)
    v_cmp_eq_u32 vcc, -1, v104
    s_cbranch_vccnz Lp_154
Lok_156:
    s_cmp_lg_u32 s7, 1
    s_cbranch_scc1 La_160
    v_mov_b32 v42, 0
    v_mov_b32_e64 v43, 0
    buffer_atomic_or_x2 v[42:43], v13, s[16:19], s66 offen offset:0 sc0 sc1
La_160:
    v_accvgpr_read_b32 v72, a192
    v_accvgpr_read_b32 v73, a193
    v_accvgpr_read_b32 v74, a194
    v_accvgpr_read_b32 v75, a195
    v_accvgpr_read_b32 v76, a196
    v_accvgpr_read_b32 v77, a197
    v_accvgpr_read_b32 v78, a198
    v_accvgpr_read_b32 v79, a199
    v_accvgpr_read_b32 v80, a200
    v_accvgpr_read_b32 v81, a201
    v_accvgpr_read_b32 v82, a202
    v_accvgpr_read_b32 v83, a203
    v_accvgpr_read_b32 v84, a204
    v_accvgpr_read_b32 v85, a205
    v_accvgpr_read_b32 v86, a206
    v_accvgpr_read_b32 v87, a207
    v_perm_b32 v88, v74, v72, s70
    v_accvgpr_write_b32 a192, v88
    v_perm_b32 v89, v78, v76, s70
    v_accvgpr_write_b32 a193, v89
    v_perm_b32 v88, v82, v80, s70
    v_accvgpr_write_b32 a194, v88
    v_perm_b32 v89, v86, v84, s70
    v_accvgpr_write_b32 a195, v89
    v_perm_b32 v88, v74, v72, s71
    v_accvgpr_write_b32 a196, v88
    v_perm_b32 v89, v78, v76, s71
    v_accvgpr_write_b32 a197, v89
    v_perm_b32 v88, v82, v80, s71
    v_accvgpr_write_b32 a198, v88
    v_perm_b32 v89, v86, v84, s71
    v_accvgpr_write_b32 a199, v89
    v_perm_b32 v88, v75, v73, s70
    v_accvgpr_write_b32 a200, v88
    v_perm_b32 v89, v79, v77, s70
    v_accvgpr_write_b32 a201, v89
    v_perm_b32 v88, v83, v81, s70
    v_accvgpr_write_b32 a202, v88
    v_perm_b32 v89, v87, v85, s70
    v_accvgpr_write_b32 a203, v89
    v_perm_b32 v88, v75, v73, s71
    v_accvgpr_write_b32 a204, v88
    v_perm_b32 v89, v79, v77, s71
    v_accvgpr_write_b32 a205, v89
    v_perm_b32 v88, v83, v81, s71
    v_accvgpr_write_b32 a206, v88
    v_perm_b32 v89, v87, v85, s71
    v_accvgpr_write_b32 a207, v89
    s_cmp_lg_u32 s7, 1
    s_cbranch_scc1 La_161
    v_mov_b32 v44, 0
    v_mov_b32 v45, 0
    buffer_atomic_or_x2 v[44:45], v13, s[16:19], s66 offen offset:0 sc0 sc1
La_161:
    s_mov_b32 s68, 0xe8000
    v_mfma_f32_16x16x32_bf16 v[72:75], v[36:39], a[192:195], 0
    v_mfma_f32_16x16x32_bf16 v[76:79], v[36:39], a[196:199], 0
    v_mfma_f32_16x16x32_bf16 v[80:83], v[36:39], a[200:203], 0
    v_mfma_f32_16x16x32_bf16 v[84:87], v[36:39], a[204:207], 0
    s_mov_b64 exec, 0xffff
    s_nop 4
    v_mov_b32 v73, v76
    v_mov_b32 v74, v80
    v_mov_b32 v75, v84
    buffer_store_dwordx4 v[72:75], v14, s[16:19], s68 offen
    s_mov_b64 exec, -1
    v_and_b32 v113, 0x30, v0
    s_cmp_lg_u32 s7, 0
    s_cbranch_scc1 Lpr_162
    s_branch Lb_157
Lpr_162:
    s_cmp_lg_u32 s7, 1
    s_cbranch_scc1 Lb_157
    v_and_b32 v112, 7, v0
    v_lshl_add_u32 v112, v112, 1, v113
Lp_158:
    v_mov_b32 v46, 0
    v_mov_b32 v47, 0
    buffer_atomic_or_x2 v[46:47], v13, s[16:19], s66 offen offset:0 sc0 sc1
    s_waitcnt vmcnt(2)
    v_cmp_gt_u32 vcc, 0x41000000, v43
    v_add_f64 v[110:111], v[42:43], v[40:41]
    s_cbranch_vccz Lok_159
    v_mov_b32 v42, 0
    v_mov_b32 v43, 0
    buffer_atomic_or_x2 v[42:43], v13, s[16:19], s66 offen offset:0 sc0 sc1
    s_waitcnt vmcnt(2)
    v_cmp_gt_u32 vcc, 0x41000000, v45
    v_add_f64 v[110:111], v[44:45], v[40:41]
    s_cbranch_vccz Lok_159
    v_mov_b32 v44, 0
    v_mov_b32 v45, 0
    buffer_atomic_or_x2 v[44:45], v13, s[16:19], s66 offen offset:0 sc0 sc1
    s_waitcnt vmcnt(2)
    v_cmp_gt_u32 vcc, 0x41000000, v47
    v_add_f64 v[110:111], v[46:47], v[40:41]
    s_cbranch_vccz Lok_159
    s_sub_u32 s69, s69, 1
    s_cbranch_scc0 Lp_158
    s_mov_b32 s69, 0
Lok_159:
    v_cvt_f32_f64_e64 v109, v[110:111]
    s_nop 1
    v_add_f32_dpp v109, v109, v109 row_ror:8 row_mask:0xf bank_mask:0xf
    v_cvt_pk_bf16_f32 v109, v109, v109
    ds_write_b16 v112, v109 offset:10240
    s_waitcnt lgkmcnt(0)
Lb_157:
    s_barrier
    ds_read_b128 v[32:35], v113 offset:10240
    s_nop 0
    s_waitcnt lgkmcnt(0)
LS13_163:
    v_mfma_f32_16x16x32_bf16 v[72:75], v[32:35], a[192:195], 0
    v_mov_b32_dpp v36, v32 quad_perm:[0,1,2,3] row_mask:0xf bank_mask:0x3
    v_mov_b32_dpp v37, v33 quad_perm:[0,1,2,3] row_mask:0xf bank_mask:0x3
    v_mfma_f32_16x16x32_bf16 v[76:79], v[32:35], a[196:199], 0
    v_mov_b32_dpp v38, v34 quad_perm:[0,1,2,3] row_mask:0xf bank_mask:0x3
    v_mov_b32_dpp v39, v35 quad_perm:[0,1,2,3] row_mask:0xf bank_mask:0x3
    v_mfma_f32_16x16x32_bf16 v[80:83], v[32:35], a[200:203], 0
    v_mfma_f32_16x16x32_bf16 v[84:87], v[32:35], a[204:207], 0
    v_mfma_f32_16x16x32_bf16 v[120:123], v[32:35], v[36:39], 0
    s_mov_b64 exec, 0xffff
    s_nop 1
    v_mov_b32 v73, v76
    s_nop 1
    v_mov_b32 v74, v80
    v_mov_b32 v75, v84
    buffer_store_dwordx4 v[72:75], v14, s[16:19], s64 offen
    s_mov_b64 exec, 0x101
    buffer_store_dword v120, v5, s[16:19], s64 offen offset:256
    s_mov_b64 exec, -1
    s_mov_b32 exec_lo, 0x00ff00ff
    s_mov_b32 exec_hi, 0x00ff00ff
    v_lshlrev_b32 v112, 16, v109
    v_accvgpr_read_b32 v113, a226
    v_lshlrev_b32 v113, 16, v113
    v_add_f32 v112, v112, v113
    v_cvt_f64_f32 v[40:41], v112
    v_add_f64 v[40:41], v[40:41], -s[0:1]
    s_mov_b64 exec, -1
LS14_164:
    v_and_b32 v113, 0x30, v0
    s_cmp_lg_u32 s7, 0
    s_cbranch_scc1 Lpr_168
    s_lshl_b32 s56, s3, 3
    s_lshl_b64 exec, 0xff, s56
    s_movk_i32 s66, 0x2000
    v_mov_b32 v42, 0
    v_mov_b32 v43, 0
    v_mov_b32 v44, 0
    v_mov_b32 v45, 0
    buffer_atomic_or_x2 v[42:43], v13, s[16:19], 0 offen offset:192 sc0 sc1
    buffer_atomic_or_x2 v[44:45], v13, s[16:19], s66 offen offset:192 sc0 sc1
    s_mov_b64 exec, -1
    s_waitcnt vmcnt(1)
    s_memtime s[56:57]
    s_waitcnt vmcnt(0)
    s_memtime s[58:59]
    s_waitcnt lgkmcnt(0)
    s_sub_u32 s56, s58, s56
    s_cmp_gt_u32 s56, 64
    s_cselect_b32 s66, 0, 8192
    v_mov_b32 v42, s66
    v_mov_b32 v43, 0
    ds_write_b32 v43, v42 offset:10368
Lpr_168:
    s_waitcnt vmcnt(0) lgkmcnt(0)
    s_barrier
    s_mov_b32 s68, 0xe8000
    buffer_load_dwordx4 a[248:251], v4, s[16:19], s68 offen sc1
    buffer_load_dwordx4 a[244:247], v3, s[16:19], s68 offen sc1
    s_cmp_lg_u32 s7, 1
    s_cbranch_scc1 Lbw_169
    s_cmp_lg_u32 s7, 1
    s_cbranch_scc1 Lb_165
    v_mov_b32 v43, 0
    ds_read_b32 v42, v43 offset:10368
    s_waitcnt lgkmcnt(0)
    v_readfirstlane_b32 s67, v42
    s_nop 0
    s_and_b32 s66, s67, 0x2000
    s_nop 15
    s_nop 15
    s_nop 15
    v_mov_b32 v42, 0
    v_mov_b32 v43, 0
    buffer_atomic_or_x2 v[42:43], v13, s[16:19], s66 offen offset:64 sc0 sc1
    v_and_b32 v112, 7, v0
    v_lshl_add_u32 v112, v112, 1, v113
    s_nop 15
    s_nop 15
    s_nop 15
    v_mov_b32 v44, 0
    v_mov_b32 v45, 0
    buffer_atomic_or_x2 v[44:45], v13, s[16:19], s66 offen offset:64 sc0 sc1
    s_nop 15
    s_nop 15
    s_nop 15
Lp_166:
    v_mov_b32 v46, 0
    v_mov_b32 v47, 0
    buffer_atomic_or_x2 v[46:47], v13, s[16:19], s66 offen offset:64 sc0 sc1
    s_waitcnt vmcnt(2)
    v_cmp_gt_u32 vcc, 0x41000000, v43
    v_add_f64 v[110:111], v[42:43], v[40:41]
    s_cbranch_vccz Lok_167
    v_mov_b32 v42, 0
    v_mov_b32_e64 v43, 0
    buffer_atomic_or_x2 v[42:43], v13, s[16:19], s66 offen offset:64 sc0 sc1
    s_waitcnt vmcnt(2)
    v_cmp_gt_u32 vcc, 0x41000000, v45
    v_add_f64 v[110:111], v[44:45], v[40:41]
    s_cbranch_vccz Lok_167
    v_mov_b32 v44, 0
    v_mov_b32 v45, 0
    buffer_atomic_or_x2 v[44:45], v13, s[16:19], s66 offen offset:64 sc0 sc1
    s_waitcnt vmcnt(2)
    v_cmp_gt_u32 vcc, 0x41000000, v47
    v_add_f64 v[110:111], v[46:47], v[40:41]
    s_cbranch_vccz Lok_167
    s_sub_u32 s69, s69, 1
    s_cbranch_scc0 Lp_166
    s_mov_b32 s69, 0
Lok_167:
    v_cvt_f32_f64_e64 v109, v[110:111]
    s_nop 1
    v_add_f32_dpp v109, v109, v109 row_ror:8 row_mask:0xf bank_mask:0xf
    v_cvt_pk_bf16_f32 v109, v109, v109
    ds_write_b16 v112, v109 offset:10240
    s_waitcnt lgkmcnt(0)
Lb_165:
    s_barrier
    ds_read_b128 v[32:35], v113 offset:10240
    s_waitcnt lgkmcnt(0)
LS16_170:
    s_mov_b32 s64, 0x74000
    s_add_u32 s65, s79, 0x74000
    v_mfma_f32_16x16x32_bf16 v[72:75], v[32:35], a[128:131], 0
    v_mov_b32_dpp v36, v32 quad_perm:[0,1,2,3] row_mask:0xf bank_mask:0x3
    v_mov_b32_dpp v37, v33 quad_perm:[0,1,2,3] row_mask:0xf bank_mask:0x3
    v_mfma_f32_16x16x32_bf16 v[88:91], v[32:35], a[144:147], 0
    v_mov_b32_dpp v38, v34 quad_perm:[0,1,2,3] row_mask:0xf bank_mask:0x3
    v_mov_b32_dpp v39, v35 quad_perm:[0,1,2,3] row_mask:0xf bank_mask:0x3
    v_mfma_f32_16x16x32_bf16 v[76:79], v[32:35], a[132:135], 0
    v_mfma_f32_16x16x32_bf16 v[92:95], v[32:35], a[148:151], 0
    v_mfma_f32_16x16x32_bf16 v[120:123], v[32:35], v[36:39], 0
    v_mfma_f32_16x16x32_bf16 v[80:83], v[32:35], a[136:139], 0
    v_mfma_f32_16x16x32_bf16 v[96:99], v[32:35], a[152:155], 0
    v_mfma_f32_16x16x32_bf16 v[84:87], v[32:35], a[140:143], 0
    v_mfma_f32_16x16x32_bf16 v[100:103], v[32:35], a[156:159], 0
    s_mov_b64 exec, 0x101
    s_nop 2
    buffer_store_dword v120, v5, s[16:19], s64 offen
    s_mov_b32 exec_lo, -1
    v_mov_b32_dpp v72, v88 quad_perm:[0,1,2,3] row_mask:0x2 bank_mask:0xf
    v_mov_b32_dpp v73, v76 quad_perm:[0,1,2,3] row_mask:0x1 bank_mask:0xf
    v_mov_b32_dpp v73, v92 quad_perm:[0,1,2,3] row_mask:0x2 bank_mask:0xf
    v_mov_b32_dpp v74, v80 quad_perm:[0,1,2,3] row_mask:0x1 bank_mask:0xf
    v_mov_b32_dpp v74, v96 quad_perm:[0,1,2,3] row_mask:0x2 bank_mask:0xf
    v_mov_b32_dpp v75, v84 quad_perm:[0,1,2,3] row_mask:0x1 bank_mask:0xf
    v_mov_b32_dpp v75, v100 quad_perm:[0,1,2,3] row_mask:0x2 bank_mask:0xf
    buffer_store_dwordx4 v[72:75], v2, s[16:19], s64 offen
    s_mov_b64 exec, -1
    s_mov_b32 exec_lo, 0x00ff00ff
    s_mov_b32 exec_hi, 0x00ff00ff
    v_lshlrev_b32 v112, 16, v109
    v_cvt_f64_f32 v[40:41], v112
    v_add_f64 v[40:41], v[40:41], -s[0:1]
    s_mov_b64 exec, -1
LS17_171:
    buffer_load_dwordx4 v[76:79], v4, s[16:19], s64 offen sc1
    buffer_load_dwordx4 v[72:75], v3, s[16:19], s64 offen sc1
    v_accvgpr_read_b32 v84, a244
    v_accvgpr_read_b32 v85, a245
    v_accvgpr_read_b32 v86, a246
    v_accvgpr_read_b32 v87, a247
    v_accvgpr_read_b32 v88, a248
    v_accvgpr_read_b32 v89, a249
    v_accvgpr_read_b32 v90, a250
    v_accvgpr_read_b32 v91, a251
    v_add_f32_dpp v84, v88, v84 quad_perm:[0,1,2,3] row_mask:0xf bank_mask:0xc
    v_add_f32_dpp v85, v89, v85 quad_perm:[0,1,2,3] row_mask:0xf bank_mask:0xc
    v_add_f32_dpp v86, v90, v86 quad_perm:[0,1,2,3] row_mask:0xf bank_mask:0xc
    v_add_f32_dpp v87, v91, v87 quad_perm:[0,1,2,3] row_mask:0xf bank_mask:0xc
    v_permlane32_swap_b32 v84, v85
    s_nop 0
    v_permlane32_swap_b32 v86, v87
    v_add_f32 v84, v84, v85
    v_add_f32 v86, v86, v87
    s_nop 1
    v_permlane16_swap_b32 v84, v86
    v_add_f32 v24, v84, v86
    s_nop 1
    v_add_f32_dpp v24, v24, v24 row_ror:8 row_mask:0xf bank_mask:0xf
    s_branch Lp_172w
Lp_172:
    buffer_load_dwordx4 v[76:79], v4, s[16:19], s64 offen sc1
    buffer_load_dwordx4 v[72:75], v3, s[16:19], s64 offen sc1
    s_sub_u32 s69, s69, 1
    s_cbranch_scc1 Lgive_174
Lp_172w:
    s_waitcnt vmcnt(1)
    v_pk_add_f32 v[80:81], v[76:77], v[78:79]
    s_nop 1
    v_add_f32_dpp v6, v80, v81 quad_perm:[0,1,2,3] row_mask:0xf bank_mask:0x3
    s_nop 0
    s_waitcnt vmcnt(0)
    v_add_f32_dpp v72, v76, v72 quad_perm:[0,1,2,3] row_mask:0xf bank_mask:0xc
    v_add_f32_dpp v73, v77, v73 quad_perm:[0,1,2,3] row_mask:0xf bank_mask:0xc
    v_add_f32_dpp v105, v6, v6 row_ror:2 row_mask:0xf bank_mask:0xf
    v_cmp_u_f32 vcc, v72, v6
    v_add_f32_dpp v74, v78, v74 quad_perm:[0,1,2,3] row_mask:0xf bank_mask:0xc
    v_add_f32_dpp v75, v79, v75 quad_perm:[0,1,2,3] row_mask:0xf bank_mask:0xc
    s_cbranch_vccnz Lp_172
    v_add_f32_dpp v105, v105, v105 row_ror:4 row_mask:0xf bank_mask:0xf
    v_permlane32_swap_b32 v72, v73
    s_nop 0
    v_add_f32_dpp v105, v105, v105 row_ror:8 row_mask:0xf bank_mask:0xf
    v_permlane32_swap_b32 v74, v75
    v_mul_f32 v105, 0x3acccccd, v105
    v_add_f32 v72, v72, v73
    s_nop 0
    v_mov_b32_dpp v106, v105 quad_perm:[0,0,2,2] row_mask:0xf bank_mask:0xf
    v_add_f32 v74, v74, v75
    v_mov_b32_dpp v107, v105 quad_perm:[1,1,3,3] row_mask:0xf bank_mask:0xf
    s_nop 0
    v_permlane16_swap_b32 v72, v74
    v_fma_f32 v107, -v106, v106, v107
    v_add_f32 v104, v72, v74
    v_max_f32 v107, 0, v107
    s_nop 0
    v_add_f32_dpp v104, v104, v104 row_ror:8 row_mask:0xf bank_mask:0xf
    v_add_f32 v107, 0x3727c5ac, v107
    v_rsq_f32 v107, v107
    v_fma_f32 v104, -v106, v24, v104
    v_mul_f32_e64 v104, v104, v107
    v_cvt_pk_bf16_f32 v107, v104, v104
    v_cmp_u_f32 vcc, v104, v105
    s_cbranch_vccnz Lp_172
Lok_173:
    ds_write_b16 v16, v107
    s_waitcnt lgkmcnt(0)
    s_nop 0
    s_barrier
LS18_175:
    s_mov_b64 exec, s[80:81]
    ds_read_b128 v[48:51], v17
    s_mov_b64 exec, s[82:83]
    ds_read_b128 v[52:55], v17
    s_mov_b64 exec, s[84:85]
    ds_read_b128 v[56:59], v17
    s_mov_b64 exec, s[86:87]
    ds_read_b128 v[60:63], v17
    s_mov_b64 exec, -1
    s_waitcnt lgkmcnt(3)
    v_mfma_f32_16x16x32_bf16 v[72:75], a[0:3], v[48:51], 0
    v_mfma_f32_16x16x32_bf16 v[76:79], a[32:35], v[48:51], 0
    s_waitcnt lgkmcnt(2)
    v_mfma_f32_16x16x32_bf16 v[72:75], a[8:11], v[52:55], v[72:75]
    v_mfma_f32_16x16x32_bf16 v[76:79], a[40:43], v[52:55], v[76:79]
    s_waitcnt lgkmcnt(1)
    v_mfma_f32_16x16x32_bf16 v[72:75], a[16:19], v[56:59], v[72:75]
    v_mfma_f32_16x16x32_bf16 v[76:79], a[48:51], v[56:59], v[76:79]
    s_waitcnt lgkmcnt(0)
    v_mfma_f32_16x16x32_bf16 v[72:75], a[24:27], v[60:63], v[72:75]
    v_mfma_f32_16x16x32_bf16 v[76:79], a[56:59], v[60:63], v[76:79]
    v_mfma_f32_16x16x32_bf16 v[80:83], a[64:67], v[48:51], 0
    v_mfma_f32_16x16x32_bf16 v[84:87], a[96:99], v[48:51], 0
    v_mfma_f32_16x16x32_bf16 v[80:83], a[72:75], v[52:55], v[80:83]
    v_mfma_f32_16x16x32_bf16 v[84:87], a[104:107], v[52:55], v[84:87]
    v_mfma_f32_16x16x32_bf16 v[80:83], a[80:83], v[56:59], v[80:83]
    v_mfma_f32_16x16x32_bf16 v[84:87], a[112:115], v[56:59], v[84:87]
    v_mfma_f32_16x16x32_bf16 v[80:83], a[88:91], v[60:63], v[80:83]
    v_add_f32_dpp v104, v73, v72 row_ror:12 row_mask:0xf bank_mask:0x1
    v_add_f32_dpp v104, v74, v104 row_ror:8 row_mask:0xf bank_mask:0x1
    v_mfma_f32_16x16x32_bf16 v[84:87], a[120:123], v[60:63], v[84:87]
    v_add_f32_dpp v104, v75, v104 row_ror:4 row_mask:0xf bank_mask:0x1
    v_add_f32_dpp v104, v76, v77 row_ror:4 row_mask:0xf bank_mask:0x2
    v_mfma_f32_16x16x32_bf16 v[88:91], a[4:7], v[48:51], 0
    v_add_f32_dpp v104, v78, v104 row_ror:12 row_mask:0xf bank_mask:0x2
    v_add_f32_dpp v104, v79, v104 row_ror:8 row_mask:0xf bank_mask:0x2
    v_mfma_f32_16x16x32_bf16 v[92:95], a[36:39], v[48:51], 0
    v_add_f32_dpp v104, v80, v82 row_ror:8 row_mask:0xf bank_mask:0x4
    v_add_f32_dpp v104, v81, v104 row_ror:4 row_mask:0xf bank_mask:0x4
    v_mfma_f32_16x16x32_bf16 v[88:91], a[12:15], v[52:55], v[88:91]
    v_add_f32_dpp v104, v83, v104 row_ror:12 row_mask:0xf bank_mask:0x4
    v_add_f32_dpp v104, v84, v87 row_ror:12 row_mask:0xf bank_mask:0x8
    v_mfma_f32_16x16x32_bf16 v[92:95], a[44:47], v[52:55], v[92:95]
    v_add_f32_dpp v104, v85, v104 row_ror:8 row_mask:0xf bank_mask:0x8
    v_add_f32_dpp v104, v86, v104 row_ror:4 row_mask:0xf bank_mask:0x8
    v_mfma_f32_16x16x32_bf16 v[88:91], a[20:23], v[56:59], v[88:91]
    v_mfma_f32_16x16x32_bf16 v[92:95], a[52:55], v[56:59], v[92:95]
    v_mfma_f32_16x16x32_bf16 v[88:91], a[28:31], v[60:63], v[88:91]
    v_mfma_f32_16x16x32_bf16 v[92:95], a[60:63], v[60:63], v[92:95]
    v_mfma_f32_16x16x32_bf16 v[96:99], a[68:71], v[48:51], 0
    v_mfma_f32_16x16x32_bf16 v[100:103], a[100:103], v[48:51], 0
    v_mfma_f32_16x16x32_bf16 v[96:99], a[76:79], v[52:55], v[96:99]
    v_mfma_f32_16x16x32_bf16 v[100:103], a[108:111], v[52:55], v[100:103]
    v_mfma_f32_16x16x32_bf16 v[96:99], a[84:87], v[56:59], v[96:99]
    v_mfma_f32_16x16x32_bf16 v[100:103], a[116:119], v[56:59], v[100:103]
    v_mfma_f32_16x16x32_bf16 v[96:99], a[92:95], v[60:63], v[96:99]
    v_add_f32_dpp v105, v89, v88 row_ror:12 row_mask:0xf bank_mask:0x1
    v_add_f32_dpp v105, v90, v105 row_ror:8 row_mask:0xf bank_mask:0x1
    v_mfma_f32_16x16x32_bf16 v[100:103], a[124:127], v[60:63], v[100:103]
    v_add_f32_dpp v105, v91, v105 row_ror:4 row_mask:0xf bank_mask:0x1
    v_add_f32_dpp v105, v92, v93 row_ror:4 row_mask:0xf bank_mask:0x2
    v_add_f32_dpp v105, v94, v105 row_ror:12 row_mask:0xf bank_mask:0x2
    v_add_f32_dpp v105, v95, v105 row_ror:8 row_mask:0xf bank_mask:0x2
    s_nop 0
    v_add_f32_dpp v105, v96, v98 row_ror:8 row_mask:0xf bank_mask:0x4
    v_add_f32_dpp v105, v97, v105 row_ror:4 row_mask:0xf bank_mask:0x4
    v_add_f32_dpp v105, v99, v105 row_ror:12 row_mask:0xf bank_mask:0x4
    v_add_f32_dpp v105, v100, v103 row_ror:12 row_mask:0xf bank_mask:0x8
    v_add_f32_dpp v105, v101, v105 row_ror:8 row_mask:0xf bank_mask:0x8
    v_add_f32_dpp v105, v102, v105 row_ror:4 row_mask:0xf bank_mask:0x8
    v_max_f32 v106, v104, v105
    s_nop 1
    v_max_f32_dpp v106, v106, v106 row_ror:1 row_mask:0xf bank_mask:0xf
    s_nop 1
    v_max_f32_dpp v106, v106, v106 row_ror:2 row_mask:0xf bank_mask:0xf
    s_nop 1
    v_max_f32_dpp v106, v106, v106 row_ror:4 row_mask:0xf bank_mask:0xf
    s_nop 1
    v_max_f32_dpp v106, v106, v106 row_ror:8 row_mask:0xf bank_mask:0xf
    s_nop 1
    v_max_f32_dpp v106, v106, v106 row_bcast:15 row_mask:0xa bank_mask:0xf
    s_nop 1
    v_max_f32_dpp v106, v106, v106 row_bcast:31 row_mask:0xc bank_mask:0xf
    v_mul_f32 v106, v106, v27
    s_nop 0
    v_readlane_b32 s72, v106, 63
    s_nop 1
    v_fma_f32 v104, v104, v27, -s72
    v_fma_f32 v105, v105, v27, -s72
    v_exp_f32 v104, v104
    v_exp_f32_e64 v105, v105
    s_nop 0
    v_cvt_pk_bf16_f32 v108, v104, v105
LS19_176:
    s_nop 1
    v_mov_b32_dpp v64, v108 row_newbcast:0 row_mask:0xf bank_mask:0x1
    v_mov_b32_dpp v65, v108 row_newbcast:0 row_mask:0xf bank_mask:0x2
    v_mov_b32_dpp v66, v108 row_newbcast:0 row_mask:0xf bank_mask:0x4
    v_mov_b32_dpp v67, v108 row_newbcast:0 row_mask:0xf bank_mask:0x8
    s_nop 0
    s_nop 0
    v_mfma_f32_16x16x32_bf16 v[72:75], v[64:67], v[126:129], 0
    v_mov_b32_dpp v68, v108 row_newbcast:1 row_mask:0xf bank_mask:0x1
    v_mov_b32_dpp v69, v108 row_newbcast:1 row_mask:0xf bank_mask:0x2
    v_mov_b32_dpp v70, v108 row_newbcast:1 row_mask:0xf bank_mask:0x4
    v_mfma_f32_16x16x32_bf16 v[76:79], v[64:67], v[130:133], 0
    v_mov_b32_dpp v71, v108 row_newbcast:1 row_mask:0xf bank_mask:0x8
    v_lshlrev_b32_e64 v107, 16, v108
    v_and_b32 v104, 0xffff0000, v108
    v_mfma_f32_16x16x32_bf16 v[72:75], v[68:71], v[134:137], v[72:75]
    v_mov_b32_dpp v64, v108 row_newbcast:2 row_mask:0xf bank_mask:0x1
    v_mov_b32_dpp v65, v108 row_newbcast:2 row_mask:0xf bank_mask:0x2
    v_mov_b32_dpp v66, v108 row_newbcast:2 row_mask:0xf bank_mask:0x4
    v_mfma_f32_16x16x32_bf16 v[76:79], v[68:71], v[138:141], v[76:79]
    v_mov_b32_dpp v67, v108 row_newbcast:2 row_mask:0xf bank_mask:0x8
    v_add_f32 v107, v107, v104
    s_nop 1
    v_add_f32_dpp v107, v107, v107 row_ror:1 row_mask:0xf bank_mask:0xf
    v_mfma_f32_16x16x32_bf16 v[72:75], v[64:67], v[142:145], v[72:75]
    v_mov_b32_dpp v68, v108 row_newbcast:3 row_mask:0xf bank_mask:0x1
    v_mov_b32_dpp v69, v108 row_newbcast:3 row_mask:0xf bank_mask:0x2
    v_mov_b32_dpp v70, v108 row_newbcast:3 row_mask:0xf bank_mask:0x4
    v_mfma_f32_16x16x32_bf16 v[76:79], v[64:67], v[146:149], v[76:79]
    v_mov_b32_dpp v71, v108 row_newbcast:3 row_mask:0xf bank_mask:0x8
    v_add_f32_dpp v107, v107, v107 row_ror:2 row_mask:0xf bank_mask:0xf
    s_nop 0
    v_mfma_f32_16x16x32_bf16 v[72:75], v[68:71], v[150:153], v[72:75]
    v_mov_b32_dpp v64, v108 row_newbcast:4 row_mask:0xf bank_mask:0x1
    v_mov_b32_dpp v65, v108 row_newbcast:4 row_mask:0xf bank_mask:0x2
    v_mov_b32_dpp v66, v108 row_newbcast:4 row_mask:0xf bank_mask:0x4
    v_mfma_f32_16x16x32_bf16 v[76:79], v[68:71], v[154:157], v[76:79]
    v_mov_b32_dpp v67, v108 row_newbcast:4 row_mask:0xf bank_mask:0x8
    v_add_f32_dpp v107, v107, v107 row_ror:4 row_mask:0xf bank_mask:0xf
    s_nop 0
    v_mfma_f32_16x16x32_bf16 v[72:75], v[64:67], v[158:161], v[72:75]
    v_mov_b32_dpp v68, v108 row_newbcast:5 row_mask:0xf bank_mask:0x1
    v_mov_b32_dpp v69, v108 row_newbcast:5 row_mask:0xf bank_mask:0x2
    v_mov_b32_dpp v70, v108 row_newbcast:5 row_mask:0xf bank_mask:0x4
    v_mfma_f32_16x16x32_bf16 v[76:79], v[64:67], v[162:165], v[76:79]
    v_mov_b32_dpp v71, v108 row_newbcast:5 row_mask:0xf bank_mask:0x8
    v_add_f32_dpp v107, v107, v107 row_ror:8 row_mask:0xf bank_mask:0xf
    s_nop 0
    v_mfma_f32_16x16x32_bf16 v[72:75], v[68:71], v[166:169], v[72:75]
    v_mov_b32_dpp v64, v108 row_newbcast:6 row_mask:0xf bank_mask:0x1
    v_mov_b32_dpp v65, v108 row_newbcast:6 row_mask:0xf bank_mask:0x2
    v_mov_b32_dpp v66, v108 row_newbcast:6 row_mask:0xf bank_mask:0x4
    v_mfma_f32_16x16x32_bf16 v[76:79], v[68:71], v[170:173], v[76:79]
    v_mov_b32_dpp v67, v108 row_newbcast:6 row_mask:0xf bank_mask:0x8
    v_add_f32_dpp v107, v107, v107 row_bcast:15 row_mask:0xa bank_mask:0xf
    s_nop 0
    v_mfma_f32_16x16x32_bf16 v[72:75], v[64:67], v[174:177], v[72:75]
    v_mov_b32_dpp v68, v108 row_newbcast:7 row_mask:0xf bank_mask:0x1
    v_mov_b32_dpp v69, v108 row_newbcast:7 row_mask:0xf bank_mask:0x2
    v_mov_b32_dpp v70, v108 row_newbcast:7 row_mask:0xf bank_mask:0x4
    v_mfma_f32_16x16x32_bf16 v[76:79], v[64:67], v[178:181], v[76:79]
    v_mov_b32_dpp v71, v108 row_newbcast:7 row_mask:0xf bank_mask:0x8
    v_add_f32_dpp v107, v107, v107 row_bcast:31 row_mask:0xc bank_mask:0xf
    s_nop 0
    v_mfma_f32_16x16x32_bf16 v[72:75], v[68:71], v[182:185], v[72:75]
    v_mov_b32_dpp v64, v108 row_newbcast:8 row_mask:0xf bank_mask:0x1
    v_mov_b32_dpp v65, v108 row_newbcast:8 row_mask:0xf bank_mask:0x2
    v_mov_b32_dpp v66, v108 row_newbcast:8 row_mask:0xf bank_mask:0x4
    v_mfma_f32_16x16x32_bf16 v[76:79], v[68:71], v[186:189], v[76:79]
    v_mov_b32_dpp v67, v108 row_newbcast:8 row_mask:0xf bank_mask:0x8
    ds_write_b64 v18, v[106:107]
    s_nop 0
    v_mfma_f32_16x16x32_bf16 v[72:75], v[64:67], v[190:193], v[72:75]
    v_mov_b32_dpp v68, v108 row_newbcast:9 row_mask:0xf bank_mask:0x1
    v_mov_b32_dpp v69, v108 row_newbcast:9 row_mask:0xf bank_mask:0x2
    v_mov_b32_dpp v70, v108 row_newbcast:9 row_mask:0xf bank_mask:0x4
    v_mfma_f32_16x16x32_bf16 v[76:79], v[64:67], v[194:197], v[76:79]
    v_mov_b32_dpp v71, v108 row_newbcast:9 row_mask:0xf bank_mask:0x8
    s_waitcnt lgkmcnt(0)
    s_barrier
    ds_read_b64 v[110:111], v19
    v_mfma_f32_16x16x32_bf16 v[72:75], v[68:71], v[198:201], v[72:75]
    v_mov_b32_dpp v64, v108 row_newbcast:10 row_mask:0xf bank_mask:0x1
    v_mov_b32_dpp v65, v108 row_newbcast:10 row_mask:0xf bank_mask:0x2
    v_mov_b32_dpp v66, v108 row_newbcast:10 row_mask:0xf bank_mask:0x4
    v_mfma_f32_16x16x32_bf16 v[76:79], v[68:71], v[202:205], v[76:79]
    v_mov_b32_dpp v67, v108 row_newbcast:10 row_mask:0xf bank_mask:0x8
    s_nop 0
    s_nop 0
    v_mfma_f32_16x16x32_bf16 v[72:75], v[64:67], v[206:209], v[72:75]
    v_mov_b32_dpp v68, v108 row_newbcast:11 row_mask:0xf bank_mask:0x1
    v_mov_b32_dpp v69, v108 row_newbcast:11 row_mask:0xf bank_mask:0x2
    v_mov_b32_dpp v70, v108 row_newbcast:11 row_mask:0xf bank_mask:0x4
    v_mfma_f32_16x16x32_bf16 v[76:79], v[64:67], v[210:213], v[76:79]
    v_mov_b32_dpp v71, v108 row_newbcast:11 row_mask:0xf bank_mask:0x8
    s_waitcnt lgkmcnt(0)
    s_nop 0
    v_mfma_f32_16x16x32_bf16 v[72:75], v[68:71], v[214:217], v[72:75]
    v_mov_b32_dpp v64, v108 row_newbcast:12 row_mask:0xf bank_mask:0x1
    v_mov_b32_dpp v65, v108 row_newbcast:12 row_mask:0xf bank_mask:0x2
    v_mov_b32_dpp v66, v108 row_newbcast:12 row_mask:0xf bank_mask:0x4
    v_mfma_f32_16x16x32_bf16 v[76:79], v[68:71], v[218:221], v[76:79]
    v_mov_b32_dpp v67, v108 row_newbcast:12 row_mask:0xf bank_mask:0x8
    v_max_f32_dpp v112, v110, v110 quad_perm:[1,0,3,2] row_mask:0xf bank_mask:0xf
    s_nop 0
    v_mfma_f32_16x16x32_bf16 v[72:75], v[64:67], v[222:225], v[72:75]
    v_mov_b32_dpp v68, v108 row_newbcast:13 row_mask:0xf bank_mask:0x1
    v_mov_b32_dpp v69, v108 row_newbcast:13 row_mask:0xf bank_mask:0x2
    v_mov_b32_dpp v70, v108 row_newbcast:13 row_mask:0xf bank_mask:0x4
    v_mfma_f32_16x16x32_bf16 v[76:79], v[64:67], v[226:229], v[76:79]
    v_mov_b32_dpp v71, v108 row_newbcast:13 row_mask:0xf bank_mask:0x8
    v_max_f32_dpp v112, v112, v112 quad_perm:[2,3,0,1] row_mask:0xf bank_mask:0xf
    v_sub_f32 v109, v110, v112
    v_mfma_f32_16x16x32_bf16 v[72:75], v[68:71], v[230:233], v[72:75]
    v_mov_b32_dpp v64, v108 row_newbcast:14 row_mask:0xf bank_mask:0x1
    v_mov_b32_dpp v65, v108 row_newbcast:14 row_mask:0xf bank_mask:0x2
    v_mov_b32_dpp v66, v108 row_newbcast:14 row_mask:0xf bank_mask:0x4
    v_mfma_f32_16x16x32_bf16 v[76:79], v[68:71], v[234:237], v[76:79]
    v_mov_b32_dpp v67, v108 row_newbcast:14 row_mask:0xf bank_mask:0x8
    v_exp_f32 v109, v109
    s_nop 0
    v_mfma_f32_16x16x32_bf16 v[72:75], v[64:67], v[238:241], v[72:75]
    v_mov_b32_dpp v68, v108 row_newbcast:15 row_mask:0xf bank_mask:0x1
    v_mov_b32_dpp v69, v108 row_newbcast:15 row_mask:0xf bank_mask:0x2
    v_mov_b32_dpp v70, v108 row_newbcast:15 row_mask:0xf bank_mask:0x4
    v_mfma_f32_16x16x32_bf16 v[76:79], v[64:67], v[242:245], v[76:79]
    v_mov_b32_dpp v71, v108 row_newbcast:15 row_mask:0xf bank_mask:0x8
    v_mul_f32_e64 v113, v109, v111
    s_nop 0
    v_mfma_f32_16x16x32_bf16 v[72:75], v[68:71], v[246:249], v[72:75]
    v_mfma_f32_16x16x32_bf16 v[76:79], v[68:71], v[250:253], v[76:79]
    v_add_f32_dpp v113, v113, v113 quad_perm:[1,0,3,2] row_mask:0xf bank_mask:0xf
    s_nop 1
    v_add_f32_dpp v113, v113, v113 quad_perm:[2,3,0,1] row_mask:0xf bank_mask:0xf
    s_cmp_lg_u32 s7, 0
    s_cbranch_scc1 Lnos_177
    s_mov_b64 exec, 0x10001
    buffer_store_dwordx2 v[112:113], v1, s[16:19], s65 offen
    s_mov_b64 exec, -1
Lnos_177:
LS20_178:
    s_nop 0
    v_mul_f32_dpp v104, v109, v72 quad_perm:[0,0,0,0] row_mask:0xf bank_mask:0xf
    v_mul_f32_dpp v105, v109, v76 quad_perm:[0,0,0,0] row_mask:0xf bank_mask:0xf
    ds_write2_b32 v20, v104, v105 offset0:0 offset1:64
    s_cmp_lg_u32 s7, 0
    s_waitcnt lgkmcnt(0)
    s_barrier
    s_cbranch_scc1 Lsk_179
    ds_read2_b64 v[72:75], v21 offset0:0 offset1:64
    ds_read2_b64 v[76:79], v21 offset0:128 offset1:192
    s_waitcnt lgkmcnt(1)
    v_pk_add_f32 v[72:73], v[72:73], v[74:75]
    s_waitcnt lgkmcnt(0)
    v_pk_add_f32 v[76:77], v[76:77], v[78:79]
    v_pk_add_f32 v[72:73], v[72:73], v[76:77]
    v_cvt_pk_bf16_f32 v72, v72, v73
    buffer_store_dword v72, v8, s[16:19], s64 offen
Lsk_179:
LS21_180:
    v_and_b32 v113, 0x30, v0
    s_cmp_lg_u32 s7, 1
    s_cbranch_scc1 Lb_181
    s_nop 15
    s_nop 15
    s_nop 15
    s_nop 15
    s_nop 15
    s_nop 15
    s_nop 15
    s_nop 15
    s_nop 15
    s_nop 15
    s_nop 15
    s_nop 15
    s_nop 15
    s_nop 15
    s_nop 15
    s_nop 15
    s_nop 15
    s_nop 15
    s_nop 15
    v_mov_b32 v42, 0
    v_mov_b32 v43, 0
    buffer_atomic_or_x2 v[42:43], v13, s[16:19], s66 offen offset:128 sc0 sc1
    v_and_b32_e64 v112, 7, v0
    v_lshl_add_u32 v112, v112, 1, v113
    s_nop 15
    s_nop 15
    s_nop 15
    v_mov_b32 v44, 0
    v_mov_b32 v45, 0
    buffer_atomic_or_x2 v[44:45], v13, s[16:19], s66 offen offset:128 sc0 sc1
    s_nop 15
    s_nop 15
    s_nop 15
Lp_182:
    v_mov_b32 v46, 0
    v_mov_b32 v47, 0
    buffer_atomic_or_x2 v[46:47], v13, s[16:19], s66 offen offset:128 sc0 sc1
    s_waitcnt vmcnt(2)
    v_cmp_gt_u32 vcc, 0x41000000, v43
    v_add_f64 v[110:111], v[42:43], v[40:41]
    s_cbranch_vccz Lok_183
    v_mov_b32 v42, 0
    v_mov_b32 v43, 0
    buffer_atomic_or_x2 v[42:43], v13, s[16:19], s66 offen offset:128 sc0 sc1
    s_waitcnt vmcnt(2)
    v_cmp_gt_u32 vcc, 0x41000000, v45
    v_add_f64 v[110:111], v[44:45], v[40:41]
    s_cbranch_vccz Lok_183
    v_mov_b32 v44, 0
    v_mov_b32 v45, 0
    buffer_atomic_or_x2 v[44:45], v13, s[16:19], s66 offen offset:128 sc0 sc1
    s_waitcnt vmcnt(2)
    v_cmp_gt_u32 vcc, 0x41000000, v47
    v_add_f64 v[110:111], v[46:47], v[40:41]
    s_cbranch_vccz Lok_183
    s_sub_u32 s69, s69, 1
    s_cbranch_scc0 Lp_182
    s_mov_b32 s69, 0
Lok_183:
    v_cvt_f32_f64_e64 v109, v[110:111]
    s_nop 1
    v_add_f32_dpp v109, v109, v109 row_ror:8 row_mask:0xf bank_mask:0xf
    v_cvt_pk_bf16_f32 v109, v109, v109
    ds_write_b16 v112, v109 offset:10240
    s_waitcnt lgkmcnt(0)
Lb_181:
    s_barrier
    ds_read_b128 v[32:35], v113 offset:10240
    s_nop 0
    s_waitcnt lgkmcnt(0)
LS23_184:
    v_mfma_f32_16x16x32_bf16 v[72:75], v[32:35], a[192:195], 0
    v_mov_b32_dpp v36, v32 quad_perm:[0,1,2,3] row_mask:0xf bank_mask:0x3
    v_mov_b32_dpp v37, v33 quad_perm:[0,1,2,3] row_mask:0xf bank_mask:0x3
    v_mfma_f32_16x16x32_bf16 v[76:79], v[32:35], a[196:199], 0
    v_mov_b32_dpp v38, v34 quad_perm:[0,1,2,3] row_mask:0xf bank_mask:0x3
    v_mov_b32_dpp v39, v35 quad_perm:[0,1,2,3] row_mask:0xf bank_mask:0x3
    v_mfma_f32_16x16x32_bf16 v[80:83], v[32:35], a[200:203], 0
    v_mfma_f32_16x16x32_bf16 v[84:87], v[32:35], a[204:207], 0
    v_mfma_f32_16x16x32_bf16 v[120:123], v[32:35], v[36:39], 0
    s_mov_b64 exec, 0xffff
    s_nop 1
    v_mov_b32 v73, v76
    s_nop 1
    v_mov_b32 v74, v80
    v_mov_b32 v75, v84
    buffer_store_dwordx4 v[72:75], v14, s[16:19], s64 offen
    s_mov_b64 exec, 0x101
    buffer_store_dword v120, v5, s[16:19], s64 offen offset:256
    s_mov_b64 exec, -1
    s_mov_b32 exec_lo, 0x00ff00ff
    s_mov_b32 exec_hi, 0x00ff00ff
    v_lshlrev_b32 v112, 16, v109
    v_accvgpr_read_b32 v113, a226
    v_lshlrev_b32 v113, 16, v113
    v_add_f32 v112, v112, v113
    v_cvt_f64_f32 v[40:41], v112
    v_add_f64 v[40:41], v[40:41], -s[0:1]
    s_mov_b64 exec, -1
LS24_185:
    s_mov_b32 s67, s3
    s_cmp_lg_u32 s67, 0
    s_cbranch_scc1 Lfin_186
    v_and_b32 v113, 0x30, v0
    s_cmp_lg_u32 s7, 1
    s_cbranch_scc1 Lb_187
    s_waitcnt vmcnt(0)
    v_mov_b32 v42, 0
    v_mov_b32 v43, 0
    buffer_atomic_or_x2 v[42:43], v13, s[16:19], s66 offen offset:192 sc0 sc1
    v_and_b32 v112, 7, v0
    v_lshl_add_u32 v112, v112, 1, v113
    s_lshl_b32 s67, s74, 6
    s_nop 15
    s_nop 15
    v_mov_b32 v44, 0
    v_mov_b32 v45, 0
    buffer_atomic_or_x2 v[44:45], v13, s[16:19], s66 offen offset:192 sc0 sc1
    s_nop 15
    s_nop 15
Lp_188:
    v_mov_b32 v46, 0
    v_mov_b32 v47, 0
    buffer_atomic_or_x2 v[46:47], v13, s[16:19], s66 offen offset:192 sc0 sc1
    s_waitcnt vmcnt(2)
    v_cmp_gt_u32 vcc, 0x41000000, v43
    v_add_f64 v[110:111], v[42:43], v[40:41]
    s_cbranch_vccz Lok_189
    v_mov_b32 v42, 0
    v_mov_b32_e64 v43, 0
    buffer_atomic_or_x2 v[42:43], v13, s[16:19], s66 offen offset:192 sc0 sc1
    s_waitcnt vmcnt(2)
    v_cmp_gt_u32 vcc, 0x41000000, v45
    v_add_f64 v[110:111], v[44:45], v[40:41]
    s_cbranch_vccz Lok_189
    v_mov_b32 v44, 0
    v_mov_b32 v45, 0
    buffer_atomic_or_x2 v[44:45], v13, s[16:19], s66 offen offset:192 sc0 sc1
    s_waitcnt vmcnt(2)
    v_cmp_gt_u32 vcc, 0x41000000, v47
    v_add_f64 v[110:111], v[46:47], v[40:41]
    s_cbranch_vccz Lok_189
    s_sub_u32 s69, s69, 1
    s_cbranch_scc0 Lp_188
    s_mov_b32 s69, 0
Lok_189:
    v_cvt_f32_f64 v109, v[110:111]
    s_nop 1
    v_add_f32_dpp v109, v109, v109 row_ror:8 row_mask:0xf bank_mask:0xf
    v_cvt_pk_bf16_f32 v109, v109, v109
    s_mov_b32 exec_lo, 0x00ff00ff
    s_mov_b32 exec_hi, 0x00ff00ff
    buffer_store_short v109, v112, s[48:51], s67 offen
    s_mov_b64 exec, -1
Lb_187:
Lfin_186:
    s_endpgm
Lretry_135:
    s_cmp_eq_u32 s69, 0
    s_cbranch_scc1 Lfok_133
    s_sub_u32 s69, s69, 1
    s_branch Lfp_132
Lfp_132:
    buffer_load_dword v114, v118, s[52:55], s77 offen sc1
    s_waitcnt vmcnt(0)
    s_branch Lfc_134
Lqp_138:
    buffer_load_dwordx4 v[76:79], v4, s[16:19], 0 offen sc1
    buffer_load_dwordx4 v[72:75], v3, s[16:19], 0 offen sc1
    s_waitcnt vmcnt(0)
    s_branch Lq_137
Lretry_140:
    s_cmp_eq_u32 s69, 0
    s_cbranch_scc1 Lok_139
    s_sub_u32 s69, s69, 1
    s_branch Lqp_138
Lretry_153:
    s_cmp_eq_u32 s69, 0
    s_cbranch_scc1 Lfok_151
    s_sub_u32 s69, s69, 1
    s_branch Lfp_150
Lfp_150:
    buffer_load_dword v114, v119, s[52:55], 0 offen sc1
    s_waitcnt vmcnt(0)
    s_branch Lfc_152
Lgive_155:
    s_mov_b32 s69, 0
    s_waitcnt vmcnt(0)
    s_branch Lok_156
Lbw_169:
    s_waitcnt vmcnt(0)
    s_branch Lb_165
Lgive_174:
    s_mov_b32 s69, 0
    s_waitcnt vmcnt(0)
    s_branch Lok_173
    s_nop 0
    s_nop 0
    s_nop 0
    s_nop 0
    s_nop 0
    s_nop 0
    s_nop 0
    s_nop 0
    s_nop 0
    s_nop 0
    s_nop 0
    s_nop 0
    s_nop 0
    s_nop 0
L_fastend:
L_loopA_slow:
LS10_190:
    s_nop 0
    v_mul_f32_dpp v104, v109, v72 quad_perm:[0,0,0,0] row_mask:0xf bank_mask:0xf
    s_nop 0
    v_mul_f32_dpp v105, v109, v76 quad_perm:[0,0,0,0] row_mask:0xf bank_mask:0xf
    ds_write2_b32 v20, v104, v105 offset0:0 offset1:64
    s_cmp_lg_u32 s7, 0
    s_waitcnt lgkmcnt(0)
    s_barrier
    s_cbranch_scc1 Lsk_191
    ds_read2_b64 v[72:75], v21 offset0:0 offset1:64
    ds_read2_b64 v[76:79], v21 offset0:128 offset1:192
    s_waitcnt lgkmcnt(1)
    v_pk_add_f32 v[72:73], v[72:73], v[74:75]
    s_waitcnt lgkmcnt(0)
    v_pk_add_f32 v[76:77], v[76:77], v[78:79]
    v_pk_add_f32 v[72:73], v[72:73], v[76:77]
    v_cvt_pk_bf16_f32 v72, v72, v73
    buffer_store_dword v72, v8, s[16:19], s64 offen sc1
Lsk_191:
LS11_192:
    s_nop 0
    s_barrier
    s_add_u32 s90, s90, 86400
    buffer_load_dwordx2 a[208:209], v25, s[32:35], s90 offen
    s_add_u32 s90, s90, 3456
    buffer_load_dwordx2 a[210:211], v25, s[32:35], s90 offen
    s_add_u32 s90, s90, 3456
    buffer_load_dwordx2 a[212:213], v25, s[32:35], s90 offen
    s_add_u32 s90, s90, 3456
    buffer_load_dwordx2 a[214:215], v25, s[32:35], s90 offen
    s_add_u32 s90, s90, 3456
    buffer_load_dwordx2 a[216:217], v25, s[32:35], s90 offen
    s_add_u32 s90, s90, 3456
    buffer_load_dwordx2 a[218:219], v25, s[32:35], s90 offen
    s_add_u32 s90, s90, 3456
    buffer_load_dwordx2 a[220:221], v25, s[32:35], s90 offen
    s_add_u32 s90, s90, 3456
    buffer_load_dwordx2 a[222:223], v25, s[32:35], s90 offen
    s_nop 0
    s_waitcnt vmcnt(22)
Lfc_195:
    v_and_b32 v120, 0x80808080, v114
    v_cmp_ne_u32 vcc, 0x80808080, v120
    s_cbranch_vccnz Lretry_196
Lfok_194:
    v_and_b32 v120, 0x40404040, v114
    v_bcnt_u32_b32 v120, v120, 0
    s_nop 1
    v_add_u32_dpp v120, v120, v120 row_ror:1 row_mask:0xf bank_mask:0xf
    s_nop 1
    v_add_u32_dpp v120, v120, v120 row_ror:2 row_mask:0xf bank_mask:0xf
    s_nop 1
    v_add_u32_dpp v120, v120, v120 row_ror:4 row_mask:0xf bank_mask:0xf
    s_nop 1
    v_add_u32_dpp v120, v120, v120 row_ror:8 row_mask:0xf bank_mask:0xf
    s_nop 1
    v_add_u32_dpp v120, v120, v120 row_bcast:15 row_mask:0xa bank_mask:0xf
    s_nop 1
    v_add_u32_dpp v120, v120, v120 row_bcast:31 row_mask:0xc bank_mask:0xf
    s_nop 0
    v_readlane_b32 s67, v120, 63
    s_nop 0
    s_cmp_gt_u32 s67, 16
    s_cselect_b32 s67, 0, 0x2000
    s_lshl_b32 s68, s75, 11
    s_and_b32 s68, s68, 0x2000
    s_xor_b32 s66, s67, s68
    v_bfe_u32 v105, v0, 3, 2
    v_lshlrev_b32 v105, 11, v105
    v_and_b32 v104, 7, v0
    v_lshl_add_u32 v105, v104, 4, v105
    s_add_u32 s67, s76, 0x6000
Lp_197:
    buffer_load_dword v104, v105, s[16:19], s67 offen sc1
    s_sub_u32 s69, s69, 1
    s_cbranch_scc1 Lgive_198
    s_waitcnt vmcnt(0)
    v_cmp_eq_u32 vcc, -1, v104
    s_cbranch_vccnz Lp_197
Lok_199:
    s_bitcmp0_b32 s7, 0
    s_cbranch_scc1 La_203
    v_mov_b32 v42, 0
    v_mov_b32_e64 v43, 0
    buffer_atomic_or_x2 v[42:43], v13, s[16:19], s66 offen offset:0 sc0 sc1
La_203:
    v_accvgpr_read_b32 v72, a192
    v_accvgpr_read_b32 v73, a193
    v_accvgpr_read_b32 v74, a194
    v_accvgpr_read_b32 v75, a195
    v_accvgpr_read_b32 v76, a196
    v_accvgpr_read_b32 v77, a197
    v_accvgpr_read_b32 v78, a198
    v_accvgpr_read_b32 v79, a199
    v_accvgpr_read_b32 v80, a200
    v_accvgpr_read_b32 v81, a201
    v_accvgpr_read_b32 v82, a202
    v_accvgpr_read_b32 v83, a203
    v_accvgpr_read_b32 v84, a204
    v_accvgpr_read_b32 v85, a205
    v_accvgpr_read_b32 v86, a206
    v_accvgpr_read_b32 v87, a207
    v_perm_b32 v88, v74, v72, s70
    v_accvgpr_write_b32 a192, v88
    v_perm_b32 v89, v78, v76, s70
    v_accvgpr_write_b32 a193, v89
    v_perm_b32 v88, v82, v80, s70
    v_accvgpr_write_b32 a194, v88
    v_perm_b32 v89, v86, v84, s70
    v_accvgpr_write_b32 a195, v89
    v_perm_b32 v88, v74, v72, s71
    v_accvgpr_write_b32 a196, v88
    v_perm_b32 v89, v78, v76, s71
    v_accvgpr_write_b32 a197, v89
    v_perm_b32 v88, v82, v80, s71
    v_accvgpr_write_b32 a198, v88
    v_perm_b32 v89, v86, v84, s71
    v_accvgpr_write_b32 a199, v89
    v_perm_b32 v88, v75, v73, s70
    v_accvgpr_write_b32 a200, v88
    v_perm_b32 v89, v79, v77, s70
    v_accvgpr_write_b32 a201, v89
    v_perm_b32 v88, v83, v81, s70
    v_accvgpr_write_b32 a202, v88
    v_perm_b32 v89, v87, v85, s70
    v_accvgpr_write_b32 a203, v89
    v_perm_b32 v88, v75, v73, s71
    v_accvgpr_write_b32 a204, v88
    v_perm_b32 v89, v79, v77, s71
    v_accvgpr_write_b32 a205, v89
    v_perm_b32 v88, v83, v81, s71
    v_accvgpr_write_b32 a206, v88
    v_perm_b32 v89, v87, v85, s71
    v_accvgpr_write_b32 a207, v89
    s_bitcmp0_b32 s7, 0
    s_cbranch_scc1 La_204
    v_mov_b32 v44, 0
    v_mov_b32 v45, 0
    buffer_atomic_or_x2 v[44:45], v13, s[16:19], s66 offen offset:0 sc0 sc1
La_204:
    v_accvgpr_read_b32 v72, a208
    v_accvgpr_read_b32 v73, a209
    v_accvgpr_read_b32 v74, a210
    v_accvgpr_read_b32 v75, a211
    v_accvgpr_read_b32 v76, a212
    v_accvgpr_read_b32 v77, a213
    v_accvgpr_read_b32 v78, a214
    v_accvgpr_read_b32 v79, a215
    v_accvgpr_read_b32 v80, a216
    v_accvgpr_read_b32 v81, a217
    v_accvgpr_read_b32 v82, a218
    v_accvgpr_read_b32 v83, a219
    v_accvgpr_read_b32 v84, a220
    v_accvgpr_read_b32 v85, a221
    v_accvgpr_read_b32 v86, a222
    v_accvgpr_read_b32 v87, a223
    v_perm_b32 v88, v74, v72, s70
    v_accvgpr_write_b32 a208, v88
    v_perm_b32 v89, v78, v76, s70
    v_accvgpr_write_b32 a209, v89
    v_perm_b32 v88, v82, v80, s70
    v_accvgpr_write_b32 a210, v88
    v_perm_b32 v89, v86, v84, s70
    v_accvgpr_write_b32 a211, v89
    v_perm_b32 v88, v74, v72, s71
    v_accvgpr_write_b32 a212, v88
    v_perm_b32 v89, v78, v76, s71
    v_accvgpr_write_b32 a213, v89
    v_perm_b32 v88, v82, v80, s71
    v_accvgpr_write_b32 a214, v88
    v_perm_b32 v89, v86, v84, s71
    v_accvgpr_write_b32 a215, v89
    v_perm_b32 v88, v75, v73, s70
    v_accvgpr_write_b32 a216, v88
    v_perm_b32 v89, v79, v77, s70
    v_accvgpr_write_b32 a217, v89
    v_perm_b32 v88, v83, v81, s70
    v_accvgpr_write_b32 a218, v88
    v_perm_b32 v89, v87, v85, s70
    v_accvgpr_write_b32 a219, v89
    v_perm_b32 v88, v75, v73, s71
    v_accvgpr_write_b32 a220, v88
    v_perm_b32 v89, v79, v77, s71
    v_accvgpr_write_b32 a221, v89
    v_perm_b32 v88, v83, v81, s71
    v_accvgpr_write_b32 a222, v88
    v_perm_b32 v89, v87, v85, s71
    v_accvgpr_write_b32 a223, v89
    s_mov_b32 s68, 0xe8000
    v_mfma_f32_16x16x32_bf16 v[72:75], v[36:39], a[192:195], 0
    v_mfma_f32_16x16x32_bf16 v[76:79], v[36:39], a[196:199], 0
    v_mfma_f32_16x16x32_bf16 v[80:83], v[36:39], a[200:203], 0
    v_mfma_f32_16x16x32_bf16 v[84:87], v[36:39], a[204:207], 0
    v_mfma_f32_16x16x32_bf16 v[72:75], v[36:39], a[208:211], v[72:75]
    v_mfma_f32_16x16x32_bf16 v[76:79], v[36:39], a[212:215], v[76:79]
    v_mfma_f32_16x16x32_bf16 v[80:83], v[36:39], a[216:219], v[80:83]
    v_mfma_f32_16x16x32_bf16 v[84:87], v[36:39], a[220:223], v[84:87]
    s_mov_b64 exec, 0xffff
    s_nop 4
    v_mov_b32 v73, v76
    v_mov_b32 v74, v80
    v_mov_b32 v75, v84
    buffer_store_dwordx4 v[72:75], v14, s[16:19], s68 offen sc1
    s_mov_b64 exec, -1
    v_and_b32 v113, 0x30, v0
    s_cmp_lg_u32 s7, 0
    s_cbranch_scc1 Lpr_205
    s_branch Lb_200
Lpr_205:
    s_bitcmp0_b32 s7, 0
    s_cbranch_scc1 Lb_200
    v_and_b32 v112, 7, v0
    v_lshl_add_u32 v112, v112, 1, v113
    s_and_b32 s67, s74, 1
    s_lshl_b32 s67, s67, 6
    v_add_u32 v112, s67, v112
Lp_201:
    v_mov_b32 v46, 0
    v_mov_b32 v47, 0
    buffer_atomic_or_x2 v[46:47], v13, s[16:19], s66 offen offset:0 sc0 sc1
    s_waitcnt vmcnt(2)
    v_cmp_gt_u32 vcc, 0x41000000, v43
    v_add_f64 v[110:111], v[42:43], v[40:41]
    s_cbranch_vccz Lok_202
    v_mov_b32 v42, 0
    v_mov_b32 v43, 0
    buffer_atomic_or_x2 v[42:43], v13, s[16:19], s66 offen offset:0 sc0 sc1
    s_waitcnt vmcnt(2)
    v_cmp_gt_u32 vcc, 0x41000000, v45
    v_add_f64 v[110:111], v[44:45], v[40:41]
    s_cbranch_vccz Lok_202
    v_mov_b32 v44, 0
    v_mov_b32_e64 v45, 0
    buffer_atomic_or_x2 v[44:45], v13, s[16:19], s66 offen offset:0 sc0 sc1
    s_waitcnt vmcnt(2)
    v_cmp_gt_u32 vcc, 0x41000000, v47
    v_add_f64 v[110:111], v[46:47], v[40:41]
    s_cbranch_vccz Lok_202
    s_sub_u32 s69, s69, 1
    s_cbranch_scc0 Lp_201
    s_mov_b32 s69, 0
Lok_202:
    v_cvt_f32_f64_e64 v109, v[110:111]
    s_nop 1
    v_add_f32_dpp v109, v109, v109 row_ror:8 row_mask:0xf bank_mask:0xf
    v_cvt_pk_bf16_f32 v109, v109, v109
    ds_write_b16 v112, v109 offset:10240
    s_waitcnt lgkmcnt(0)
Lb_200:
    s_barrier
    ds_read_b128 v[32:35], v113 offset:10240
    ds_read_b128 v[28:31], v113 offset:10304
    s_nop 0
    s_waitcnt lgkmcnt(1)
LS13_206:
    v_mfma_f32_16x16x32_bf16 v[72:75], v[32:35], a[192:195], 0
    v_mov_b32_dpp v36, v32 quad_perm:[0,1,2,3] row_mask:0xf bank_mask:0x3
    v_mov_b32_dpp v37, v33 quad_perm:[0,1,2,3] row_mask:0xf bank_mask:0x3
    v_mfma_f32_16x16x32_bf16 v[76:79], v[32:35], a[196:199], 0
    v_mov_b32_dpp v38, v34 quad_perm:[0,1,2,3] row_mask:0xf bank_mask:0x3
    v_mov_b32_dpp v39, v35 quad_perm:[0,1,2,3] row_mask:0xf bank_mask:0x3
    v_mfma_f32_16x16x32_bf16 v[80:83], v[32:35], a[200:203], 0
    v_mfma_f32_16x16x32_bf16 v[84:87], v[32:35], a[204:207], 0
    v_mfma_f32_16x16x32_bf16 v[120:123], v[32:35], v[36:39], 0
    s_nop 0
    s_waitcnt lgkmcnt(0)
    v_mfma_f32_16x16x32_bf16 v[72:75], v[28:31], a[208:211], v[72:75]
    v_mov_b32_dpp v36, v28 quad_perm:[0,1,2,3] row_mask:0xf bank_mask:0x3
    v_mov_b32_dpp v37, v29 quad_perm:[0,1,2,3] row_mask:0xf bank_mask:0x3
    v_mfma_f32_16x16x32_bf16 v[76:79], v[28:31], a[212:215], v[76:79]
    v_mov_b32_dpp v38, v30 quad_perm:[0,1,2,3] row_mask:0xf bank_mask:0x3
    v_mov_b32_dpp v39, v31 quad_perm:[0,1,2,3] row_mask:0xf bank_mask:0x3
    v_mfma_f32_16x16x32_bf16 v[80:83], v[28:31], a[216:219], v[80:83]
    v_mfma_f32_16x16x32_bf16 v[84:87], v[28:31], a[220:223], v[84:87]
    v_mfma_f32_16x16x32_bf16 v[120:123], v[28:31], v[36:39], v[120:123]
    s_mov_b64 exec, 0xffff
    s_nop 1
    v_mov_b32 v73, v76
    s_nop 1
    v_mov_b32 v74, v80
    v_mov_b32 v75, v84
    buffer_store_dwordx4 v[72:75], v14, s[16:19], s64 offen sc1
    s_mov_b64 exec, 0x101
    buffer_store_dword v120, v5, s[16:19], s64 offen offset:256 sc1
    s_mov_b64 exec, -1
    s_mov_b32 exec_lo, 0x00ff00ff
    s_mov_b32 exec_hi, 0x00ff00ff
    v_lshlrev_b32 v112, 16, v109
    v_accvgpr_read_b32 v113, a226
    v_lshlrev_b32 v113, 16, v113
    v_add_f32 v112, v112, v113
    v_cvt_f64_f32 v[40:41], v112
    v_add_f64 v[40:41], v[40:41], -s[0:1]
    s_mov_b64 exec, -1
LS14_207:
    v_and_b32 v113, 0x30, v0
    s_cmp_lg_u32 s7, 0
    s_cbranch_scc1 Lpr_211
    s_lshl_b32 s56, s3, 3
    s_lshl_b64 exec, 0xff, s56
    s_movk_i32 s66, 0x2000
    v_mov_b32 v42, 0
    v_mov_b32 v43, 0
    v_mov_b32 v44, 0
    v_mov_b32 v45, 0
    buffer_atomic_or_x2 v[42:43], v13, s[16:19], 0 offen offset:192 sc0 sc1
    buffer_atomic_or_x2 v[44:45], v13, s[16:19], s66 offen offset:192 sc0 sc1
    s_mov_b64 exec, -1
    s_waitcnt vmcnt(1)
    s_memtime s[56:57]
    s_waitcnt vmcnt(0)
    s_memtime s[58:59]
    s_waitcnt lgkmcnt(0)
    s_sub_u32 s56, s58, s56
    s_cmp_gt_u32 s56, 64
    s_cselect_b32 s66, 0, 8192
    v_mov_b32 v42, s66
    v_mov_b32 v43, 0
    ds_write_b32 v43, v42 offset:10368
Lpr_211:
    s_waitcnt vmcnt(0) lgkmcnt(0)
    s_barrier
    s_mov_b32 s68, 0xe8000
    buffer_load_dwordx4 a[248:251], v4, s[16:19], s68 offen sc1
    buffer_load_dwordx4 a[244:247], v3, s[16:19], s68 offen sc1
    s_bitcmp0_b32 s7, 0
    s_cbranch_scc1 Lbw_212
    s_bitcmp0_b32 s7, 0
    s_cbranch_scc1 Lb_208
    v_mov_b32 v43, 0
    ds_read_b32 v42, v43 offset:10368
    s_waitcnt lgkmcnt(0)
    v_readfirstlane_b32 s67, v42
    s_nop 0
    s_and_b32 s66, s67, 0x2000
    s_nop 15
    s_nop 15
    s_nop 15
    v_mov_b32 v42, 0
    v_mov_b32 v43, 0
    buffer_atomic_or_x2 v[42:43], v13, s[16:19], s66 offen offset:64 sc0 sc1
    v_and_b32 v112, 7, v0
    v_lshl_add_u32 v112, v112, 1, v113
    s_and_b32 s67, s74, 1
    s_lshl_b32 s67, s67, 6
    v_add_u32 v112, s67, v112
    s_nop 15
    s_nop 15
    s_nop 15
    v_mov_b32 v44, 0
    v_mov_b32 v45, 0
    buffer_atomic_or_x2 v[44:45], v13, s[16:19], s66 offen offset:64 sc0 sc1
    s_nop 15
    s_nop 15
    s_nop 15
Lp_209:
    v_mov_b32 v46, 0
    v_mov_b32 v47, 0
    buffer_atomic_or_x2 v[46:47], v13, s[16:19], s66 offen offset:64 sc0 sc1
    s_waitcnt vmcnt(2)
    v_cmp_gt_u32 vcc, 0x41000000, v43
    v_add_f64 v[110:111], v[42:43], v[40:41]
    s_cbranch_vccz Lok_210
    v_mov_b32 v42, 0
    v_mov_b32 v43, 0
    buffer_atomic_or_x2 v[42:43], v13, s[16:19], s66 offen offset:64 sc0 sc1
    s_waitcnt vmcnt(2)
    v_cmp_gt_u32 vcc, 0x41000000, v45
    v_add_f64 v[110:111], v[44:45], v[40:41]
    s_cbranch_vccz Lok_210
    v_mov_b32 v44, 0
    v_mov_b32 v45, 0
    buffer_atomic_or_x2 v[44:45], v13, s[16:19], s66 offen offset:64 sc0 sc1
    s_waitcnt vmcnt(2)
    v_cmp_gt_u32 vcc, 0x41000000, v47
    v_add_f64 v[110:111], v[46:47], v[40:41]
    s_cbranch_vccz Lok_210
    s_sub_u32 s69, s69, 1
    s_cbranch_scc0 Lp_209
    s_mov_b32 s69, 0
Lok_210:
    v_cvt_f32_f64 v109, v[110:111]
    s_nop 1
    v_add_f32_dpp v109, v109, v109 row_ror:8 row_mask:0xf bank_mask:0xf
    v_cvt_pk_bf16_f32 v109, v109, v109
    ds_write_b16 v112, v109 offset:10240
    s_waitcnt lgkmcnt(0)
Lb_208:
    s_barrier
    ds_read_b128 v[32:35], v113 offset:10240
    ds_read_b128 v[28:31], v113 offset:10304
    s_nop 0
    s_waitcnt lgkmcnt(1)
LS16_213:
    s_mov_b32 s64, 0x74000
    s_add_u32 s65, s79, 0x74000
    v_mfma_f32_16x16x32_bf16 v[72:75], v[32:35], a[128:131], 0
    v_mov_b32_dpp v36, v32 quad_perm:[0,1,2,3] row_mask:0xf bank_mask:0x3
    v_mov_b32_dpp v37, v33 quad_perm:[0,1,2,3] row_mask:0xf bank_mask:0x3
    v_mfma_f32_16x16x32_bf16 v[88:91], v[32:35], a[144:147], 0
    v_mov_b32_dpp v38, v34 quad_perm:[0,1,2,3] row_mask:0xf bank_mask:0x3
    v_mov_b32_dpp v39, v35 quad_perm:[0,1,2,3] row_mask:0xf bank_mask:0x3
    v_mfma_f32_16x16x32_bf16 v[76:79], v[32:35], a[132:135], 0
    v_mfma_f32_16x16x32_bf16 v[92:95], v[32:35], a[148:151], 0
    v_mfma_f32_16x16x32_bf16 v[120:123], v[32:35], v[36:39], 0
    v_mfma_f32_16x16x32_bf16 v[80:83], v[32:35], a[136:139], 0
    v_mfma_f32_16x16x32_bf16 v[96:99], v[32:35], a[152:155], 0
    v_mfma_f32_16x16x32_bf16 v[84:87], v[32:35], a[140:143], 0
    v_mfma_f32_16x16x32_bf16 v[100:103], v[32:35], a[156:159], 0
    s_nop 0
    s_waitcnt lgkmcnt(0)
    v_mfma_f32_16x16x32_bf16 v[72:75], v[28:31], a[160:163], v[72:75]
    v_mov_b32_dpp v36, v28 quad_perm:[0,1,2,3] row_mask:0xf bank_mask:0x3
    v_mov_b32_dpp v37, v29 quad_perm:[0,1,2,3] row_mask:0xf bank_mask:0x3
    v_mfma_f32_16x16x32_bf16 v[88:91], v[28:31], a[176:179], v[88:91]
    v_mov_b32_dpp v38, v30 quad_perm:[0,1,2,3] row_mask:0xf bank_mask:0x3
    v_mov_b32_dpp v39, v31 quad_perm:[0,1,2,3] row_mask:0xf bank_mask:0x3
    v_mfma_f32_16x16x32_bf16 v[76:79], v[28:31], a[164:167], v[76:79]
    v_mfma_f32_16x16x32_bf16 v[92:95], v[28:31], a[180:183], v[92:95]
    v_mfma_f32_16x16x32_bf16 v[120:123], v[28:31], v[36:39], v[120:123]
    v_mfma_f32_16x16x32_bf16 v[80:83], v[28:31], a[168:171], v[80:83]
    v_mfma_f32_16x16x32_bf16 v[96:99], v[28:31], a[184:187], v[96:99]
    v_mfma_f32_16x16x32_bf16 v[84:87], v[28:31], a[172:175], v[84:87]
    v_mfma_f32_16x16x32_bf16 v[100:103], v[28:31], a[188:191], v[100:103]
    s_mov_b64 exec, 0x101
    s_nop 2
    buffer_store_dword v120, v5, s[16:19], s64 offen sc1
    s_mov_b32 exec_lo, -1
    v_mov_b32_dpp v72, v88 quad_perm:[0,1,2,3] row_mask:0x2 bank_mask:0xf
    v_mov_b32_dpp v73, v76 quad_perm:[0,1,2,3] row_mask:0x1 bank_mask:0xf
    v_mov_b32_dpp v73, v92 quad_perm:[0,1,2,3] row_mask:0x2 bank_mask:0xf
    v_mov_b32_dpp v74, v80 quad_perm:[0,1,2,3] row_mask:0x1 bank_mask:0xf
    v_mov_b32_dpp v74, v96 quad_perm:[0,1,2,3] row_mask:0x2 bank_mask:0xf
    v_mov_b32_dpp v75, v84 quad_perm:[0,1,2,3] row_mask:0x1 bank_mask:0xf
    v_mov_b32_dpp v75, v100 quad_perm:[0,1,2,3] row_mask:0x2 bank_mask:0xf
    buffer_store_dwordx4 v[72:75], v2, s[16:19], s64 offen sc1
    s_mov_b64 exec, -1
    s_mov_b32 exec_lo, 0x00ff00ff
    s_mov_b32 exec_hi, 0x00ff00ff
    v_lshlrev_b32 v112, 16, v109
    v_cvt_f64_f32_e64 v[40:41], v112
    v_add_f64 v[40:41], v[40:41], -s[0:1]
    s_mov_b64 exec, -1
LS17_214:
    buffer_load_dwordx4 v[76:79], v4, s[16:19], s64 offen sc1
    buffer_load_dwordx4 v[72:75], v3, s[16:19], s64 offen sc1
    v_accvgpr_read_b32 v84, a244
    v_accvgpr_read_b32 v85, a245
    v_accvgpr_read_b32 v86, a246
    v_accvgpr_read_b32 v87, a247
    v_accvgpr_read_b32 v88, a248
    v_accvgpr_read_b32 v89, a249
    v_accvgpr_read_b32 v90, a250
    v_accvgpr_read_b32 v91, a251
    v_add_f32_dpp v84, v88, v84 quad_perm:[0,1,2,3] row_mask:0xf bank_mask:0xc
    v_add_f32_dpp v85, v89, v85 quad_perm:[0,1,2,3] row_mask:0xf bank_mask:0xc
    v_add_f32_dpp v86, v90, v86 quad_perm:[0,1,2,3] row_mask:0xf bank_mask:0xc
    v_add_f32_dpp v87, v91, v87 quad_perm:[0,1,2,3] row_mask:0xf bank_mask:0xc
    v_permlane32_swap_b32 v84, v85
    s_nop 0
    v_permlane32_swap_b32 v86, v87
    v_add_f32 v84, v84, v85
    v_add_f32 v86, v86, v87
    s_nop 1
    v_permlane16_swap_b32 v84, v86
    v_add_f32 v24, v84, v86
    s_nop 1
    v_add_f32_dpp v24, v24, v24 row_ror:8 row_mask:0xf bank_mask:0xf
    s_branch Lp_215w
Lp_215:
    buffer_load_dwordx4 v[76:79], v4, s[16:19], s64 offen sc1
    buffer_load_dwordx4 v[72:75], v3, s[16:19], s64 offen sc1
    s_sub_u32 s69, s69, 1
    s_cbranch_scc1 Lgive_217
Lp_215w:
    s_waitcnt vmcnt(1)
    v_pk_add_f32 v[80:81], v[76:77], v[78:79]
    s_nop 0
    s_nop 0
    v_add_f32_dpp v6, v80, v81 quad_perm:[0,1,2,3] row_mask:0xf bank_mask:0x3
    s_waitcnt vmcnt(0)
    v_add_f32_dpp v72, v76, v72 quad_perm:[0,1,2,3] row_mask:0xf bank_mask:0xc
    v_add_f32_dpp v73, v77, v73 quad_perm:[0,1,2,3] row_mask:0xf bank_mask:0xc
    v_add_f32_dpp v105, v6, v6 row_ror:2 row_mask:0xf bank_mask:0xf
    v_cmp_u_f32 vcc, v72, v6
    v_add_f32_dpp v74, v78, v74 quad_perm:[0,1,2,3] row_mask:0xf bank_mask:0xc
    v_add_f32_dpp v75, v79, v75 quad_perm:[0,1,2,3] row_mask:0xf bank_mask:0xc
    s_cbranch_vccnz Lp_215
    v_add_f32_dpp v105, v105, v105 row_ror:4 row_mask:0xf bank_mask:0xf
    v_permlane32_swap_b32 v72, v73
    s_nop 0
    v_add_f32_dpp v105, v105, v105 row_ror:8 row_mask:0xf bank_mask:0xf
    v_permlane32_swap_b32 v74, v75
    v_mul_f32 v105, 0x3acccccd, v105
    v_add_f32 v72, v72, v73
    s_nop 0
    v_mov_b32_dpp v106, v105 quad_perm:[0,0,2,2] row_mask:0xf bank_mask:0xf
    v_add_f32 v74, v74, v75
    v_mov_b32_dpp v107, v105 quad_perm:[1,1,3,3] row_mask:0xf bank_mask:0xf
    s_nop 0
    v_permlane16_swap_b32 v72, v74
    v_fma_f32 v107, -v106, v106, v107
    v_add_f32 v104, v72, v74
    v_max_f32 v107, 0, v107
    s_nop 0
    v_add_f32_dpp v104, v104, v104 row_ror:8 row_mask:0xf bank_mask:0xf
    v_add_f32 v107, 0x3727c5ac, v107
    v_rsq_f32 v107, v107
    v_fma_f32 v104, -v106, v24, v104
    v_mul_f32 v104, v104, v107
    v_cvt_pk_bf16_f32 v107, v104, v104
    v_cmp_u_f32 vcc, v104, v105
    s_cbranch_vccnz Lp_215
Lok_216:
    ds_write_b16 v16, v107
    s_waitcnt lgkmcnt(0)
    s_barrier
LS18_218:
    s_mov_b64 exec, s[80:81]
    ds_read_b128 v[48:51], v17
    s_mov_b64 exec, s[82:83]
    ds_read_b128 v[52:55], v17
    s_mov_b64 exec, s[84:85]
    ds_read_b128 v[56:59], v17
    s_mov_b64 exec, s[86:87]
    ds_read_b128 v[60:63], v17
    s_mov_b64 exec, -1
    s_waitcnt lgkmcnt(3)
    v_mfma_f32_16x16x32_bf16 v[72:75], a[0:3], v[48:51], 0
    v_mfma_f32_16x16x32_bf16 v[76:79], a[32:35], v[48:51], 0
    s_nop 0
    s_waitcnt lgkmcnt(2)
    v_mfma_f32_16x16x32_bf16 v[72:75], a[8:11], v[52:55], v[72:75]
    v_mfma_f32_16x16x32_bf16 v[76:79], a[40:43], v[52:55], v[76:79]
    s_waitcnt lgkmcnt(1)
    v_mfma_f32_16x16x32_bf16 v[72:75], a[16:19], v[56:59], v[72:75]
    v_mfma_f32_16x16x32_bf16 v[76:79], a[48:51], v[56:59], v[76:79]
    s_waitcnt lgkmcnt(0)
    v_mfma_f32_16x16x32_bf16 v[72:75], a[24:27], v[60:63], v[72:75]
    v_mfma_f32_16x16x32_bf16 v[76:79], a[56:59], v[60:63], v[76:79]
    v_mfma_f32_16x16x32_bf16 v[80:83], a[64:67], v[48:51], 0
    v_mfma_f32_16x16x32_bf16 v[84:87], a[96:99], v[48:51], 0
    v_mfma_f32_16x16x32_bf16 v[80:83], a[72:75], v[52:55], v[80:83]
    v_mfma_f32_16x16x32_bf16 v[84:87], a[104:107], v[52:55], v[84:87]
    v_mfma_f32_16x16x32_bf16 v[80:83], a[80:83], v[56:59], v[80:83]
    v_mfma_f32_16x16x32_bf16 v[84:87], a[112:115], v[56:59], v[84:87]
    v_mfma_f32_16x16x32_bf16 v[80:83], a[88:91], v[60:63], v[80:83]
    v_add_f32_dpp v104, v73, v72 row_ror:12 row_mask:0xf bank_mask:0x1
    v_add_f32_dpp v104, v74, v104 row_ror:8 row_mask:0xf bank_mask:0x1
    v_mfma_f32_16x16x32_bf16 v[84:87], a[120:123], v[60:63], v[84:87]
    v_add_f32_dpp v104, v75, v104 row_ror:4 row_mask:0xf bank_mask:0x1
    v_add_f32_dpp v104, v76, v77 row_ror:4 row_mask:0xf bank_mask:0x2
    v_mfma_f32_16x16x32_bf16 v[88:91], a[4:7], v[48:51], 0
    v_add_f32_dpp v104, v78, v104 row_ror:12 row_mask:0xf bank_mask:0x2
    v_add_f32_dpp v104, v79, v104 row_ror:8 row_mask:0xf bank_mask:0x2
    v_mfma_f32_16x16x32_bf16 v[92:95], a[36:39], v[48:51], 0
    v_add_f32_dpp v104, v80, v82 row_ror:8 row_mask:0xf bank_mask:0x4
    v_add_f32_dpp v104, v81, v104 row_ror:4 row_mask:0xf bank_mask:0x4
    v_mfma_f32_16x16x32_bf16 v[88:91], a[12:15], v[52:55], v[88:91]
    v_add_f32_dpp v104, v83, v104 row_ror:12 row_mask:0xf bank_mask:0x4
    v_add_f32_dpp v104, v84, v87 row_ror:12 row_mask:0xf bank_mask:0x8
    v_mfma_f32_16x16x32_bf16 v[92:95], a[44:47], v[52:55], v[92:95]
    v_add_f32_dpp v104, v85, v104 row_ror:8 row_mask:0xf bank_mask:0x8
    v_add_f32_dpp v104, v86, v104 row_ror:4 row_mask:0xf bank_mask:0x8
    v_mfma_f32_16x16x32_bf16 v[88:91], a[20:23], v[56:59], v[88:91]
    v_mfma_f32_16x16x32_bf16 v[92:95], a[52:55], v[56:59], v[92:95]
    v_mfma_f32_16x16x32_bf16 v[88:91], a[28:31], v[60:63], v[88:91]
    v_mfma_f32_16x16x32_bf16 v[92:95], a[60:63], v[60:63], v[92:95]
    v_mfma_f32_16x16x32_bf16 v[96:99], a[68:71], v[48:51], 0
    v_mfma_f32_16x16x32_bf16 v[100:103], a[100:103], v[48:51], 0
    v_mfma_f32_16x16x32_bf16 v[96:99], a[76:79], v[52:55], v[96:99]
    v_mfma_f32_16x16x32_bf16 v[100:103], a[108:111], v[52:55], v[100:103]
    v_mfma_f32_16x16x32_bf16 v[96:99], a[84:87], v[56:59], v[96:99]
    v_mfma_f32_16x16x32_bf16 v[100:103], a[116:119], v[56:59], v[100:103]
    v_mfma_f32_16x16x32_bf16 v[96:99], a[92:95], v[60:63], v[96:99]
    v_add_f32_dpp v105, v89, v88 row_ror:12 row_mask:0xf bank_mask:0x1
    v_add_f32_dpp v105, v90, v105 row_ror:8 row_mask:0xf bank_mask:0x1
    v_mfma_f32_16x16x32_bf16 v[100:103], a[124:127], v[60:63], v[100:103]
    v_add_f32_dpp v105, v91, v105 row_ror:4 row_mask:0xf bank_mask:0x1
    v_add_f32_dpp v105, v92, v93 row_ror:4 row_mask:0xf bank_mask:0x2
    v_add_f32_dpp v105, v94, v105 row_ror:12 row_mask:0xf bank_mask:0x2
    v_add_f32_dpp v105, v95, v105 row_ror:8 row_mask:0xf bank_mask:0x2
    s_nop 0
    v_add_f32_dpp v105, v96, v98 row_ror:8 row_mask:0xf bank_mask:0x4
    v_add_f32_dpp v105, v97, v105 row_ror:4 row_mask:0xf bank_mask:0x4
    v_add_f32_dpp v105, v99, v105 row_ror:12 row_mask:0xf bank_mask:0x4
    v_add_f32_dpp v105, v100, v103 row_ror:12 row_mask:0xf bank_mask:0x8
    v_add_f32_dpp v105, v101, v105 row_ror:8 row_mask:0xf bank_mask:0x8
    v_add_f32_dpp v105, v102, v105 row_ror:4 row_mask:0xf bank_mask:0x8
    v_max_f32 v106, v104, v105
    s_nop 1
    v_max_f32_dpp v106, v106, v106 row_ror:1 row_mask:0xf bank_mask:0xf
    s_nop 1
    v_max_f32_dpp v106, v106, v106 row_ror:2 row_mask:0xf bank_mask:0xf
    s_nop 1
    v_max_f32_dpp v106, v106, v106 row_ror:4 row_mask:0xf bank_mask:0xf
    s_nop 1
    v_max_f32_dpp v106, v106, v106 row_ror:8 row_mask:0xf bank_mask:0xf
    s_nop 1
    v_max_f32_dpp v106, v106, v106 row_bcast:15 row_mask:0xa bank_mask:0xf
    s_nop 1
    v_max_f32_dpp v106, v106, v106 row_bcast:31 row_mask:0xc bank_mask:0xf
    v_mul_f32 v106, v106, v27
    s_nop 0
    v_readlane_b32 s72, v106, 63
    s_nop 1
    v_fma_f32 v104, v104, v27, -s72
    v_fma_f32 v105, v105, v27, -s72
    v_exp_f32 v104, v104
    v_exp_f32 v105, v105
    s_nop 0
    v_cvt_pk_bf16_f32 v108, v104, v105
LS19_219:
    s_nop 1
    v_mov_b32_dpp v64, v108 row_newbcast:0 row_mask:0xf bank_mask:0x1
    v_mov_b32_dpp v65, v108 row_newbcast:0 row_mask:0xf bank_mask:0x2
    v_mov_b32_dpp v66, v108 row_newbcast:0 row_mask:0xf bank_mask:0x4
    v_mov_b32_dpp v67, v108 row_newbcast:0 row_mask:0xf bank_mask:0x8
    s_nop 1
    v_mfma_f32_16x16x32_bf16 v[72:75], v[64:67], v[126:129], 0
    v_mov_b32_dpp v68, v108 row_newbcast:1 row_mask:0xf bank_mask:0x1
    v_mov_b32_dpp v69, v108 row_newbcast:1 row_mask:0xf bank_mask:0x2
    v_mov_b32_dpp v70, v108 row_newbcast:1 row_mask:0xf bank_mask:0x4
    v_mfma_f32_16x16x32_bf16 v[76:79], v[64:67], v[130:133], 0
    v_mov_b32_dpp v71, v108 row_newbcast:1 row_mask:0xf bank_mask:0x8
    v_lshlrev_b32_e64 v107, 16, v108
    v_and_b32 v104, 0xffff0000, v108
    v_mfma_f32_16x16x32_bf16 v[72:75], v[68:71], v[134:137], v[72:75]
    v_mov_b32_dpp v64, v108 row_newbcast:2 row_mask:0xf bank_mask:0x1
    v_mov_b32_dpp v65, v108 row_newbcast:2 row_mask:0xf bank_mask:0x2
    v_mov_b32_dpp v66, v108 row_newbcast:2 row_mask:0xf bank_mask:0x4
    v_mfma_f32_16x16x32_bf16 v[76:79], v[68:71], v[138:141], v[76:79]
    v_mov_b32_dpp v67, v108 row_newbcast:2 row_mask:0xf bank_mask:0x8
    v_add_f32 v107, v107, v104
    s_nop 1
    v_add_f32_dpp v107, v107, v107 row_ror:1 row_mask:0xf bank_mask:0xf
    v_mfma_f32_16x16x32_bf16 v[72:75], v[64:67], v[142:145], v[72:75]
    v_mov_b32_dpp v68, v108 row_newbcast:3 row_mask:0xf bank_mask:0x1
    v_mov_b32_dpp v69, v108 row_newbcast:3 row_mask:0xf bank_mask:0x2
    v_mov_b32_dpp v70, v108 row_newbcast:3 row_mask:0xf bank_mask:0x4
    v_mfma_f32_16x16x32_bf16 v[76:79], v[64:67], v[146:149], v[76:79]
    v_mov_b32_dpp v71, v108 row_newbcast:3 row_mask:0xf bank_mask:0x8
    v_add_f32_dpp v107, v107, v107 row_ror:2 row_mask:0xf bank_mask:0xf
    s_nop 0
    v_mfma_f32_16x16x32_bf16 v[72:75], v[68:71], v[150:153], v[72:75]
    v_mov_b32_dpp v64, v108 row_newbcast:4 row_mask:0xf bank_mask:0x1
    v_mov_b32_dpp v65, v108 row_newbcast:4 row_mask:0xf bank_mask:0x2
    v_mov_b32_dpp v66, v108 row_newbcast:4 row_mask:0xf bank_mask:0x4
    v_mfma_f32_16x16x32_bf16 v[76:79], v[68:71], v[154:157], v[76:79]
    v_mov_b32_dpp v67, v108 row_newbcast:4 row_mask:0xf bank_mask:0x8
    v_add_f32_dpp v107, v107, v107 row_ror:4 row_mask:0xf bank_mask:0xf
    s_nop 0
    v_mfma_f32_16x16x32_bf16 v[72:75], v[64:67], v[158:161], v[72:75]
    v_mov_b32_dpp v68, v108 row_newbcast:5 row_mask:0xf bank_mask:0x1
    v_mov_b32_dpp v69, v108 row_newbcast:5 row_mask:0xf bank_mask:0x2
    v_mov_b32_dpp v70, v108 row_newbcast:5 row_mask:0xf bank_mask:0x4
    v_mfma_f32_16x16x32_bf16 v[76:79], v[64:67], v[162:165], v[76:79]
    v_mov_b32_dpp v71, v108 row_newbcast:5 row_mask:0xf bank_mask:0x8
    v_add_f32_dpp v107, v107, v107 row_ror:8 row_mask:0xf bank_mask:0xf
    s_nop 0
    v_mfma_f32_16x16x32_bf16 v[72:75], v[68:71], v[166:169], v[72:75]
    v_mov_b32_dpp v64, v108 row_newbcast:6 row_mask:0xf bank_mask:0x1
    v_mov_b32_dpp v65, v108 row_newbcast:6 row_mask:0xf bank_mask:0x2
    v_mov_b32_dpp v66, v108 row_newbcast:6 row_mask:0xf bank_mask:0x4
    v_mfma_f32_16x16x32_bf16 v[76:79], v[68:71], v[170:173], v[76:79]
    v_mov_b32_dpp v67, v108 row_newbcast:6 row_mask:0xf bank_mask:0x8
    v_add_f32_dpp v107, v107, v107 row_bcast:15 row_mask:0xa bank_mask:0xf
    s_nop 0
    v_mfma_f32_16x16x32_bf16 v[72:75], v[64:67], v[174:177], v[72:75]
    v_mov_b32_dpp v68, v108 row_newbcast:7 row_mask:0xf bank_mask:0x1
    v_mov_b32_dpp v69, v108 row_newbcast:7 row_mask:0xf bank_mask:0x2
    v_mov_b32_dpp v70, v108 row_newbcast:7 row_mask:0xf bank_mask:0x4
    v_mfma_f32_16x16x32_bf16 v[76:79], v[64:67], v[178:181], v[76:79]
    v_mov_b32_dpp v71, v108 row_newbcast:7 row_mask:0xf bank_mask:0x8
    v_add_f32_dpp v107, v107, v107 row_bcast:31 row_mask:0xc bank_mask:0xf
    s_nop 0
    v_mfma_f32_16x16x32_bf16 v[72:75], v[68:71], v[182:185], v[72:75]
    v_mov_b32_dpp v64, v108 row_newbcast:8 row_mask:0xf bank_mask:0x1
    v_mov_b32_dpp v65, v108 row_newbcast:8 row_mask:0xf bank_mask:0x2
    v_mov_b32_dpp v66, v108 row_newbcast:8 row_mask:0xf bank_mask:0x4
    v_mfma_f32_16x16x32_bf16 v[76:79], v[68:71], v[186:189], v[76:79]
    v_mov_b32_dpp v67, v108 row_newbcast:8 row_mask:0xf bank_mask:0x8
    ds_write_b64 v18, v[106:107]
    s_nop 0
    v_mfma_f32_16x16x32_bf16 v[72:75], v[64:67], v[190:193], v[72:75]
    v_mov_b32_dpp v68, v108 row_newbcast:9 row_mask:0xf bank_mask:0x1
    v_mov_b32_dpp v69, v108 row_newbcast:9 row_mask:0xf bank_mask:0x2
    v_mov_b32_dpp v70, v108 row_newbcast:9 row_mask:0xf bank_mask:0x4
    v_mfma_f32_16x16x32_bf16 v[76:79], v[64:67], v[194:197], v[76:79]
    v_mov_b32_dpp v71, v108 row_newbcast:9 row_mask:0xf bank_mask:0x8
    s_waitcnt lgkmcnt(0)
    s_barrier
    ds_read_b64 v[110:111], v19
    v_mfma_f32_16x16x32_bf16 v[72:75], v[68:71], v[198:201], v[72:75]
    v_mov_b32_dpp v64, v108 row_newbcast:10 row_mask:0xf bank_mask:0x1
    v_mov_b32_dpp v65, v108 row_newbcast:10 row_mask:0xf bank_mask:0x2
    v_mov_b32_dpp v66, v108 row_newbcast:10 row_mask:0xf bank_mask:0x4
    v_mfma_f32_16x16x32_bf16 v[76:79], v[68:71], v[202:205], v[76:79]
    v_mov_b32_dpp v67, v108 row_newbcast:10 row_mask:0xf bank_mask:0x8
    s_nop 0
    s_nop 0
    v_mfma_f32_16x16x32_bf16 v[72:75], v[64:67], v[206:209], v[72:75]
    v_mov_b32_dpp v68, v108 row_newbcast:11 row_mask:0xf bank_mask:0x1
    v_mov_b32_dpp v69, v108 row_newbcast:11 row_mask:0xf bank_mask:0x2
    v_mov_b32_dpp v70, v108 row_newbcast:11 row_mask:0xf bank_mask:0x4
    v_mfma_f32_16x16x32_bf16 v[76:79], v[64:67], v[210:213], v[76:79]
    v_mov_b32_dpp v71, v108 row_newbcast:11 row_mask:0xf bank_mask:0x8
    s_waitcnt lgkmcnt(0)
    s_nop 0
    v_mfma_f32_16x16x32_bf16 v[72:75], v[68:71], v[214:217], v[72:75]
    v_mov_b32_dpp v64, v108 row_newbcast:12 row_mask:0xf bank_mask:0x1
    v_mov_b32_dpp v65, v108 row_newbcast:12 row_mask:0xf bank_mask:0x2
    v_mov_b32_dpp v66, v108 row_newbcast:12 row_mask:0xf bank_mask:0x4
    v_mfma_f32_16x16x32_bf16 v[76:79], v[68:71], v[218:221], v[76:79]
    v_mov_b32_dpp v67, v108 row_newbcast:12 row_mask:0xf bank_mask:0x8
    v_max_f32_dpp v112, v110, v110 quad_perm:[1,0,3,2] row_mask:0xf bank_mask:0xf
    s_nop 0
    v_mfma_f32_16x16x32_bf16 v[72:75], v[64:67], v[222:225], v[72:75]
    v_mov_b32_dpp v68, v108 row_newbcast:13 row_mask:0xf bank_mask:0x1
    v_mov_b32_dpp v69, v108 row_newbcast:13 row_mask:0xf bank_mask:0x2
    v_mov_b32_dpp v70, v108 row_newbcast:13 row_mask:0xf bank_mask:0x4
    v_mfma_f32_16x16x32_bf16 v[76:79], v[64:67], v[226:229], v[76:79]
    v_mov_b32_dpp v71, v108 row_newbcast:13 row_mask:0xf bank_mask:0x8
    v_max_f32_dpp v112, v112, v112 quad_perm:[2,3,0,1] row_mask:0xf bank_mask:0xf
    v_sub_f32 v109, v110, v112
    v_mfma_f32_16x16x32_bf16 v[72:75], v[68:71], v[230:233], v[72:75]
    v_mov_b32_dpp v64, v108 row_newbcast:14 row_mask:0xf bank_mask:0x1
    v_mov_b32_dpp v65, v108 row_newbcast:14 row_mask:0xf bank_mask:0x2
    v_mov_b32_dpp v66, v108 row_newbcast:14 row_mask:0xf bank_mask:0x4
    v_mfma_f32_16x16x32_bf16 v[76:79], v[68:71], v[234:237], v[76:79]
    v_mov_b32_dpp v67, v108 row_newbcast:14 row_mask:0xf bank_mask:0x8
    v_exp_f32 v109, v109
    s_nop 0
    v_mfma_f32_16x16x32_bf16 v[72:75], v[64:67], v[238:241], v[72:75]
    v_mov_b32_dpp v68, v108 row_newbcast:15 row_mask:0xf bank_mask:0x1
    v_mov_b32_dpp v69, v108 row_newbcast:15 row_mask:0xf bank_mask:0x2
    v_mov_b32_dpp v70, v108 row_newbcast:15 row_mask:0xf bank_mask:0x4
    v_mfma_f32_16x16x32_bf16 v[76:79], v[64:67], v[242:245], v[76:79]
    v_mov_b32_dpp v71, v108 row_newbcast:15 row_mask:0xf bank_mask:0x8
    v_mul_f32 v113, v109, v111
    s_nop 0
    v_mfma_f32_16x16x32_bf16 v[72:75], v[68:71], v[246:249], v[72:75]
    v_mfma_f32_16x16x32_bf16 v[76:79], v[68:71], v[250:253], v[76:79]
    v_add_f32_dpp v113, v113, v113 quad_perm:[1,0,3,2] row_mask:0xf bank_mask:0xf
    s_nop 0
    s_nop 0
    v_add_f32_dpp v113, v113, v113 quad_perm:[2,3,0,1] row_mask:0xf bank_mask:0xf
    s_cmp_lg_u32 s7, 0
    s_cbranch_scc1 Lnos_220
    s_mov_b64 exec, 0x10001
    buffer_store_dwordx2 v[112:113], v1, s[16:19], s65 offen sc1
    s_mov_b64 exec, -1
Lnos_220:
LS20_221:
    s_nop 0
    v_mul_f32_dpp v104, v109, v72 quad_perm:[0,0,0,0] row_mask:0xf bank_mask:0xf
    v_mul_f32_dpp v105, v109, v76 quad_perm:[0,0,0,0] row_mask:0xf bank_mask:0xf
    ds_write2_b32 v20, v104, v105 offset0:0 offset1:64
    s_cmp_lg_u32 s7, 0
    s_waitcnt lgkmcnt(0)
    s_barrier
    s_cbranch_scc1 Lsk_222
    ds_read2_b64 v[72:75], v21 offset0:0 offset1:64
    ds_read2_b64 v[76:79], v21 offset0:128 offset1:192
    s_waitcnt lgkmcnt(1)
    v_pk_add_f32 v[72:73], v[72:73], v[74:75]
    s_waitcnt lgkmcnt(0)
    v_pk_add_f32 v[76:77], v[76:77], v[78:79]
    v_pk_add_f32 v[72:73], v[72:73], v[76:77]
    v_cvt_pk_bf16_f32 v72, v72, v73
    buffer_store_dword v72, v8, s[16:19], s64 offen sc1
Lsk_222:
LS21_223:
    v_and_b32 v113, 0x30, v0
    s_bitcmp0_b32 s7, 0
    s_cbranch_scc1 Lb_224
    s_nop 15
    s_nop 15
    s_nop 15
    s_nop 15
    s_nop 15
    s_nop 15
    s_nop 15
    s_nop 15
    s_nop 15
    s_nop 15
    s_nop 15
    s_nop 15
    s_nop 15
    s_nop 15
    s_nop 15
    s_nop 15
    s_nop 15
    s_nop 15
    s_nop 15
    v_mov_b32 v42, 0
    v_mov_b32 v43, 0
    buffer_atomic_or_x2 v[42:43], v13, s[16:19], s66 offen offset:128 sc0 sc1
    v_and_b32 v112, 7, v0
    v_lshl_add_u32 v112, v112, 1, v113
    s_and_b32 s67, s74, 1
    s_lshl_b32 s67, s67, 6
    v_add_u32 v112, s67, v112
    s_nop 15
    s_nop 15
    s_nop 15
    v_mov_b32 v44, 0
    v_mov_b32 v45, 0
    buffer_atomic_or_x2 v[44:45], v13, s[16:19], s66 offen offset:128 sc0 sc1
    s_nop 15
    s_nop 15
    s_nop 15
Lp_225:
    v_mov_b32 v46, 0
    v_mov_b32 v47, 0
    buffer_atomic_or_x2 v[46:47], v13, s[16:19], s66 offen offset:128 sc0 sc1
    s_waitcnt vmcnt(2)
    v_cmp_gt_u32 vcc, 0x41000000, v43
    v_add_f64 v[110:111], v[42:43], v[40:41]
    s_cbranch_vccz Lok_226
    v_mov_b32 v42, 0
    v_mov_b32_e64 v43, 0
    buffer_atomic_or_x2 v[42:43], v13, s[16:19], s66 offen offset:128 sc0 sc1
    s_waitcnt vmcnt(2)
    v_cmp_gt_u32 vcc, 0x41000000, v45
    v_add_f64 v[110:111], v[44:45], v[40:41]
    s_cbranch_vccz Lok_226
    v_mov_b32 v44, 0
    v_mov_b32 v45, 0
    buffer_atomic_or_x2 v[44:45], v13, s[16:19], s66 offen offset:128 sc0 sc1
    s_waitcnt vmcnt(2)
    v_cmp_gt_u32 vcc, 0x41000000, v47
    v_add_f64 v[110:111], v[46:47], v[40:41]
    s_cbranch_vccz Lok_226
    s_sub_u32 s69, s69, 1
    s_cbranch_scc0 Lp_225
    s_mov_b32 s69, 0
Lok_226:
    v_cvt_f32_f64 v109, v[110:111]
    s_nop 1
    v_add_f32_dpp v109, v109, v109 row_ror:8 row_mask:0xf bank_mask:0xf
    v_cvt_pk_bf16_f32 v109, v109, v109
    ds_write_b16 v112, v109 offset:10240
    s_waitcnt lgkmcnt(0)
Lb_224:
    s_barrier
    ds_read_b128 v[32:35], v113 offset:10240
    ds_read_b128 v[28:31], v113 offset:10304
    s_nop 0
    s_waitcnt lgkmcnt(1)
LS23_227:
    v_mfma_f32_16x16x32_bf16 v[72:75], v[32:35], a[192:195], 0
    v_mov_b32_dpp v36, v32 quad_perm:[0,1,2,3] row_mask:0xf bank_mask:0x3
    v_mov_b32_dpp v37, v33 quad_perm:[0,1,2,3] row_mask:0xf bank_mask:0x3
    v_mfma_f32_16x16x32_bf16 v[76:79], v[32:35], a[196:199], 0
    v_mov_b32_dpp v38, v34 quad_perm:[0,1,2,3] row_mask:0xf bank_mask:0x3
    v_mov_b32_dpp v39, v35 quad_perm:[0,1,2,3] row_mask:0xf bank_mask:0x3
    v_mfma_f32_16x16x32_bf16 v[80:83], v[32:35], a[200:203], 0
    v_mfma_f32_16x16x32_bf16 v[84:87], v[32:35], a[204:207], 0
    v_mfma_f32_16x16x32_bf16 v[120:123], v[32:35], v[36:39], 0
    s_nop 0
    s_waitcnt lgkmcnt(0)
    v_mfma_f32_16x16x32_bf16 v[72:75], v[28:31], a[208:211], v[72:75]
    v_mov_b32_dpp v36, v28 quad_perm:[0,1,2,3] row_mask:0xf bank_mask:0x3
    v_mov_b32_dpp v37, v29 quad_perm:[0,1,2,3] row_mask:0xf bank_mask:0x3
    v_mfma_f32_16x16x32_bf16 v[76:79], v[28:31], a[212:215], v[76:79]
    v_mov_b32_dpp v38, v30 quad_perm:[0,1,2,3] row_mask:0xf bank_mask:0x3
    v_mov_b32_dpp v39, v31 quad_perm:[0,1,2,3] row_mask:0xf bank_mask:0x3
    v_mfma_f32_16x16x32_bf16 v[80:83], v[28:31], a[216:219], v[80:83]
    v_mfma_f32_16x16x32_bf16 v[84:87], v[28:31], a[220:223], v[84:87]
    v_mfma_f32_16x16x32_bf16 v[120:123], v[28:31], v[36:39], v[120:123]
    s_mov_b64 exec, 0xffff
    s_nop 1
    v_mov_b32 v73, v76
    s_nop 1
    v_mov_b32 v74, v80
    v_mov_b32_e64 v75, v84
    buffer_store_dwordx4 v[72:75], v14, s[16:19], s64 offen sc1
    s_mov_b64 exec, 0x101
    buffer_store_dword v120, v5, s[16:19], s64 offen offset:256 sc1
    s_mov_b64 exec, -1
    s_mov_b32 exec_lo, 0x00ff00ff
    s_mov_b32 exec_hi, 0x00ff00ff
    v_lshlrev_b32 v112, 16, v109
    v_accvgpr_read_b32 v113, a226
    v_lshlrev_b32 v113, 16, v113
    v_add_f32 v112, v112, v113
    v_cvt_f64_f32 v[40:41], v112
    v_add_f64 v[40:41], v[40:41], -s[0:1]
    s_mov_b64 exec, -1
LS24_228:
    s_mov_b32 s67, s3
    s_cmp_lg_u32 s67, 0
    s_cbranch_scc1 Lfin_229
    v_and_b32 v113, 0x30, v0
    s_bitcmp0_b32 s7, 0
    s_cbranch_scc1 Lb_230
    s_waitcnt vmcnt(0)
    v_mov_b32 v42, 0
    v_mov_b32 v43, 0
    buffer_atomic_or_x2 v[42:43], v13, s[16:19], s66 offen offset:192 sc0 sc1
    v_and_b32 v112, 7, v0
    v_lshl_add_u32 v112, v112, 1, v113
    s_lshl_b32 s67, s74, 6
    s_nop 15
    s_nop 15
    v_mov_b32 v44, 0
    v_mov_b32 v45, 0
    buffer_atomic_or_x2 v[44:45], v13, s[16:19], s66 offen offset:192 sc0 sc1
    s_nop 15
    s_nop 15
Lp_231:
    v_mov_b32 v46, 0
    v_mov_b32 v47, 0
    buffer_atomic_or_x2 v[46:47], v13, s[16:19], s66 offen offset:192 sc0 sc1
    s_waitcnt vmcnt(2)
    v_cmp_gt_u32 vcc, 0x41000000, v43
    v_add_f64 v[110:111], v[42:43], v[40:41]
    s_cbranch_vccz Lok_232
    v_mov_b32 v42, 0
    v_mov_b32 v43, 0
    buffer_atomic_or_x2 v[42:43], v13, s[16:19], s66 offen offset:192 sc0 sc1
    s_waitcnt vmcnt(2)
    v_cmp_gt_u32 vcc, 0x41000000, v45
    v_add_f64 v[110:111], v[44:45], v[40:41]
    s_cbranch_vccz Lok_232
    v_mov_b32 v44, 0
    v_mov_b32 v45, 0
    buffer_atomic_or_x2 v[44:45], v13, s[16:19], s66 offen offset:192 sc0 sc1
    s_waitcnt vmcnt(2)
    v_cmp_gt_u32 vcc, 0x41000000, v47
    v_add_f64 v[110:111], v[46:47], v[40:41]
    s_cbranch_vccz Lok_232
    s_sub_u32 s69, s69, 1
    s_cbranch_scc0 Lp_231
    s_mov_b32 s69, 0
Lok_232:
    v_cvt_f32_f64 v109, v[110:111]
    s_nop 1
    v_add_f32_dpp v109, v109, v109 row_ror:8 row_mask:0xf bank_mask:0xf
    v_cvt_pk_bf16_f32 v109, v109, v109
    s_mov_b32 exec_lo, 0x00ff00ff
    s_mov_b32 exec_hi, 0x00ff00ff
    buffer_store_short v109, v112, s[48:51], s67 offen
    s_mov_b64 exec, -1
Lb_230:
Lfin_229:
    s_endpgm
Lretry_196:
    s_cmp_eq_u32 s69, 0
    s_cbranch_scc1 Lfok_194
    s_sub_u32 s69, s69, 1
    s_branch Lfp_193
Lfp_193:
    buffer_load_dword v114, v119, s[52:55], 0 offen sc1
    s_waitcnt vmcnt(0)
    s_branch Lfc_195
Lgive_198:
    s_mov_b32 s69, 0
    s_waitcnt vmcnt(0)
    s_branch Lok_199
Lbw_212:
    s_waitcnt vmcnt(0)
    s_branch Lb_208
Lgive_217:
    s_mov_b32 s69, 0
    s_nop 0
    s_waitcnt vmcnt(0)
    s_branch Lok_216
L_loopB_slow:
LS10_233:
    v_mul_f32_dpp v104, v109, v72 quad_perm:[0,0,0,0] row_mask:0xf bank_mask:0xf
    s_nop 0
    v_mul_f32_dpp v105, v109, v76 quad_perm:[0,0,0,0] row_mask:0xf bank_mask:0xf
    ds_write2_b32 v20, v104, v105 offset0:0 offset1:64
    s_cmp_lg_u32 s7, 0
    s_waitcnt lgkmcnt(0)
    s_barrier
    s_cbranch_scc1 Lsk_234
    ds_read2_b64 v[72:75], v21 offset0:0 offset1:64
    ds_read2_b64 v[76:79], v21 offset0:128 offset1:192
    s_waitcnt lgkmcnt(1)
    v_pk_add_f32 v[72:73], v[72:73], v[74:75]
    s_waitcnt lgkmcnt(0)
    v_pk_add_f32 v[76:77], v[76:77], v[78:79]
    v_pk_add_f32 v[72:73], v[72:73], v[76:77]
    v_cvt_pk_bf16_f32 v72, v72, v73
    buffer_store_dword v72, v8, s[16:19], s64 offen sc1
Lsk_234:
LS11_235:
    s_waitcnt vmcnt(6)
Lfc_238:
    v_and_b32 v120, 0x80808080, v114
    v_cmp_ne_u32 vcc, 0x80808080, v120
    s_cbranch_vccnz Lretry_239
Lfok_237:
Lp_240:
    buffer_load_dwordx2 v[108:109], v11, s[16:19], s64 offen sc1
    buffer_load_dwordx4 v[104:107], v9, s[16:19], s64 offen sc1
    s_sub_u32 s69, s69, 1
    s_cbranch_scc1 Lgive_242
    s_waitcnt vmcnt(0)
    v_max3_u32 v113, v104, v105, v106
    v_max3_u32 v113, v113, v107, v108
    v_mfma_f32_16x16x32_bf16 v[72:75], v[104:107], a[160:163], 0
    v_max_u32 v113, v113, v109
    v_cmp_eq_u32 vcc, -1, v113
    v_max_f32_dpp v110, v108, v108 quad_perm:[1,0,3,2] row_mask:0xf bank_mask:0xf
    s_cbranch_vccnz Lp_240
Lok_241:
    v_mfma_f32_16x16x32_bf16 v[76:79], v[104:107], a[164:167], 0
    v_max_f32_dpp v110, v110, v110 quad_perm:[2,3,0,1] row_mask:0xf bank_mask:0xf
    v_mfma_f32_16x16x32_bf16 v[80:83], v[104:107], a[168:171], 0
    s_nop 0
    v_max_f32_dpp v110, v110, v110 row_half_mirror row_mask:0xf bank_mask:0xf
    v_mfma_f32_16x16x32_bf16 v[84:87], v[104:107], a[172:175], 0
    v_sub_f32 v111, v108, v110
    v_exp_f32 v111, v111
    v_mfma_f32_16x16x32_bf16 v[88:91], v[104:107], a[176:179], 0
    v_mul_f32 v112, v111, v109
    v_mfma_f32_16x16x32_bf16 v[92:95], v[104:107], a[180:183], 0
    s_nop 0
    v_add_f32_dpp v112, v112, v112 quad_perm:[1,0,3,2] row_mask:0xf bank_mask:0xf
    v_mfma_f32_16x16x32_bf16 v[96:99], v[104:107], a[184:187], 0
    s_nop 0
    v_add_f32_dpp v112, v112, v112 quad_perm:[2,3,0,1] row_mask:0xf bank_mask:0xf
    v_mfma_f32_16x16x32_bf16 v[100:103], v[104:107], a[188:191], 0
    s_nop 0
    v_add_f32_dpp v112, v112, v112 row_half_mirror row_mask:0xf bank_mask:0xf
    v_rcp_f32 v112, v112
    s_nop 0
    v_mul_f32 v111, v111, v112
    s_nop 0
    s_nop 0
    v_mul_f32_dpp v116, v111, v72 row_newbcast:0 row_mask:0xf bank_mask:0xf
    v_mul_f32_dpp v117, v111, v76 row_newbcast:0 row_mask:0xf bank_mask:0xf
    v_mul_f32_dpp v118, v111, v80 row_newbcast:0 row_mask:0xf bank_mask:0xf
    v_mul_f32_dpp v119, v111, v84 row_newbcast:0 row_mask:0xf bank_mask:0xf
    v_mul_f32_dpp v120, v111, v88 row_newbcast:0 row_mask:0xf bank_mask:0xf
    v_mul_f32_dpp v121, v111, v92 row_newbcast:0 row_mask:0xf bank_mask:0xf
    v_mul_f32_dpp v122, v111, v96 row_newbcast:0 row_mask:0xf bank_mask:0xf
    v_mul_f32_dpp v123, v111, v100 row_newbcast:0 row_mask:0xf bank_mask:0xf
    v_fmac_f32_dpp v116, v111, v73 row_newbcast:1 row_mask:0xf bank_mask:0xf
    v_fmac_f32_dpp v117, v111, v77 row_newbcast:1 row_mask:0xf bank_mask:0xf
    v_fmac_f32_dpp v118, v111, v81 row_newbcast:1 row_mask:0xf bank_mask:0xf
    v_fmac_f32_dpp v119, v111, v85 row_newbcast:1 row_mask:0xf bank_mask:0xf
    v_fmac_f32_dpp v120, v111, v89 row_newbcast:1 row_mask:0xf bank_mask:0xf
    v_fmac_f32_dpp v121, v111, v93 row_newbcast:1 row_mask:0xf bank_mask:0xf
    v_fmac_f32_dpp v122, v111, v97 row_newbcast:1 row_mask:0xf bank_mask:0xf
    v_fmac_f32_dpp v123, v111, v101 row_newbcast:1 row_mask:0xf bank_mask:0xf
    v_fmac_f32_dpp v116, v111, v74 row_newbcast:2 row_mask:0xf bank_mask:0xf
    v_fmac_f32_dpp v117, v111, v78 row_newbcast:2 row_mask:0xf bank_mask:0xf
    v_fmac_f32_dpp v118, v111, v82 row_newbcast:2 row_mask:0xf bank_mask:0xf
    v_fmac_f32_dpp v119, v111, v86 row_newbcast:2 row_mask:0xf bank_mask:0xf
    v_fmac_f32_dpp v120, v111, v90 row_newbcast:2 row_mask:0xf bank_mask:0xf
    v_fmac_f32_dpp v121, v111, v94 row_newbcast:2 row_mask:0xf bank_mask:0xf
    v_fmac_f32_dpp v122, v111, v98 row_newbcast:2 row_mask:0xf bank_mask:0xf
    v_fmac_f32_dpp v123, v111, v102 row_newbcast:2 row_mask:0xf bank_mask:0xf
    v_fmac_f32_dpp v116, v111, v75 row_newbcast:3 row_mask:0xf bank_mask:0xf
    v_fmac_f32_dpp v117, v111, v79 row_newbcast:3 row_mask:0xf bank_mask:0xf
    v_fmac_f32_dpp v118, v111, v83 row_newbcast:3 row_mask:0xf bank_mask:0xf
    v_fmac_f32_dpp v119, v111, v87 row_newbcast:3 row_mask:0xf bank_mask:0xf
    v_fmac_f32_dpp v120, v111, v91 row_newbcast:3 row_mask:0xf bank_mask:0xf
    v_fmac_f32_dpp v121, v111, v95 row_newbcast:3 row_mask:0xf bank_mask:0xf
    v_fmac_f32_dpp v122, v111, v99 row_newbcast:3 row_mask:0xf bank_mask:0xf
    v_fmac_f32_dpp v123, v111, v103 row_newbcast:3 row_mask:0xf bank_mask:0xf
    v_permlane16_swap_b32 v116, v120
    v_permlane16_swap_b32 v117, v121
    v_permlane16_swap_b32 v118, v122
    v_permlane16_swap_b32 v119, v123
    v_pk_add_f32 v[116:117], v[116:117], v[120:121]
    v_pk_add_f32 v[118:119], v[118:119], v[122:123]
    ds_write_b128 v22, v[116:119] offset:0
    s_cmp_lg_u32 s7, 0
    s_waitcnt lgkmcnt(0)
    s_barrier
    s_cbranch_scc1 Lsk_243
    ds_read2st64_b32 v[72:73], v23 offset0:0 offset1:1
    ds_read2st64_b32 v[74:75], v23 offset0:2 offset1:3
    ds_read2st64_b32 v[76:77], v23 offset0:4 offset1:5
    ds_read2st64_b32 v[78:79], v23 offset0:6 offset1:7
    s_waitcnt lgkmcnt(2)
    v_pk_add_f32 v[72:73], v[72:73], v[74:75]
    s_waitcnt lgkmcnt(0)
    v_pk_add_f32 v[76:77], v[76:77], v[78:79]
    v_pk_add_f32 v[72:73], v[72:73], v[76:77]
    v_add_f32 v72, v72, v73
    v_cvt_f64_f32 v[74:75], v72
    v_add_f64 v[74:75], v[74:75], s[0:1]
    v_add_u32 v75, 0xbf480000, v75
    buffer_atomic_add_x2 v[74:75], v12, s[16:19], 0 offen offset:0 sc1
    buffer_atomic_add_x2 v[74:75], v12, s[16:19], s66 offen offset:0 sc1
Lsk_243:
LS12_244:
    s_barrier
    s_mul_i32 s90, s3, 216
    s_and_b32 s91, s74, 1
    s_mul_i32 s91, s91, 108
    s_add_u32 s90, s90, s91
    s_mul_i32 s91, s7, 28
    s_add_u32 s90, s90, s91
    s_lshl_b32 s91, s90, 1
    buffer_load_ushort a228, v26, s[36:39], s91 offen
    s_mul_i32 s90, s90, 1280
    s_lshr_b32 s91, s74, 1
    s_lshl_b32 s91, s91, 7
    s_add_u32 s90, s90, s91
    buffer_load_dwordx2 v[84:85], v24, s[40:43], s90 offen
    s_add_u32 s90, s90, 5120
    buffer_load_dwordx2 v[86:87], v24, s[40:43], s90 offen
    s_add_u32 s90, s90, 5120
    buffer_load_dwordx2 v[88:89], v24, s[40:43], s90 offen
    s_add_u32 s90, s90, 5120
    buffer_load_dwordx2 v[90:91], v24, s[40:43], s90 offen
    s_add_u32 s90, s90, 5120
    buffer_load_dwordx2 v[92:93], v24, s[40:43], s90 offen
    s_add_u32 s90, s90, 5120
    buffer_load_dwordx2 v[94:95], v24, s[40:43], s90 offen
    s_add_u32 s90, s90, 5120
    buffer_load_dwordx2 v[96:97], v24, s[40:43], s90 offen
    s_add_u32 s90, s90, 5120
    buffer_load_dwordx2 v[98:99], v24, s[40:43], s90 offen
    s_waitcnt vmcnt(4)
    s_mov_b32 s68, 0xe8000
    buffer_load_dwordx4 v[116:119], v7, s[16:19], s68 offen sc1
    buffer_load_dwordx4 v[112:115], v15, s[16:19], s68 offen sc1
    buffer_load_dwordx4 v[76:79], v7, s[16:19], s64 offen sc1
    buffer_load_dwordx4 v[72:75], v15, s[16:19], s64 offen sc1
    s_waitcnt vmcnt(4)
    v_accvgpr_read_b32 v26, a228
    v_lshlrev_b32 v26, 16, v26
    v_perm_b32 v100, v86, v84, s70
    v_accvgpr_write_b32 a208, v100
    v_perm_b32 v101, v90, v88, s70
    v_accvgpr_write_b32 a209, v101
    v_perm_b32 v100, v94, v92, s70
    v_accvgpr_write_b32 a210, v100
    v_perm_b32 v101, v98, v96, s70
    v_accvgpr_write_b32 a211, v101
    v_perm_b32 v100, v86, v84, s71
    v_accvgpr_write_b32 a212, v100
    v_perm_b32 v101, v90, v88, s71
    v_accvgpr_write_b32 a213, v101
    v_perm_b32 v100, v94, v92, s71
    v_accvgpr_write_b32 a214, v100
    v_perm_b32 v101, v98, v96, s71
    v_accvgpr_write_b32 a215, v101
    v_perm_b32 v100, v87, v85, s70
    v_accvgpr_write_b32 a216, v100
    v_perm_b32 v101, v91, v89, s70
    v_accvgpr_write_b32 a217, v101
    v_perm_b32 v100, v95, v93, s70
    v_accvgpr_write_b32 a218, v100
    v_perm_b32 v101, v99, v97, s70
    v_accvgpr_write_b32 a219, v101
    v_perm_b32 v100, v87, v85, s71
    v_accvgpr_write_b32 a220, v100
    v_perm_b32 v101, v91, v89, s71
    v_accvgpr_write_b32 a221, v101
    v_perm_b32 v100, v95, v93, s71
    v_accvgpr_write_b32 a222, v100
    v_perm_b32 v101, v99, v97, s71
    v_accvgpr_write_b32 a223, v101
    s_branch Lc_246
Lcp_247:
    buffer_load_dwordx4 v[116:119], v7, s[16:19], s68 offen sc1
    buffer_load_dwordx4 v[112:115], v15, s[16:19], s68 offen sc1
    buffer_load_dwordx4 v[76:79], v7, s[16:19], s64 offen sc1
    buffer_load_dwordx4 v[72:75], v15, s[16:19], s64 offen sc1
    s_sub_u32 s69, s69, 1
    s_cbranch_scc1 Lgive_250
Lc_246:
    s_waitcnt vmcnt(2)
    v_add_f32_dpp v112, v116, v112 quad_perm:[0,1,2,3] row_mask:0xf bank_mask:0xc
    v_add_f32_dpp v113, v117, v113 quad_perm:[0,1,2,3] row_mask:0xf bank_mask:0xc
    v_add_f32_dpp v114, v118, v114 quad_perm:[0,1,2,3] row_mask:0xf bank_mask:0xc
    v_add_f32_dpp v115, v119, v115 quad_perm:[0,1,2,3] row_mask:0xf bank_mask:0xc
    v_permlane32_swap_b32 v112, v113
    s_nop 0
    v_permlane32_swap_b32 v114, v115
    v_add_f32 v112, v112, v113
    v_add_f32 v114, v114, v115
    s_nop 1
    v_permlane16_swap_b32 v112, v114
    v_add_f32 v25, v112, v114
    s_nop 1
    v_add_f32_dpp v25, v25, v25 row_ror:8 row_mask:0xf bank_mask:0xf
    v_cmp_u_f32 vcc, v25, v25
    s_cbranch_vccnz Lcp_247
Lok_249:
    s_branch Lp_245w
Lp_245:
    buffer_load_dwordx4 v[76:79], v7, s[16:19], s64 offen sc1
    buffer_load_dwordx4 v[72:75], v15, s[16:19], s64 offen sc1
    s_sub_u32 s69, s69, 1
    s_cbranch_scc1 Lgive_252
Lp_245w:
    s_waitcnt vmcnt(1)
    v_pk_add_f32 v[80:81], v[76:77], v[78:79]
    s_nop 1
    v_add_f32_dpp v6, v80, v81 quad_perm:[0,1,2,3] row_mask:0xf bank_mask:0x3
    s_waitcnt vmcnt(0)
    v_add_f32_dpp v72, v76, v72 quad_perm:[0,1,2,3] row_mask:0xf bank_mask:0xc
    v_add_f32_dpp v73, v77, v73 quad_perm:[0,1,2,3] row_mask:0xf bank_mask:0xc
    v_add_f32_dpp v105, v6, v6 row_ror:2 row_mask:0xf bank_mask:0xf
    v_cmp_u_f32 vcc, v72, v6
    v_add_f32_dpp v74, v78, v74 quad_perm:[0,1,2,3] row_mask:0xf bank_mask:0xc
    v_add_f32_dpp v75, v79, v75 quad_perm:[0,1,2,3] row_mask:0xf bank_mask:0xc
    s_cbranch_vccnz Lp_245
    v_add_f32_dpp v105, v105, v105 row_ror:4 row_mask:0xf bank_mask:0xf
    v_permlane32_swap_b32 v72, v73
    s_nop 0
    v_add_f32_dpp v105, v105, v105 row_ror:8 row_mask:0xf bank_mask:0xf
    v_permlane32_swap_b32 v74, v75
    v_mul_f32 v105, 0x3acccccd, v105
    v_add_f32 v72, v72, v73
    s_nop 0
    v_mov_b32_dpp v106, v105 quad_perm:[0,0,2,2] row_mask:0xf bank_mask:0xf
    v_add_f32 v74, v74, v75
    v_mov_b32_dpp v107, v105 quad_perm:[1,1,3,3] row_mask:0xf bank_mask:0xf
    s_nop 0
    v_permlane16_swap_b32 v72, v74
    v_fma_f32 v107, -v106, v106, v107
    v_add_f32 v104, v72, v74
    v_max_f32 v107, 0, v107
    s_nop 0
    v_add_f32_dpp v104, v104, v104 row_ror:8 row_mask:0xf bank_mask:0xf
    v_mul_f32 v107, 0x3f800054, v107
    v_add_f32 v107, 0x2edbe6ff, v107
    v_rsq_f32 v107, v107
    v_fma_f32 v104, -v106, v25, v104
    v_fma_f32 v104, v104, v107, v26
    v_mul_f32 v108, v104, v104
    v_cmp_u_f32 vcc, v104, v105
    v_mul_f32 v108, 0xbdd2d3e8, v108
    v_add_f32 v108, 0xc0135761, v108
    s_cbranch_vccnz Lp_245
Lok_251:
    v_mul_f32 v108, v108, v104
    v_exp_f32 v109, v108
    s_nop 0
    v_add_f32 v109, 1.0, v109
    v_rcp_f32 v109, v109
    s_nop 0
    v_mul_f32 v104, v104, v109
    v_cvt_pk_bf16_f32 v104, v104, v104
    v_and_b32 v112, v104, v28
    v_and_b32 v113, v104, v29
    v_and_b32 v114, v104, v30
    v_and_b32 v115, v104, v31
    s_nop 1
    v_mfma_f32_16x16x32_bf16 v[72:75], v[112:115], a[208:211], 0
    v_mfma_f32_16x16x32_bf16 v[76:79], v[112:115], a[212:215], 0
    v_mfma_f32_16x16x32_bf16 v[80:83], v[112:115], a[216:219], 0
    v_mfma_f32_16x16x32_bf16 v[84:87], v[112:115], a[220:223], 0
    s_nop 4
    v_pk_add_f32 v[72:73], v[72:73], v[74:75]
    v_add_f32 v116, v72, v73
    v_pk_add_f32 v[76:77], v[76:77], v[78:79]
    v_add_f32 v117, v76, v77
    v_pk_add_f32 v[80:81], v[80:81], v[82:83]
    v_add_f32 v118, v80, v81
    v_pk_add_f32 v[84:85], v[84:85], v[86:87]
    v_add_f32_e64 v119, v84, v85
    ds_write_b128 v10, v[116:119] offset:2048
    s_cmp_lg_u32 s7, 0
    s_waitcnt lgkmcnt(0)
    s_barrier
    s_cbranch_scc1 Lsk_253
    ds_read2st64_b32 v[72:73], v23 offset0:8 offset1:9
    ds_read2st64_b32 v[74:75], v23 offset0:10 offset1:11
    ds_read2st64_b32 v[76:77], v23 offset0:12 offset1:13
    ds_read2st64_b32 v[78:79], v23 offset0:14 offset1:15
    s_nop 0
    s_waitcnt lgkmcnt(2)
    v_pk_add_f32 v[72:73], v[72:73], v[74:75]
    s_waitcnt lgkmcnt(0)
    v_pk_add_f32 v[76:77], v[76:77], v[78:79]
    v_pk_add_f32 v[72:73], v[72:73], v[76:77]
    v_add_f32 v72, v72, v73
    v_cvt_f64_f32_e64 v[74:75], v72
    v_add_f64 v[74:75], v[74:75], s[0:1]
    v_add_u32 v75, 0xbf480000, v75
    buffer_atomic_add_x2 v[74:75], v12, s[16:19], 0 offen offset:64 sc1
    buffer_atomic_add_x2 v[74:75], v12, s[16:19], s66 offen offset:64 sc1
Lsk_253:
LS15_254:
    s_mov_b32 s68, 0xe8000
    buffer_load_dwordx4 a[248:251], v4, s[16:19], s68 offen sc1
    buffer_load_dwordx4 a[244:247], v3, s[16:19], s68 offen sc1
    s_nop 0
    s_waitcnt vmcnt(0)
    v_accvgpr_read_b32 v72, a244
    v_accvgpr_read_b32 v73, a245
    v_accvgpr_read_b32 v74, a246
    v_accvgpr_read_b32 v75, a247
    v_accvgpr_read_b32 v76, a248
    v_accvgpr_read_b32 v77, a249
    v_accvgpr_read_b32 v78, a250
    v_accvgpr_read_b32 v79, a251
    v_add_f32_dpp v72, v76, v72 quad_perm:[0,1,2,3] row_mask:0xf bank_mask:0xc
    v_add_f32_dpp v73, v77, v73 quad_perm:[0,1,2,3] row_mask:0xf bank_mask:0xc
    v_add_f32_dpp v74, v78, v74 quad_perm:[0,1,2,3] row_mask:0xf bank_mask:0xc
    v_add_f32_dpp v75, v79, v75 quad_perm:[0,1,2,3] row_mask:0xf bank_mask:0xc
    v_permlane32_swap_b32 v72, v73
    s_nop 0
    v_permlane32_swap_b32 v74, v75
    v_add_f32 v72, v72, v73
    v_add_f32 v74, v74, v75
    s_nop 1
    v_permlane16_swap_b32 v72, v74
    v_add_f32_e64 v24, v72, v74
    s_nop 1
    v_add_f32_dpp v24, v24, v24 row_ror:8 row_mask:0xf bank_mask:0xf
    s_mov_b32 s64, 0x74000
    s_add_u32 s65, s79, 0x74000
    buffer_load_dwordx2 a[232:233], v11, s[16:19], s64 offen sc1
    buffer_load_dwordx4 a[236:239], v9, s[16:19], s64 offen sc1
Lp_255:
    buffer_load_dwordx4 v[76:79], v4, s[16:19], s64 offen sc1
    buffer_load_dwordx4 v[72:75], v3, s[16:19], s64 offen sc1
    s_sub_u32 s69, s69, 1
    s_cbranch_scc1 Lgive_257
    s_waitcnt vmcnt(1)
    v_pk_add_f32 v[80:81], v[76:77], v[78:79]
    s_nop 1
    v_add_f32_dpp v6, v80, v81 quad_perm:[0,1,2,3] row_mask:0xf bank_mask:0x3
    s_nop 0
    s_waitcnt vmcnt(0)
    v_add_f32_dpp v72, v76, v72 quad_perm:[0,1,2,3] row_mask:0xf bank_mask:0xc
    v_add_f32_dpp v73, v77, v73 quad_perm:[0,1,2,3] row_mask:0xf bank_mask:0xc
    v_add_f32_dpp v105, v6, v6 row_ror:2 row_mask:0xf bank_mask:0xf
    v_cmp_u_f32 vcc, v72, v6
    v_add_f32_dpp v74, v78, v74 quad_perm:[0,1,2,3] row_mask:0xf bank_mask:0xc
    v_add_f32_dpp v75, v79, v75 quad_perm:[0,1,2,3] row_mask:0xf bank_mask:0xc
    s_cbranch_vccnz Lp_255
    v_add_f32_dpp v105, v105, v105 row_ror:4 row_mask:0xf bank_mask:0xf
    v_permlane32_swap_b32 v72, v73
    s_nop 0
    v_add_f32_dpp v105, v105, v105 row_ror:8 row_mask:0xf bank_mask:0xf
    v_permlane32_swap_b32 v74, v75
    v_mul_f32 v105, 0x3acccccd, v105
    v_add_f32 v72, v72, v73
    s_nop 0
    v_mov_b32_dpp v106, v105 quad_perm:[0,0,2,2] row_mask:0xf bank_mask:0xf
    v_add_f32 v74, v74, v75
    v_mov_b32_dpp v107, v105 quad_perm:[1,1,3,3] row_mask:0xf bank_mask:0xf
    s_nop 0
    v_permlane16_swap_b32 v72, v74
    v_fma_f32 v107, -v106, v106, v107
    v_add_f32 v104, v72, v74
    v_max_f32 v107, 0, v107
    s_nop 0
    v_add_f32_dpp v104, v104, v104 row_ror:8 row_mask:0xf bank_mask:0xf
    v_add_f32 v107, 0x3727c5ac, v107
    v_rsq_f32 v107, v107
    v_fma_f32 v104, -v106, v24, v104
    v_mul_f32_e64 v104, v104, v107
    v_cvt_pk_bf16_f32 v107, v104, v104
    v_cmp_u_f32 vcc, v104, v105
    s_cbranch_vccnz Lp_255
Lok_256:
    ds_write_b16 v16, v107
    s_waitcnt lgkmcnt(0)
    s_nop 0
    s_barrier
LS18_258:
    s_mov_b64 exec, s[80:81]
    ds_read_b128 v[48:51], v17
    s_mov_b64 exec, s[82:83]
    ds_read_b128 v[52:55], v17
    s_mov_b64 exec, s[84:85]
    ds_read_b128 v[56:59], v17
    s_mov_b64 exec, s[86:87]
    ds_read_b128 v[60:63], v17
    s_mov_b64 exec, -1
    s_waitcnt lgkmcnt(3)
    v_mfma_f32_16x16x32_bf16 v[72:75], a[0:3], v[48:51], 0
    v_mfma_f32_16x16x32_bf16 v[76:79], a[32:35], v[48:51], 0
    s_waitcnt lgkmcnt(2)
    v_mfma_f32_16x16x32_bf16 v[72:75], a[8:11], v[52:55], v[72:75]
    v_mfma_f32_16x16x32_bf16 v[76:79], a[40:43], v[52:55], v[76:79]
    s_waitcnt lgkmcnt(1)
    v_mfma_f32_16x16x32_bf16 v[72:75], a[16:19], v[56:59], v[72:75]
    v_mfma_f32_16x16x32_bf16 v[76:79], a[48:51], v[56:59], v[76:79]
    s_waitcnt lgkmcnt(0)
    v_mfma_f32_16x16x32_bf16 v[72:75], a[24:27], v[60:63], v[72:75]
    v_mfma_f32_16x16x32_bf16 v[76:79], a[56:59], v[60:63], v[76:79]
    v_mfma_f32_16x16x32_bf16 v[80:83], a[64:67], v[48:51], 0
    v_mfma_f32_16x16x32_bf16 v[84:87], a[96:99], v[48:51], 0
    v_mfma_f32_16x16x32_bf16 v[80:83], a[72:75], v[52:55], v[80:83]
    v_mfma_f32_16x16x32_bf16 v[84:87], a[104:107], v[52:55], v[84:87]
    v_mfma_f32_16x16x32_bf16 v[80:83], a[80:83], v[56:59], v[80:83]
    v_mfma_f32_16x16x32_bf16 v[84:87], a[112:115], v[56:59], v[84:87]
    v_mfma_f32_16x16x32_bf16 v[80:83], a[88:91], v[60:63], v[80:83]
    v_add_f32_dpp v104, v73, v72 row_ror:12 row_mask:0xf bank_mask:0x1
    v_add_f32_dpp v104, v74, v104 row_ror:8 row_mask:0xf bank_mask:0x1
    v_mfma_f32_16x16x32_bf16 v[84:87], a[120:123], v[60:63], v[84:87]
    v_add_f32_dpp v104, v75, v104 row_ror:4 row_mask:0xf bank_mask:0x1
    v_add_f32_dpp v104, v76, v77 row_ror:4 row_mask:0xf bank_mask:0x2
    v_mfma_f32_16x16x32_bf16 v[88:91], a[4:7], v[48:51], 0
    v_add_f32_dpp v104, v78, v104 row_ror:12 row_mask:0xf bank_mask:0x2
    v_add_f32_dpp v104, v79, v104 row_ror:8 row_mask:0xf bank_mask:0x2
    v_mfma_f32_16x16x32_bf16 v[92:95], a[36:39], v[48:51], 0
    v_add_f32_dpp v104, v80, v82 row_ror:8 row_mask:0xf bank_mask:0x4
    v_add_f32_dpp v104, v81, v104 row_ror:4 row_mask:0xf bank_mask:0x4
    v_mfma_f32_16x16x32_bf16 v[88:91], a[12:15], v[52:55], v[88:91]
    v_add_f32_dpp v104, v83, v104 row_ror:12 row_mask:0xf bank_mask:0x4
    v_add_f32_dpp v104, v84, v87 row_ror:12 row_mask:0xf bank_mask:0x8
    v_mfma_f32_16x16x32_bf16 v[92:95], a[44:47], v[52:55], v[92:95]
    v_add_f32_dpp v104, v85, v104 row_ror:8 row_mask:0xf bank_mask:0x8
    v_add_f32_dpp v104, v86, v104 row_ror:4 row_mask:0xf bank_mask:0x8
    v_mfma_f32_16x16x32_bf16 v[88:91], a[20:23], v[56:59], v[88:91]
    v_mfma_f32_16x16x32_bf16 v[92:95], a[52:55], v[56:59], v[92:95]
    v_mfma_f32_16x16x32_bf16 v[88:91], a[28:31], v[60:63], v[88:91]
    v_mfma_f32_16x16x32_bf16 v[92:95], a[60:63], v[60:63], v[92:95]
    v_mfma_f32_16x16x32_bf16 v[96:99], a[68:71], v[48:51], 0
    v_mfma_f32_16x16x32_bf16 v[100:103], a[100:103], v[48:51], 0
    v_mfma_f32_16x16x32_bf16 v[96:99], a[76:79], v[52:55], v[96:99]
    v_mfma_f32_16x16x32_bf16 v[100:103], a[108:111], v[52:55], v[100:103]
    v_mfma_f32_16x16x32_bf16 v[96:99], a[84:87], v[56:59], v[96:99]
    v_mfma_f32_16x16x32_bf16 v[100:103], a[116:119], v[56:59], v[100:103]
    v_mfma_f32_16x16x32_bf16 v[96:99], a[92:95], v[60:63], v[96:99]
    v_add_f32_dpp v105, v89, v88 row_ror:12 row_mask:0xf bank_mask:0x1
    v_add_f32_dpp v105, v90, v105 row_ror:8 row_mask:0xf bank_mask:0x1
    v_mfma_f32_16x16x32_bf16 v[100:103], a[124:127], v[60:63], v[100:103]
    v_add_f32_dpp v105, v91, v105 row_ror:4 row_mask:0xf bank_mask:0x1
    v_add_f32_dpp v105, v92, v93 row_ror:4 row_mask:0xf bank_mask:0x2
    v_add_f32_dpp v105, v94, v105 row_ror:12 row_mask:0xf bank_mask:0x2
    v_add_f32_dpp v105, v95, v105 row_ror:8 row_mask:0xf bank_mask:0x2
    s_nop 0
    v_add_f32_dpp v105, v96, v98 row_ror:8 row_mask:0xf bank_mask:0x4
    v_add_f32_dpp v105, v97, v105 row_ror:4 row_mask:0xf bank_mask:0x4
    v_add_f32_dpp v105, v99, v105 row_ror:12 row_mask:0xf bank_mask:0x4
    v_add_f32_dpp v105, v100, v103 row_ror:12 row_mask:0xf bank_mask:0x8
    v_add_f32_dpp v105, v101, v105 row_ror:8 row_mask:0xf bank_mask:0x8
    v_add_f32_dpp v105, v102, v105 row_ror:4 row_mask:0xf bank_mask:0x8
    v_max_f32 v106, v104, v105
    s_nop 1
    v_max_f32_dpp v106, v106, v106 row_ror:1 row_mask:0xf bank_mask:0xf
    s_nop 1
    v_max_f32_dpp v106, v106, v106 row_ror:2 row_mask:0xf bank_mask:0xf
    s_nop 1
    v_max_f32_dpp v106, v106, v106 row_ror:4 row_mask:0xf bank_mask:0xf
    s_nop 1
    v_max_f32_dpp v106, v106, v106 row_ror:8 row_mask:0xf bank_mask:0xf
    s_nop 1
    v_max_f32_dpp v106, v106, v106 row_bcast:15 row_mask:0xa bank_mask:0xf
    s_nop 1
    v_max_f32_dpp v106, v106, v106 row_bcast:31 row_mask:0xc bank_mask:0xf
    v_mul_f32 v106, v106, v27
    s_nop 0
    v_readlane_b32 s72, v106, 63
    s_nop 1
    v_fma_f32 v104, v104, v27, -s72
    v_fma_f32 v105, v105, v27, -s72
    v_exp_f32 v104, v104
    v_exp_f32_e64 v105, v105
    s_nop 0
    v_cvt_pk_bf16_f32 v108, v104, v105
LS19_259:
    s_nop 1
    v_mov_b32_dpp v64, v108 row_newbcast:0 row_mask:0xf bank_mask:0x1
    v_mov_b32_dpp v65, v108 row_newbcast:0 row_mask:0xf bank_mask:0x2
    v_mov_b32_dpp v66, v108 row_newbcast:0 row_mask:0xf bank_mask:0x4
    v_mov_b32_dpp v67, v108 row_newbcast:0 row_mask:0xf bank_mask:0x8
    s_nop 0
    s_nop 0
    v_mfma_f32_16x16x32_bf16 v[72:75], v[64:67], v[126:129], 0
    v_mov_b32_dpp v68, v108 row_newbcast:1 row_mask:0xf bank_mask:0x1
    v_mov_b32_dpp v69, v108 row_newbcast:1 row_mask:0xf bank_mask:0x2
    v_mov_b32_dpp v70, v108 row_newbcast:1 row_mask:0xf bank_mask:0x4
    v_mfma_f32_16x16x32_bf16 v[76:79], v[64:67], v[130:133], 0
    v_mov_b32_dpp v71, v108 row_newbcast:1 row_mask:0xf bank_mask:0x8
    v_lshlrev_b32_e64 v107, 16, v108
    v_and_b32 v104, 0xffff0000, v108
    v_mfma_f32_16x16x32_bf16 v[72:75], v[68:71], v[134:137], v[72:75]
    v_mov_b32_dpp v64, v108 row_newbcast:2 row_mask:0xf bank_mask:0x1
    v_mov_b32_dpp v65, v108 row_newbcast:2 row_mask:0xf bank_mask:0x2
    v_mov_b32_dpp v66, v108 row_newbcast:2 row_mask:0xf bank_mask:0x4
    v_mfma_f32_16x16x32_bf16 v[76:79], v[68:71], v[138:141], v[76:79]
    v_mov_b32_dpp v67, v108 row_newbcast:2 row_mask:0xf bank_mask:0x8
    v_add_f32 v107, v107, v104
    s_nop 1
    v_add_f32_dpp v107, v107, v107 row_ror:1 row_mask:0xf bank_mask:0xf
    v_mfma_f32_16x16x32_bf16 v[72:75], v[64:67], v[142:145], v[72:75]
    v_mov_b32_dpp v68, v108 row_newbcast:3 row_mask:0xf bank_mask:0x1
    v_mov_b32_dpp v69, v108 row_newbcast:3 row_mask:0xf bank_mask:0x2
    v_mov_b32_dpp v70, v108 row_newbcast:3 row_mask:0xf bank_mask:0x4
    v_mfma_f32_16x16x32_bf16 v[76:79], v[64:67], v[146:149], v[76:79]
    v_mov_b32_dpp v71, v108 row_newbcast:3 row_mask:0xf bank_mask:0x8
    v_add_f32_dpp v107, v107, v107 row_ror:2 row_mask:0xf bank_mask:0xf
    s_nop 0
    v_mfma_f32_16x16x32_bf16 v[72:75], v[68:71], v[150:153], v[72:75]
    v_mov_b32_dpp v64, v108 row_newbcast:4 row_mask:0xf bank_mask:0x1
    v_mov_b32_dpp v65, v108 row_newbcast:4 row_mask:0xf bank_mask:0x2
    v_mov_b32_dpp v66, v108 row_newbcast:4 row_mask:0xf bank_mask:0x4
    v_mfma_f32_16x16x32_bf16 v[76:79], v[68:71], v[154:157], v[76:79]
    v_mov_b32_dpp v67, v108 row_newbcast:4 row_mask:0xf bank_mask:0x8
    v_add_f32_dpp v107, v107, v107 row_ror:4 row_mask:0xf bank_mask:0xf
    s_nop 0
    v_mfma_f32_16x16x32_bf16 v[72:75], v[64:67], v[158:161], v[72:75]
    v_mov_b32_dpp v68, v108 row_newbcast:5 row_mask:0xf bank_mask:0x1
    v_mov_b32_dpp v69, v108 row_newbcast:5 row_mask:0xf bank_mask:0x2
    v_mov_b32_dpp v70, v108 row_newbcast:5 row_mask:0xf bank_mask:0x4
    v_mfma_f32_16x16x32_bf16 v[76:79], v[64:67], v[162:165], v[76:79]
    v_mov_b32_dpp v71, v108 row_newbcast:5 row_mask:0xf bank_mask:0x8
    v_add_f32_dpp v107, v107, v107 row_ror:8 row_mask:0xf bank_mask:0xf
    s_nop 0
    v_mfma_f32_16x16x32_bf16 v[72:75], v[68:71], v[166:169], v[72:75]
    v_mov_b32_dpp v64, v108 row_newbcast:6 row_mask:0xf bank_mask:0x1
    v_mov_b32_dpp v65, v108 row_newbcast:6 row_mask:0xf bank_mask:0x2
    v_mov_b32_dpp v66, v108 row_newbcast:6 row_mask:0xf bank_mask:0x4
    v_mfma_f32_16x16x32_bf16 v[76:79], v[68:71], v[170:173], v[76:79]
    v_mov_b32_dpp v67, v108 row_newbcast:6 row_mask:0xf bank_mask:0x8
    v_add_f32_dpp v107, v107, v107 row_bcast:15 row_mask:0xa bank_mask:0xf
    s_nop 0
    v_mfma_f32_16x16x32_bf16 v[72:75], v[64:67], v[174:177], v[72:75]
    v_mov_b32_dpp v68, v108 row_newbcast:7 row_mask:0xf bank_mask:0x1
    v_mov_b32_dpp v69, v108 row_newbcast:7 row_mask:0xf bank_mask:0x2
    v_mov_b32_dpp v70, v108 row_newbcast:7 row_mask:0xf bank_mask:0x4
    v_mfma_f32_16x16x32_bf16 v[76:79], v[64:67], v[178:181], v[76:79]
    v_mov_b32_dpp v71, v108 row_newbcast:7 row_mask:0xf bank_mask:0x8
    v_add_f32_dpp v107, v107, v107 row_bcast:31 row_mask:0xc bank_mask:0xf
    s_nop 0
    v_mfma_f32_16x16x32_bf16 v[72:75], v[68:71], v[182:185], v[72:75]
    v_mov_b32_dpp v64, v108 row_newbcast:8 row_mask:0xf bank_mask:0x1
    v_mov_b32_dpp v65, v108 row_newbcast:8 row_mask:0xf bank_mask:0x2
    v_mov_b32_dpp v66, v108 row_newbcast:8 row_mask:0xf bank_mask:0x4
    v_mfma_f32_16x16x32_bf16 v[76:79], v[68:71], v[186:189], v[76:79]
    v_mov_b32_dpp v67, v108 row_newbcast:8 row_mask:0xf bank_mask:0x8
    ds_write_b64 v18, v[106:107]
    s_nop 0
    v_mfma_f32_16x16x32_bf16 v[72:75], v[64:67], v[190:193], v[72:75]
    v_mov_b32_dpp v68, v108 row_newbcast:9 row_mask:0xf bank_mask:0x1
    v_mov_b32_dpp v69, v108 row_newbcast:9 row_mask:0xf bank_mask:0x2
    v_mov_b32_dpp v70, v108 row_newbcast:9 row_mask:0xf bank_mask:0x4
    v_mfma_f32_16x16x32_bf16 v[76:79], v[64:67], v[194:197], v[76:79]
    v_mov_b32_dpp v71, v108 row_newbcast:9 row_mask:0xf bank_mask:0x8
    s_waitcnt lgkmcnt(0)
    s_barrier
    ds_read_b64 v[110:111], v19
    v_mfma_f32_16x16x32_bf16 v[72:75], v[68:71], v[198:201], v[72:75]
    v_mov_b32_dpp v64, v108 row_newbcast:10 row_mask:0xf bank_mask:0x1
    v_mov_b32_dpp v65, v108 row_newbcast:10 row_mask:0xf bank_mask:0x2
    v_mov_b32_dpp v66, v108 row_newbcast:10 row_mask:0xf bank_mask:0x4
    v_mfma_f32_16x16x32_bf16 v[76:79], v[68:71], v[202:205], v[76:79]
    v_mov_b32_dpp v67, v108 row_newbcast:10 row_mask:0xf bank_mask:0x8
    s_nop 0
    s_nop 0
    v_mfma_f32_16x16x32_bf16 v[72:75], v[64:67], v[206:209], v[72:75]
    v_mov_b32_dpp v68, v108 row_newbcast:11 row_mask:0xf bank_mask:0x1
    v_mov_b32_dpp v69, v108 row_newbcast:11 row_mask:0xf bank_mask:0x2
    v_mov_b32_dpp v70, v108 row_newbcast:11 row_mask:0xf bank_mask:0x4
    v_mfma_f32_16x16x32_bf16 v[76:79], v[64:67], v[210:213], v[76:79]
    v_mov_b32_dpp v71, v108 row_newbcast:11 row_mask:0xf bank_mask:0x8
    s_waitcnt lgkmcnt(0)
    s_nop 0
    v_mfma_f32_16x16x32_bf16 v[72:75], v[68:71], v[214:217], v[72:75]
    v_mov_b32_dpp v64, v108 row_newbcast:12 row_mask:0xf bank_mask:0x1
    v_mov_b32_dpp v65, v108 row_newbcast:12 row_mask:0xf bank_mask:0x2
    v_mov_b32_dpp v66, v108 row_newbcast:12 row_mask:0xf bank_mask:0x4
    v_mfma_f32_16x16x32_bf16 v[76:79], v[68:71], v[218:221], v[76:79]
    v_mov_b32_dpp v67, v108 row_newbcast:12 row_mask:0xf bank_mask:0x8
    v_max_f32_dpp v112, v110, v110 quad_perm:[1,0,3,2] row_mask:0xf bank_mask:0xf
    s_nop 0
    v_mfma_f32_16x16x32_bf16 v[72:75], v[64:67], v[222:225], v[72:75]
    v_mov_b32_dpp v68, v108 row_newbcast:13 row_mask:0xf bank_mask:0x1
    v_mov_b32_dpp v69, v108 row_newbcast:13 row_mask:0xf bank_mask:0x2
    v_mov_b32_dpp v70, v108 row_newbcast:13 row_mask:0xf bank_mask:0x4
    v_mfma_f32_16x16x32_bf16 v[76:79], v[64:67], v[226:229], v[76:79]
    v_mov_b32_dpp v71, v108 row_newbcast:13 row_mask:0xf bank_mask:0x8
    v_max_f32_dpp v112, v112, v112 quad_perm:[2,3,0,1] row_mask:0xf bank_mask:0xf
    v_sub_f32 v109, v110, v112
    v_mfma_f32_16x16x32_bf16 v[72:75], v[68:71], v[230:233], v[72:75]
    v_mov_b32_dpp v64, v108 row_newbcast:14 row_mask:0xf bank_mask:0x1
    v_mov_b32_dpp v65, v108 row_newbcast:14 row_mask:0xf bank_mask:0x2
    v_mov_b32_dpp v66, v108 row_newbcast:14 row_mask:0xf bank_mask:0x4
    v_mfma_f32_16x16x32_bf16 v[76:79], v[68:71], v[234:237], v[76:79]
    v_mov_b32_dpp v67, v108 row_newbcast:14 row_mask:0xf bank_mask:0x8
    v_exp_f32 v109, v109
    s_nop 0
    v_mfma_f32_16x16x32_bf16 v[72:75], v[64:67], v[238:241], v[72:75]
    v_mov_b32_dpp v68, v108 row_newbcast:15 row_mask:0xf bank_mask:0x1
    v_mov_b32_dpp v69, v108 row_newbcast:15 row_mask:0xf bank_mask:0x2
    v_mov_b32_dpp v70, v108 row_newbcast:15 row_mask:0xf bank_mask:0x4
    v_mfma_f32_16x16x32_bf16 v[76:79], v[64:67], v[242:245], v[76:79]
    v_mov_b32_dpp v71, v108 row_newbcast:15 row_mask:0xf bank_mask:0x8
    v_mul_f32_e64 v113, v109, v111
    s_nop 0
    v_mfma_f32_16x16x32_bf16 v[72:75], v[68:71], v[246:249], v[72:75]
    v_mfma_f32_16x16x32_bf16 v[76:79], v[68:71], v[250:253], v[76:79]
    v_add_f32_dpp v113, v113, v113 quad_perm:[1,0,3,2] row_mask:0xf bank_mask:0xf
    s_nop 1
    v_add_f32_dpp v113, v113, v113 quad_perm:[2,3,0,1] row_mask:0xf bank_mask:0xf
    s_cmp_lg_u32 s7, 0
    s_cbranch_scc1 Lnos_260
    s_mov_b64 exec, 0x10001
    buffer_store_dwordx2 v[112:113], v1, s[16:19], s65 offen sc1
    s_mov_b64 exec, -1
Lnos_260:
LS20_261:
    s_nop 0
    v_mul_f32_dpp v104, v109, v72 quad_perm:[0,0,0,0] row_mask:0xf bank_mask:0xf
    v_mul_f32_dpp v105, v109, v76 quad_perm:[0,0,0,0] row_mask:0xf bank_mask:0xf
    ds_write2_b32 v20, v104, v105 offset0:0 offset1:64
    s_cmp_lg_u32 s7, 0
    s_waitcnt lgkmcnt(0)
    s_barrier
    s_cbranch_scc1 Lsk_262
    ds_read2_b64 v[72:75], v21 offset0:0 offset1:64
    ds_read2_b64 v[76:79], v21 offset0:128 offset1:192
    s_waitcnt lgkmcnt(1)
    v_pk_add_f32 v[72:73], v[72:73], v[74:75]
    s_waitcnt lgkmcnt(0)
    v_pk_add_f32 v[76:77], v[76:77], v[78:79]
    v_pk_add_f32 v[72:73], v[72:73], v[76:77]
    v_cvt_pk_bf16_f32 v72, v72, v73
    buffer_store_dword v72, v8, s[16:19], s64 offen sc1
Lsk_262:
LS21_263:
Lp_264:
    buffer_load_dwordx2 v[108:109], v11, s[16:19], s64 offen sc1
    buffer_load_dwordx4 v[104:107], v9, s[16:19], s64 offen sc1
    s_sub_u32 s69, s69, 1
    s_cbranch_scc1 Lgive_266
    s_nop 0
    s_waitcnt vmcnt(0)
    v_max3_u32 v113, v104, v105, v106
    v_max3_u32 v113, v113, v107, v108
    v_mfma_f32_16x16x32_bf16 v[72:75], v[104:107], a[160:163], 0
    v_max_u32 v113, v113, v109
    v_cmp_eq_u32 vcc, -1, v113
    v_max_f32_dpp v110, v108, v108 quad_perm:[1,0,3,2] row_mask:0xf bank_mask:0xf
    s_cbranch_vccnz Lp_264
Lok_265:
    v_mfma_f32_16x16x32_bf16 v[76:79], v[104:107], a[164:167], 0
    v_max_f32_dpp v110, v110, v110 quad_perm:[2,3,0,1] row_mask:0xf bank_mask:0xf
    v_mfma_f32_16x16x32_bf16 v[80:83], v[104:107], a[168:171], 0
    s_nop 0
    v_max_f32_dpp v110, v110, v110 row_half_mirror row_mask:0xf bank_mask:0xf
    v_mfma_f32_16x16x32_bf16 v[84:87], v[104:107], a[172:175], 0
    v_sub_f32 v111, v108, v110
    v_exp_f32 v111, v111
    v_mfma_f32_16x16x32_bf16 v[88:91], v[104:107], a[176:179], 0
    v_mul_f32_e64 v112, v111, v109
    v_mfma_f32_16x16x32_bf16 v[92:95], v[104:107], a[180:183], 0
    s_nop 0
    v_add_f32_dpp v112, v112, v112 quad_perm:[1,0,3,2] row_mask:0xf bank_mask:0xf
    v_mfma_f32_16x16x32_bf16 v[96:99], v[104:107], a[184:187], 0
    s_nop 0
    v_add_f32_dpp v112, v112, v112 quad_perm:[2,3,0,1] row_mask:0xf bank_mask:0xf
    v_mfma_f32_16x16x32_bf16 v[100:103], v[104:107], a[188:191], 0
    s_nop 0
    v_add_f32_dpp v112, v112, v112 row_half_mirror row_mask:0xf bank_mask:0xf
    v_rcp_f32 v112, v112
    s_nop 0
    v_mul_f32_e64 v111, v111, v112
    s_nop 1
    v_mul_f32_dpp v116, v111, v72 row_newbcast:0 row_mask:0xf bank_mask:0xf
    v_mul_f32_dpp v117, v111, v76 row_newbcast:0 row_mask:0xf bank_mask:0xf
    v_mul_f32_dpp v118, v111, v80 row_newbcast:0 row_mask:0xf bank_mask:0xf
    v_mul_f32_dpp v119, v111, v84 row_newbcast:0 row_mask:0xf bank_mask:0xf
    v_mul_f32_dpp v120, v111, v88 row_newbcast:0 row_mask:0xf bank_mask:0xf
    v_mul_f32_dpp v121, v111, v92 row_newbcast:0 row_mask:0xf bank_mask:0xf
    v_mul_f32_dpp v122, v111, v96 row_newbcast:0 row_mask:0xf bank_mask:0xf
    v_mul_f32_dpp v123, v111, v100 row_newbcast:0 row_mask:0xf bank_mask:0xf
    v_fmac_f32_dpp v116, v111, v73 row_newbcast:1 row_mask:0xf bank_mask:0xf
    v_fmac_f32_dpp v117, v111, v77 row_newbcast:1 row_mask:0xf bank_mask:0xf
    v_fmac_f32_dpp v118, v111, v81 row_newbcast:1 row_mask:0xf bank_mask:0xf
    v_fmac_f32_dpp v119, v111, v85 row_newbcast:1 row_mask:0xf bank_mask:0xf
    v_fmac_f32_dpp v120, v111, v89 row_newbcast:1 row_mask:0xf bank_mask:0xf
    v_fmac_f32_dpp v121, v111, v93 row_newbcast:1 row_mask:0xf bank_mask:0xf
    v_fmac_f32_dpp v122, v111, v97 row_newbcast:1 row_mask:0xf bank_mask:0xf
    v_fmac_f32_dpp v123, v111, v101 row_newbcast:1 row_mask:0xf bank_mask:0xf
    v_fmac_f32_dpp v116, v111, v74 row_newbcast:2 row_mask:0xf bank_mask:0xf
    v_fmac_f32_dpp v117, v111, v78 row_newbcast:2 row_mask:0xf bank_mask:0xf
    v_fmac_f32_dpp v118, v111, v82 row_newbcast:2 row_mask:0xf bank_mask:0xf
    v_fmac_f32_dpp v119, v111, v86 row_newbcast:2 row_mask:0xf bank_mask:0xf
    v_fmac_f32_dpp v120, v111, v90 row_newbcast:2 row_mask:0xf bank_mask:0xf
    v_fmac_f32_dpp v121, v111, v94 row_newbcast:2 row_mask:0xf bank_mask:0xf
    v_fmac_f32_dpp v122, v111, v98 row_newbcast:2 row_mask:0xf bank_mask:0xf
    v_fmac_f32_dpp v123, v111, v102 row_newbcast:2 row_mask:0xf bank_mask:0xf
    v_fmac_f32_dpp v116, v111, v75 row_newbcast:3 row_mask:0xf bank_mask:0xf
    v_fmac_f32_dpp v117, v111, v79 row_newbcast:3 row_mask:0xf bank_mask:0xf
    v_fmac_f32_dpp v118, v111, v83 row_newbcast:3 row_mask:0xf bank_mask:0xf
    v_fmac_f32_dpp v119, v111, v87 row_newbcast:3 row_mask:0xf bank_mask:0xf
    v_fmac_f32_dpp v120, v111, v91 row_newbcast:3 row_mask:0xf bank_mask:0xf
    v_fmac_f32_dpp v121, v111, v95 row_newbcast:3 row_mask:0xf bank_mask:0xf
    v_fmac_f32_dpp v122, v111, v99 row_newbcast:3 row_mask:0xf bank_mask:0xf
    v_fmac_f32_dpp v123, v111, v103 row_newbcast:3 row_mask:0xf bank_mask:0xf
    v_permlane16_swap_b32 v116, v120
    v_permlane16_swap_b32 v117, v121
    v_permlane16_swap_b32 v118, v122
    v_permlane16_swap_b32 v119, v123
    v_pk_add_f32 v[116:117], v[116:117], v[120:121]
    v_pk_add_f32 v[118:119], v[118:119], v[122:123]
    ds_write_b128 v22, v[116:119] offset:0
    s_cmp_lg_u32 s7, 0
    s_waitcnt lgkmcnt(0)
    s_barrier
    s_cbranch_scc1 Lsk_267
    ds_read2st64_b32 v[72:73], v23 offset0:0 offset1:1
    ds_read2st64_b32 v[74:75], v23 offset0:2 offset1:3
    ds_read2st64_b32 v[76:77], v23 offset0:4 offset1:5
    ds_read2st64_b32 v[78:79], v23 offset0:6 offset1:7
    s_waitcnt lgkmcnt(2)
    v_pk_add_f32 v[72:73], v[72:73], v[74:75]
    s_waitcnt lgkmcnt(0)
    v_pk_add_f32 v[76:77], v[76:77], v[78:79]
    v_pk_add_f32 v[72:73], v[72:73], v[76:77]
    v_add_f32 v72, v72, v73
    v_cvt_f64_f32 v[74:75], v72
    v_add_f64 v[74:75], v[74:75], s[0:1]
    v_add_u32 v75, 0xbf480000, v75
    buffer_atomic_add_x2 v[74:75], v12, s[16:19], 0 offen offset:128 sc1
    buffer_atomic_add_x2 v[74:75], v12, s[16:19], s66 offen offset:128 sc1
Lsk_267:
LS22_268:
Lp_269:
    buffer_load_dwordx4 v[76:79], v7, s[16:19], s64 offen sc1
    buffer_load_dwordx4 v[72:75], v15, s[16:19], s64 offen sc1
    s_sub_u32 s69, s69, 1
    s_cbranch_scc1 Lgive_271
    s_waitcnt vmcnt(1)
    v_pk_add_f32 v[80:81], v[76:77], v[78:79]
    s_nop 1
    v_add_f32_dpp v6, v80, v81 quad_perm:[0,1,2,3] row_mask:0xf bank_mask:0x3
    s_waitcnt vmcnt(0)
    v_add_f32_dpp v72, v76, v72 quad_perm:[0,1,2,3] row_mask:0xf bank_mask:0xc
    v_add_f32_dpp v73, v77, v73 quad_perm:[0,1,2,3] row_mask:0xf bank_mask:0xc
    v_add_f32_dpp v105, v6, v6 row_ror:2 row_mask:0xf bank_mask:0xf
    v_cmp_u_f32 vcc, v72, v6
    v_add_f32_dpp v74, v78, v74 quad_perm:[0,1,2,3] row_mask:0xf bank_mask:0xc
    v_add_f32_dpp v75, v79, v75 quad_perm:[0,1,2,3] row_mask:0xf bank_mask:0xc
    s_cbranch_vccnz Lp_269
    v_add_f32_dpp v105, v105, v105 row_ror:4 row_mask:0xf bank_mask:0xf
    v_permlane32_swap_b32 v72, v73
    s_nop 0
    v_add_f32_dpp v105, v105, v105 row_ror:8 row_mask:0xf bank_mask:0xf
    v_permlane32_swap_b32 v74, v75
    v_mul_f32 v105, 0x3acccccd, v105
    v_add_f32 v72, v72, v73
    s_nop 0
    v_mov_b32_dpp v106, v105 quad_perm:[0,0,2,2] row_mask:0xf bank_mask:0xf
    v_add_f32_e64 v74, v74, v75
    v_mov_b32_dpp v107, v105 quad_perm:[1,1,3,3] row_mask:0xf bank_mask:0xf
    s_nop 0
    v_permlane16_swap_b32 v72, v74
    v_fma_f32 v107, -v106, v106, v107
    v_add_f32 v104, v72, v74
    v_max_f32 v107, 0, v107
    s_nop 0
    v_add_f32_dpp v104, v104, v104 row_ror:8 row_mask:0xf bank_mask:0xf
    v_mul_f32 v107, 0x3f800054, v107
    v_add_f32 v107, 0x2edbe6ff, v107
    v_rsq_f32 v107, v107
    v_fma_f32 v104, -v106, v25, v104
    v_fma_f32 v104, v104, v107, v26
    v_mul_f32 v108, v104, v104
    v_cmp_u_f32 vcc, v104, v105
    v_mul_f32 v108, 0xbdd2d3e8, v108
    v_add_f32 v108, 0xc0135761, v108
    s_cbranch_vccnz Lp_269
Lok_270:
    v_mul_f32 v108, v108, v104
    v_exp_f32 v109, v108
    s_nop 0
    v_add_f32 v109, 1.0, v109
    v_rcp_f32 v109, v109
    s_nop 0
    v_mul_f32 v104, v104, v109
    v_cvt_pk_bf16_f32 v104, v104, v104
    v_and_b32 v112, v104, v28
    v_and_b32 v113, v104, v29
    v_and_b32 v114, v104, v30
    v_and_b32 v115, v104, v31
    s_nop 1
    v_mfma_f32_16x16x32_bf16 v[72:75], v[112:115], a[208:211], 0
    v_mfma_f32_16x16x32_bf16 v[76:79], v[112:115], a[212:215], 0
    v_mfma_f32_16x16x32_bf16 v[80:83], v[112:115], a[216:219], 0
    v_mfma_f32_16x16x32_bf16 v[84:87], v[112:115], a[220:223], 0
    s_nop 4
    v_pk_add_f32 v[72:73], v[72:73], v[74:75]
    v_add_f32 v116, v72, v73
    v_pk_add_f32 v[76:77], v[76:77], v[78:79]
    v_add_f32 v117, v76, v77
    v_pk_add_f32 v[80:81], v[80:81], v[82:83]
    v_add_f32 v118, v80, v81
    v_pk_add_f32 v[84:85], v[84:85], v[86:87]
    v_add_f32 v119, v84, v85
    ds_write_b128 v10, v[116:119] offset:2048
    s_cmp_lg_u32 s7, 0
    s_waitcnt lgkmcnt(0)
    s_barrier
    s_cbranch_scc1 Lsk_272
    ds_read2st64_b32 v[72:73], v23 offset0:8 offset1:9
    ds_read2st64_b32 v[74:75], v23 offset0:10 offset1:11
    ds_read2st64_b32 v[76:77], v23 offset0:12 offset1:13
    ds_read2st64_b32 v[78:79], v23 offset0:14 offset1:15
    s_waitcnt lgkmcnt(2)
    v_pk_add_f32 v[72:73], v[72:73], v[74:75]
    s_waitcnt lgkmcnt(0)
    v_pk_add_f32 v[76:77], v[76:77], v[78:79]
    v_pk_add_f32 v[72:73], v[72:73], v[76:77]
    v_add_f32 v72, v72, v73
    v_cvt_f64_f32_e64 v[74:75], v72
    v_add_f64 v[74:75], v[74:75], s[0:1]
    v_add_u32 v75, 0xbf480000, v75
    buffer_atomic_add_x2 v[74:75], v12, s[16:19], 0 offen offset:192 sc1
    buffer_atomic_add_x2 v[74:75], v12, s[16:19], s66 offen offset:192 sc1
Lsk_272:
LS25_273:
    s_endpgm
Lretry_239:
    s_cmp_eq_u32 s69, 0
    s_cbranch_scc1 Lfok_237
    s_sub_u32 s69, s69, 1
    s_branch Lfp_236
Lfp_236:
    buffer_load_dword v114, v119, s[52:55], 0 offen sc1
    s_waitcnt vmcnt(0)
    s_branch Lfc_238
Lgive_242:
    s_mov_b32 s69, 0
    s_waitcnt vmcnt(0)
    s_branch Lok_241
Lgive_250:
    s_mov_b32 s69, 0
    s_waitcnt vmcnt(0)
    s_branch Lok_249
Lgive_252:
    s_mov_b32 s69, 0
    s_waitcnt vmcnt(0)
    s_branch Lok_251
Lgive_257:
    s_mov_b32 s69, 0
    s_waitcnt vmcnt(0)
    s_branch Lok_256
Lgive_266:
    s_mov_b32 s69, 0
    s_waitcnt vmcnt(0)
    s_branch Lok_265
Lgive_271:
    s_mov_b32 s69, 0
    s_waitcnt vmcnt(0)
    s_branch Lok_270
L_loopC_slow:
LS10_274:
    s_nop 0
    v_mul_f32_dpp v104, v109, v72 quad_perm:[0,0,0,0] row_mask:0xf bank_mask:0xf
    s_nop 0
    v_mul_f32_dpp v105, v109, v76 quad_perm:[0,0,0,0] row_mask:0xf bank_mask:0xf
    ds_write2_b32 v20, v104, v105 offset0:0 offset1:64
    s_cmp_lg_u32 s7, 0
    s_waitcnt lgkmcnt(0)
    s_barrier
    s_cbranch_scc1 Lsk_275
    ds_read2_b64 v[72:75], v21 offset0:0 offset1:64
    ds_read2_b64 v[76:79], v21 offset0:128 offset1:192
    s_waitcnt lgkmcnt(1)
    v_pk_add_f32 v[72:73], v[72:73], v[74:75]
    s_waitcnt lgkmcnt(0)
    v_pk_add_f32 v[76:77], v[76:77], v[78:79]
    v_pk_add_f32 v[72:73], v[72:73], v[76:77]
    v_cvt_pk_bf16_f32 v72, v72, v73
    buffer_store_dword v72, v8, s[16:19], s64 offen sc1
Lsk_275:
LS11_276:
    s_barrier
    s_waitcnt vmcnt(14)
Lfc_279:
    v_and_b32 v120, 0x80808080, v114
    v_cmp_ne_u32 vcc, 0x80808080, v120
    s_cbranch_vccnz Lretry_280
Lfok_278:
    v_and_b32 v120, 0x40404040, v114
    v_bcnt_u32_b32 v120, v120, 0
    s_nop 1
    v_add_u32_dpp v120, v120, v120 row_ror:1 row_mask:0xf bank_mask:0xf
    s_nop 1
    v_add_u32_dpp v120, v120, v120 row_ror:2 row_mask:0xf bank_mask:0xf
    s_nop 1
    v_add_u32_dpp v120, v120, v120 row_ror:4 row_mask:0xf bank_mask:0xf
    s_nop 1
    v_add_u32_dpp v120, v120, v120 row_ror:8 row_mask:0xf bank_mask:0xf
    s_nop 1
    v_add_u32_dpp v120, v120, v120 row_bcast:15 row_mask:0xa bank_mask:0xf
    s_nop 1
    v_add_u32_dpp v120, v120, v120 row_bcast:31 row_mask:0xc bank_mask:0xf
    s_nop 0
    v_readlane_b32 s67, v120, 63
    s_nop 0
    s_cmp_gt_u32 s67, 16
    s_cselect_b32 s67, 0, 0x2000
    s_lshl_b32 s68, s75, 11
    s_and_b32 s68, s68, 0x2000
    s_xor_b32 s66, s67, s68
    v_bfe_u32 v105, v0, 3, 2
    v_lshlrev_b32 v105, 11, v105
    v_and_b32 v104, 7, v0
    v_lshl_add_u32 v105, v104, 4, v105
    s_add_u32 s67, s76, 0x6000
Lp_281:
    buffer_load_dword v104, v105, s[16:19], s67 offen sc1
    s_sub_u32 s69, s69, 1
    s_cbranch_scc1 Lgive_282
    s_waitcnt vmcnt(0)
    v_cmp_eq_u32 vcc, -1, v104
    s_cbranch_vccnz Lp_281
Lok_283:
    s_cmp_lg_u32 s7, 1
    s_cbranch_scc1 La_287
    v_mov_b32 v42, 0
    v_mov_b32_e64 v43, 0
    buffer_atomic_or_x2 v[42:43], v13, s[16:19], s66 offen offset:0 sc0 sc1
La_287:
    v_accvgpr_read_b32 v72, a192
    v_accvgpr_read_b32 v73, a193
    v_accvgpr_read_b32 v74, a194
    v_accvgpr_read_b32 v75, a195
    v_accvgpr_read_b32 v76, a196
    v_accvgpr_read_b32 v77, a197
    v_accvgpr_read_b32 v78, a198
    v_accvgpr_read_b32 v79, a199
    v_accvgpr_read_b32 v80, a200
    v_accvgpr_read_b32 v81, a201
    v_accvgpr_read_b32 v82, a202
    v_accvgpr_read_b32 v83, a203
    v_accvgpr_read_b32 v84, a204
    v_accvgpr_read_b32 v85, a205
    v_accvgpr_read_b32 v86, a206
    v_accvgpr_read_b32 v87, a207
    v_perm_b32 v88, v74, v72, s70
    v_accvgpr_write_b32 a192, v88
    v_perm_b32 v89, v78, v76, s70
    v_accvgpr_write_b32 a193, v89
    v_perm_b32 v88, v82, v80, s70
    v_accvgpr_write_b32 a194, v88
    v_perm_b32 v89, v86, v84, s70
    v_accvgpr_write_b32 a195, v89
    v_perm_b32 v88, v74, v72, s71
    v_accvgpr_write_b32 a196, v88
    v_perm_b32 v89, v78, v76, s71
    v_accvgpr_write_b32 a197, v89
    v_perm_b32 v88, v82, v80, s71
    v_accvgpr_write_b32 a198, v88
    v_perm_b32 v89, v86, v84, s71
    v_accvgpr_write_b32 a199, v89
    v_perm_b32 v88, v75, v73, s70
    v_accvgpr_write_b32 a200, v88
    v_perm_b32 v89, v79, v77, s70
    v_accvgpr_write_b32 a201, v89
    v_perm_b32 v88, v83, v81, s70
    v_accvgpr_write_b32 a202, v88
    v_perm_b32 v89, v87, v85, s70
    v_accvgpr_write_b32 a203, v89
    v_perm_b32 v88, v75, v73, s71
    v_accvgpr_write_b32 a204, v88
    v_perm_b32 v89, v79, v77, s71
    v_accvgpr_write_b32 a205, v89
    v_perm_b32 v88, v83, v81, s71
    v_accvgpr_write_b32 a206, v88
    v_perm_b32 v89, v87, v85, s71
    v_accvgpr_write_b32 a207, v89
    s_cmp_lg_u32 s7, 1
    s_cbranch_scc1 La_288
    v_mov_b32 v44, 0
    v_mov_b32 v45, 0
    buffer_atomic_or_x2 v[44:45], v13, s[16:19], s66 offen offset:0 sc0 sc1
La_288:
    s_mov_b32 s68, 0xe8000
    v_mfma_f32_16x16x32_bf16 v[72:75], v[36:39], a[192:195], 0
    v_mfma_f32_16x16x32_bf16 v[76:79], v[36:39], a[196:199], 0
    v_mfma_f32_16x16x32_bf16 v[80:83], v[36:39], a[200:203], 0
    v_mfma_f32_16x16x32_bf16 v[84:87], v[36:39], a[204:207], 0
    s_mov_b64 exec, 0xffff
    s_nop 4
    v_mov_b32 v73, v76
    v_mov_b32 v74, v80
    v_mov_b32 v75, v84
    buffer_store_dwordx4 v[72:75], v14, s[16:19], s68 offen sc1
    s_mov_b64 exec, -1
    v_and_b32 v113, 0x30, v0
    s_cmp_lg_u32 s7, 0
    s_cbranch_scc1 Lpr_289
    s_branch Lb_284
Lpr_289:
    s_cmp_lg_u32 s7, 1
    s_cbranch_scc1 Lb_284
    v_and_b32 v112, 7, v0
    v_lshl_add_u32 v112, v112, 1, v113
Lp_285:
    v_mov_b32 v46, 0
    v_mov_b32 v47, 0
    buffer_atomic_or_x2 v[46:47], v13, s[16:19], s66 offen offset:0 sc0 sc1
    s_waitcnt vmcnt(2)
    v_cmp_gt_u32 vcc, 0x41000000, v43
    v_add_f64 v[110:111], v[42:43], v[40:41]
    s_cbranch_vccz Lok_286
    v_mov_b32 v42, 0
    v_mov_b32 v43, 0
    buffer_atomic_or_x2 v[42:43], v13, s[16:19], s66 offen offset:0 sc0 sc1
    s_waitcnt vmcnt(2)
    v_cmp_gt_u32 vcc, 0x41000000, v45
    v_add_f64 v[110:111], v[44:45], v[40:41]
    s_cbranch_vccz Lok_286
    v_mov_b32 v44, 0
    v_mov_b32 v45, 0
    buffer_atomic_or_x2 v[44:45], v13, s[16:19], s66 offen offset:0 sc0 sc1
    s_waitcnt vmcnt(2)
    v_cmp_gt_u32 vcc, 0x41000000, v47
    v_add_f64 v[110:111], v[46:47], v[40:41]
    s_cbranch_vccz Lok_286
    s_sub_u32 s69, s69, 1
    s_cbranch_scc0 Lp_285
    s_mov_b32 s69, 0
Lok_286:
    v_cvt_f32_f64 v109, v[110:111]
    s_nop 1
    v_add_f32_dpp v109, v109, v109 row_ror:8 row_mask:0xf bank_mask:0xf
    v_cvt_pk_bf16_f32 v109, v109, v109
    ds_write_b16 v112, v109 offset:10240
    s_waitcnt lgkmcnt(0)
Lb_284:
    s_barrier
    ds_read_b128 v[32:35], v113 offset:10240
    s_waitcnt lgkmcnt(0)
LS13_290:
    v_mfma_f32_16x16x32_bf16 v[72:75], v[32:35], a[192:195], 0
    v_mov_b32_dpp v36, v32 quad_perm:[0,1,2,3] row_mask:0xf bank_mask:0x3
    v_mov_b32_dpp v37, v33 quad_perm:[0,1,2,3] row_mask:0xf bank_mask:0x3
    v_mfma_f32_16x16x32_bf16 v[76:79], v[32:35], a[196:199], 0
    v_mov_b32_dpp v38, v34 quad_perm:[0,1,2,3] row_mask:0xf bank_mask:0x3
    v_mov_b32_dpp v39, v35 quad_perm:[0,1,2,3] row_mask:0xf bank_mask:0x3
    v_mfma_f32_16x16x32_bf16 v[80:83], v[32:35], a[200:203], 0
    v_mfma_f32_16x16x32_bf16 v[84:87], v[32:35], a[204:207], 0
    v_mfma_f32_16x16x32_bf16 v[120:123], v[32:35], v[36:39], 0
    s_mov_b64 exec, 0xffff
    s_nop 1
    v_mov_b32 v73, v76
    s_nop 1
    v_mov_b32 v74, v80
    v_mov_b32 v75, v84
    buffer_store_dwordx4 v[72:75], v14, s[16:19], s64 offen sc1
    s_mov_b64 exec, 0x101
    buffer_store_dword v120, v5, s[16:19], s64 offen offset:256 sc1
    s_mov_b64 exec, -1
    s_mov_b32 exec_lo, 0x00ff00ff
    s_mov_b32 exec_hi, 0x00ff00ff
    v_lshlrev_b32 v112, 16, v109
    v_accvgpr_read_b32 v113, a226
    v_lshlrev_b32 v113, 16, v113
    v_add_f32 v112, v112, v113
    v_cvt_f64_f32 v[40:41], v112
    v_add_f64 v[40:41], v[40:41], -s[0:1]
    s_mov_b64 exec, -1
LS14_291:
    v_and_b32 v113, 0x30, v0
    s_cmp_lg_u32 s7, 0
    s_cbranch_scc1 Lpr_295
    s_lshl_b32 s56, s3, 3
    s_lshl_b64 exec, 0xff, s56
    s_movk_i32 s66, 0x2000
    v_mov_b32 v42, 0
    v_mov_b32 v43, 0
    v_mov_b32 v44, 0
    v_mov_b32 v45, 0
    buffer_atomic_or_x2 v[42:43], v13, s[16:19], 0 offen offset:192 sc0 sc1
    buffer_atomic_or_x2 v[44:45], v13, s[16:19], s66 offen offset:192 sc0 sc1
    s_mov_b64 exec, -1
    s_waitcnt vmcnt(1)
    s_memtime s[56:57]
    s_waitcnt vmcnt(0)
    s_memtime s[58:59]
    s_waitcnt lgkmcnt(0)
    s_sub_u32 s56, s58, s56
    s_cmp_gt_u32 s56, 64
    s_cselect_b32 s66, 0, 8192
    v_mov_b32 v42, s66
    v_mov_b32 v43, 0
    ds_write_b32 v43, v42 offset:10368
Lpr_295:
    s_waitcnt vmcnt(0) lgkmcnt(0)
    s_barrier
    s_mov_b32 s68, 0xe8000
    buffer_load_dwordx4 a[248:251], v4, s[16:19], s68 offen sc1
    buffer_load_dwordx4 a[244:247], v3, s[16:19], s68 offen sc1
    s_cmp_lg_u32 s7, 1
    s_cbranch_scc1 Lbw_296
    s_cmp_lg_u32 s7, 1
    s_cbranch_scc1 Lb_292
    v_mov_b32 v43, 0
    ds_read_b32 v42, v43 offset:10368
    s_waitcnt lgkmcnt(0)
    v_readfirstlane_b32 s67, v42
    s_nop 0
    s_and_b32 s66, s67, 0x2000
    s_nop 15
    s_nop 15
    s_nop 15
    v_mov_b32 v42, 0
    v_mov_b32 v43, 0
    buffer_atomic_or_x2 v[42:43], v13, s[16:19], s66 offen offset:64 sc0 sc1
    v_and_b32 v112, 7, v0
    v_lshl_add_u32 v112, v112, 1, v113
    s_nop 15
    s_nop 15
    s_nop 15
    v_mov_b32 v44, 0
    v_mov_b32_e64 v45, 0
    buffer_atomic_or_x2 v[44:45], v13, s[16:19], s66 offen offset:64 sc0 sc1
    s_nop 15
    s_nop 15
    s_nop 15
Lp_293:
    v_mov_b32 v46, 0
    v_mov_b32 v47, 0
    buffer_atomic_or_x2 v[46:47], v13, s[16:19], s66 offen offset:64 sc0 sc1
    s_waitcnt vmcnt(2)
    v_cmp_gt_u32 vcc, 0x41000000, v43
    v_add_f64 v[110:111], v[42:43], v[40:41]
    s_cbranch_vccz Lok_294
    v_mov_b32 v42, 0
    v_mov_b32 v43, 0
    buffer_atomic_or_x2 v[42:43], v13, s[16:19], s66 offen offset:64 sc0 sc1
    s_waitcnt vmcnt(2)
    v_cmp_gt_u32 vcc, 0x41000000, v45
    v_add_f64 v[110:111], v[44:45], v[40:41]
    s_cbranch_vccz Lok_294
    v_mov_b32 v44, 0
    v_mov_b32 v45, 0
    buffer_atomic_or_x2 v[44:45], v13, s[16:19], s66 offen offset:64 sc0 sc1
    s_waitcnt vmcnt(2)
    v_cmp_gt_u32 vcc, 0x41000000, v47
    v_add_f64 v[110:111], v[46:47], v[40:41]
    s_cbranch_vccz Lok_294
    s_sub_u32 s69, s69, 1
    s_cbranch_scc0 Lp_293
    s_mov_b32 s69, 0
Lok_294:
    v_cvt_f32_f64 v109, v[110:111]
    s_nop 1
    v_add_f32_dpp v109, v109, v109 row_ror:8 row_mask:0xf bank_mask:0xf
    v_cvt_pk_bf16_f32 v109, v109, v109
    ds_write_b16 v112, v109 offset:10240
    s_waitcnt lgkmcnt(0)
Lb_292:
    s_barrier
    ds_read_b128 v[32:35], v113 offset:10240
    s_nop 0
    s_waitcnt lgkmcnt(0)
LS16_297:
    s_mov_b32 s64, 0x74000
    s_add_u32 s65, s79, 0x74000
    v_mfma_f32_16x16x32_bf16 v[72:75], v[32:35], a[128:131], 0
    v_mov_b32_dpp v36, v32 quad_perm:[0,1,2,3] row_mask:0xf bank_mask:0x3
    v_mov_b32_dpp v37, v33 quad_perm:[0,1,2,3] row_mask:0xf bank_mask:0x3
    v_mfma_f32_16x16x32_bf16 v[88:91], v[32:35], a[144:147], 0
    v_mov_b32_dpp v38, v34 quad_perm:[0,1,2,3] row_mask:0xf bank_mask:0x3
    v_mov_b32_dpp v39, v35 quad_perm:[0,1,2,3] row_mask:0xf bank_mask:0x3
    v_mfma_f32_16x16x32_bf16 v[76:79], v[32:35], a[132:135], 0
    v_mfma_f32_16x16x32_bf16 v[92:95], v[32:35], a[148:151], 0
    v_mfma_f32_16x16x32_bf16 v[120:123], v[32:35], v[36:39], 0
    v_mfma_f32_16x16x32_bf16 v[80:83], v[32:35], a[136:139], 0
    v_mfma_f32_16x16x32_bf16 v[96:99], v[32:35], a[152:155], 0
    v_mfma_f32_16x16x32_bf16 v[84:87], v[32:35], a[140:143], 0
    v_mfma_f32_16x16x32_bf16 v[100:103], v[32:35], a[156:159], 0
    s_mov_b64 exec, 0x101
    s_nop 2
    buffer_store_dword v120, v5, s[16:19], s64 offen sc1
    s_mov_b32 exec_lo, -1
    v_mov_b32_dpp v72, v88 quad_perm:[0,1,2,3] row_mask:0x2 bank_mask:0xf
    v_mov_b32_dpp v73, v76 quad_perm:[0,1,2,3] row_mask:0x1 bank_mask:0xf
    v_mov_b32_dpp v73, v92 quad_perm:[0,1,2,3] row_mask:0x2 bank_mask:0xf
    v_mov_b32_dpp v74, v80 quad_perm:[0,1,2,3] row_mask:0x1 bank_mask:0xf
    v_mov_b32_dpp v74, v96 quad_perm:[0,1,2,3] row_mask:0x2 bank_mask:0xf
    v_mov_b32_dpp v75, v84 quad_perm:[0,1,2,3] row_mask:0x1 bank_mask:0xf
    v_mov_b32_dpp v75, v100 quad_perm:[0,1,2,3] row_mask:0x2 bank_mask:0xf
    buffer_store_dwordx4 v[72:75], v2, s[16:19], s64 offen sc1
    s_mov_b64 exec, -1
    s_mov_b32 exec_lo, 0x00ff00ff
    s_mov_b32 exec_hi, 0x00ff00ff
    v_lshlrev_b32 v112, 16, v109
    v_cvt_f64_f32_e64 v[40:41], v112
    v_add_f64 v[40:41], v[40:41], -s[0:1]
    s_mov_b64 exec, -1
LS17_298:
    buffer_load_dwordx4 v[76:79], v4, s[16:19], s64 offen sc1
    buffer_load_dwordx4 v[72:75], v3, s[16:19], s64 offen sc1
    v_accvgpr_read_b32 v84, a244
    v_accvgpr_read_b32 v85, a245
    v_accvgpr_read_b32 v86, a246
    v_accvgpr_read_b32 v87, a247
    v_accvgpr_read_b32 v88, a248
    v_accvgpr_read_b32 v89, a249
    v_accvgpr_read_b32 v90, a250
    v_accvgpr_read_b32 v91, a251
    v_add_f32_dpp v84, v88, v84 quad_perm:[0,1,2,3] row_mask:0xf bank_mask:0xc
    v_add_f32_dpp v85, v89, v85 quad_perm:[0,1,2,3] row_mask:0xf bank_mask:0xc
    v_add_f32_dpp v86, v90, v86 quad_perm:[0,1,2,3] row_mask:0xf bank_mask:0xc
    v_add_f32_dpp v87, v91, v87 quad_perm:[0,1,2,3] row_mask:0xf bank_mask:0xc
    v_permlane32_swap_b32 v84, v85
    s_nop 0
    v_permlane32_swap_b32 v86, v87
    v_add_f32 v84, v84, v85
    v_add_f32 v86, v86, v87
    s_nop 1
    v_permlane16_swap_b32 v84, v86
    v_add_f32 v24, v84, v86
    s_nop 1
    v_add_f32_dpp v24, v24, v24 row_ror:8 row_mask:0xf bank_mask:0xf
    s_branch Lp_299w
Lp_299:
    buffer_load_dwordx4 v[76:79], v4, s[16:19], s64 offen sc1
    buffer_load_dwordx4 v[72:75], v3, s[16:19], s64 offen sc1
    s_sub_u32 s69, s69, 1
    s_cbranch_scc1 Lgive_301
Lp_299w:
    s_waitcnt vmcnt(1)
    v_pk_add_f32 v[80:81], v[76:77], v[78:79]
    s_nop 0
    s_nop 0
    v_add_f32_dpp v6, v80, v81 quad_perm:[0,1,2,3] row_mask:0xf bank_mask:0x3
    s_waitcnt vmcnt(0)
    v_add_f32_dpp v72, v76, v72 quad_perm:[0,1,2,3] row_mask:0xf bank_mask:0xc
    v_add_f32_dpp v73, v77, v73 quad_perm:[0,1,2,3] row_mask:0xf bank_mask:0xc
    v_add_f32_dpp v105, v6, v6 row_ror:2 row_mask:0xf bank_mask:0xf
    v_cmp_u_f32 vcc, v72, v6
    v_add_f32_dpp v74, v78, v74 quad_perm:[0,1,2,3] row_mask:0xf bank_mask:0xc
    v_add_f32_dpp v75, v79, v75 quad_perm:[0,1,2,3] row_mask:0xf bank_mask:0xc
    s_cbranch_vccnz Lp_299
    v_add_f32_dpp v105, v105, v105 row_ror:4 row_mask:0xf bank_mask:0xf
    v_permlane32_swap_b32 v72, v73
    s_nop 0
    v_add_f32_dpp v105, v105, v105 row_ror:8 row_mask:0xf bank_mask:0xf
    v_permlane32_swap_b32 v74, v75
    v_mul_f32 v105, 0x3acccccd, v105
    v_add_f32 v72, v72, v73
    s_nop 0
    v_mov_b32_dpp v106, v105 quad_perm:[0,0,2,2] row_mask:0xf bank_mask:0xf
    v_add_f32 v74, v74, v75
    v_mov_b32_dpp v107, v105 quad_perm:[1,1,3,3] row_mask:0xf bank_mask:0xf
    s_nop 0
    v_permlane16_swap_b32 v72, v74
    v_fma_f32 v107, -v106, v106, v107
    v_add_f32 v104, v72, v74
    v_max_f32 v107, 0, v107
    s_nop 0
    v_add_f32_dpp v104, v104, v104 row_ror:8 row_mask:0xf bank_mask:0xf
    v_add_f32 v107, 0x3727c5ac, v107
    v_rsq_f32 v107, v107
    v_fma_f32 v104, -v106, v24, v104
    v_mul_f32 v104, v104, v107
    v_cvt_pk_bf16_f32 v107, v104, v104
    v_cmp_u_f32 vcc, v104, v105
    s_cbranch_vccnz Lp_299
Lok_300:
    ds_write_b16 v16, v107
    s_waitcnt lgkmcnt(0)
    s_barrier
LS18_302:
    s_mov_b64 exec, s[80:81]
    ds_read_b128 v[48:51], v17
    s_mov_b64 exec, s[82:83]
    ds_read_b128 v[52:55], v17
    s_mov_b64 exec, s[84:85]
    ds_read_b128 v[56:59], v17
    s_mov_b64 exec, s[86:87]
    ds_read_b128 v[60:63], v17
    s_mov_b64 exec, -1
    s_waitcnt lgkmcnt(3)
    v_mfma_f32_16x16x32_bf16 v[72:75], a[0:3], v[48:51], 0
    v_mfma_f32_16x16x32_bf16 v[76:79], a[32:35], v[48:51], 0
    s_nop 0
    s_waitcnt lgkmcnt(2)
    v_mfma_f32_16x16x32_bf16 v[72:75], a[8:11], v[52:55], v[72:75]
    v_mfma_f32_16x16x32_bf16 v[76:79], a[40:43], v[52:55], v[76:79]
    s_waitcnt lgkmcnt(1)
    v_mfma_f32_16x16x32_bf16 v[72:75], a[16:19], v[56:59], v[72:75]
    v_mfma_f32_16x16x32_bf16 v[76:79], a[48:51], v[56:59], v[76:79]
    s_waitcnt lgkmcnt(0)
    v_mfma_f32_16x16x32_bf16 v[72:75], a[24:27], v[60:63], v[72:75]
    v_mfma_f32_16x16x32_bf16 v[76:79], a[56:59], v[60:63], v[76:79]
    v_mfma_f32_16x16x32_bf16 v[80:83], a[64:67], v[48:51], 0
    v_mfma_f32_16x16x32_bf16 v[84:87], a[96:99], v[48:51], 0
    v_mfma_f32_16x16x32_bf16 v[80:83], a[72:75], v[52:55], v[80:83]
    v_mfma_f32_16x16x32_bf16 v[84:87], a[104:107], v[52:55], v[84:87]
    v_mfma_f32_16x16x32_bf16 v[80:83], a[80:83], v[56:59], v[80:83]
    v_mfma_f32_16x16x32_bf16 v[84:87], a[112:115], v[56:59], v[84:87]
    v_mfma_f32_16x16x32_bf16 v[80:83], a[88:91], v[60:63], v[80:83]
    v_add_f32_dpp v104, v73, v72 row_ror:12 row_mask:0xf bank_mask:0x1
    v_add_f32_dpp v104, v74, v104 row_ror:8 row_mask:0xf bank_mask:0x1
    v_mfma_f32_16x16x32_bf16 v[84:87], a[120:123], v[60:63], v[84:87]
    v_add_f32_dpp v104, v75, v104 row_ror:4 row_mask:0xf bank_mask:0x1
    v_add_f32_dpp v104, v76, v77 row_ror:4 row_mask:0xf bank_mask:0x2
    v_mfma_f32_16x16x32_bf16 v[88:91], a[4:7], v[48:51], 0
    v_add_f32_dpp v104, v78, v104 row_ror:12 row_mask:0xf bank_mask:0x2
    v_add_f32_dpp v104, v79, v104 row_ror:8 row_mask:0xf bank_mask:0x2
    v_mfma_f32_16x16x32_bf16 v[92:95], a[36:39], v[48:51], 0
    v_add_f32_dpp v104, v80, v82 row_ror:8 row_mask:0xf bank_mask:0x4
    v_add_f32_dpp v104, v81, v104 row_ror:4 row_mask:0xf bank_mask:0x4
    v_mfma_f32_16x16x32_bf16 v[88:91], a[12:15], v[52:55], v[88:91]
    v_add_f32_dpp v104, v83, v104 row_ror:12 row_mask:0xf bank_mask:0x4
    v_add_f32_dpp v104, v84, v87 row_ror:12 row_mask:0xf bank_mask:0x8
    v_mfma_f32_16x16x32_bf16 v[92:95], a[44:47], v[52:55], v[92:95]
    v_add_f32_dpp v104, v85, v104 row_ror:8 row_mask:0xf bank_mask:0x8
    v_add_f32_dpp v104, v86, v104 row_ror:4 row_mask:0xf bank_mask:0x8
    v_mfma_f32_16x16x32_bf16 v[88:91], a[20:23], v[56:59], v[88:91]
    v_mfma_f32_16x16x32_bf16 v[92:95], a[52:55], v[56:59], v[92:95]
    v_mfma_f32_16x16x32_bf16 v[88:91], a[28:31], v[60:63], v[88:91]
    v_mfma_f32_16x16x32_bf16 v[92:95], a[60:63], v[60:63], v[92:95]
    v_mfma_f32_16x16x32_bf16 v[96:99], a[68:71], v[48:51], 0
    v_mfma_f32_16x16x32_bf16 v[100:103], a[100:103], v[48:51], 0
    v_mfma_f32_16x16x32_bf16 v[96:99], a[76:79], v[52:55], v[96:99]
    v_mfma_f32_16x16x32_bf16 v[100:103], a[108:111], v[52:55], v[100:103]
    v_mfma_f32_16x16x32_bf16 v[96:99], a[84:87], v[56:59], v[96:99]
    v_mfma_f32_16x16x32_bf16 v[100:103], a[116:119], v[56:59], v[100:103]
    v_mfma_f32_16x16x32_bf16 v[96:99], a[92:95], v[60:63], v[96:99]
    v_add_f32_dpp v105, v89, v88 row_ror:12 row_mask:0xf bank_mask:0x1
    v_add_f32_dpp v105, v90, v105 row_ror:8 row_mask:0xf bank_mask:0x1
    v_mfma_f32_16x16x32_bf16 v[100:103], a[124:127], v[60:63], v[100:103]
    v_add_f32_dpp v105, v91, v105 row_ror:4 row_mask:0xf bank_mask:0x1
    v_add_f32_dpp v105, v92, v93 row_ror:4 row_mask:0xf bank_mask:0x2
    v_add_f32_dpp v105, v94, v105 row_ror:12 row_mask:0xf bank_mask:0x2
    v_add_f32_dpp v105, v95, v105 row_ror:8 row_mask:0xf bank_mask:0x2
    s_nop 0
    v_add_f32_dpp v105, v96, v98 row_ror:8 row_mask:0xf bank_mask:0x4
    v_add_f32_dpp v105, v97, v105 row_ror:4 row_mask:0xf bank_mask:0x4
    v_add_f32_dpp v105, v99, v105 row_ror:12 row_mask:0xf bank_mask:0x4
    v_add_f32_dpp v105, v100, v103 row_ror:12 row_mask:0xf bank_mask:0x8
    v_add_f32_dpp v105, v101, v105 row_ror:8 row_mask:0xf bank_mask:0x8
    v_add_f32_dpp v105, v102, v105 row_ror:4 row_mask:0xf bank_mask:0x8
    v_max_f32 v106, v104, v105
    s_nop 1
    v_max_f32_dpp v106, v106, v106 row_ror:1 row_mask:0xf bank_mask:0xf
    s_nop 1
    v_max_f32_dpp v106, v106, v106 row_ror:2 row_mask:0xf bank_mask:0xf
    s_nop 1
    v_max_f32_dpp v106, v106, v106 row_ror:4 row_mask:0xf bank_mask:0xf
    s_nop 1
    v_max_f32_dpp v106, v106, v106 row_ror:8 row_mask:0xf bank_mask:0xf
    s_nop 1
    v_max_f32_dpp v106, v106, v106 row_bcast:15 row_mask:0xa bank_mask:0xf
    s_nop 1
    v_max_f32_dpp v106, v106, v106 row_bcast:31 row_mask:0xc bank_mask:0xf
    v_mul_f32 v106, v106, v27
    s_nop 0
    v_readlane_b32 s72, v106, 63
    s_nop 1
    v_fma_f32 v104, v104, v27, -s72
    v_fma_f32 v105, v105, v27, -s72
    v_exp_f32 v104, v104
    v_exp_f32 v105, v105
    s_nop 0
    v_cvt_pk_bf16_f32 v108, v104, v105
LS19_303:
    s_nop 1
    v_mov_b32_dpp v64, v108 row_newbcast:0 row_mask:0xf bank_mask:0x1
    v_mov_b32_dpp v65, v108 row_newbcast:0 row_mask:0xf bank_mask:0x2
    v_mov_b32_dpp v66, v108 row_newbcast:0 row_mask:0xf bank_mask:0x4
    v_mov_b32_dpp v67, v108 row_newbcast:0 row_mask:0xf bank_mask:0x8
    s_nop 1
    v_mfma_f32_16x16x32_bf16 v[72:75], v[64:67], v[126:129], 0
    v_mov_b32_dpp v68, v108 row_newbcast:1 row_mask:0xf bank_mask:0x1
    v_mov_b32_dpp v69, v108 row_newbcast:1 row_mask:0xf bank_mask:0x2
    v_mov_b32_dpp v70, v108 row_newbcast:1 row_mask:0xf bank_mask:0x4
    v_mfma_f32_16x16x32_bf16 v[76:79], v[64:67], v[130:133], 0
    v_mov_b32_dpp v71, v108 row_newbcast:1 row_mask:0xf bank_mask:0x8
    v_lshlrev_b32_e64 v107, 16, v108
    v_and_b32 v104, 0xffff0000, v108
    v_mfma_f32_16x16x32_bf16 v[72:75], v[68:71], v[134:137], v[72:75]
    v_mov_b32_dpp v64, v108 row_newbcast:2 row_mask:0xf bank_mask:0x1
    v_mov_b32_dpp v65, v108 row_newbcast:2 row_mask:0xf bank_mask:0x2
    v_mov_b32_dpp v66, v108 row_newbcast:2 row_mask:0xf bank_mask:0x4
    v_mfma_f32_16x16x32_bf16 v[76:79], v[68:71], v[138:141], v[76:79]
    v_mov_b32_dpp v67, v108 row_newbcast:2 row_mask:0xf bank_mask:0x8
    v_add_f32 v107, v107, v104
    s_nop 1
    v_add_f32_dpp v107, v107, v107 row_ror:1 row_mask:0xf bank_mask:0xf
    v_mfma_f32_16x16x32_bf16 v[72:75], v[64:67], v[142:145], v[72:75]
    v_mov_b32_dpp v68, v108 row_newbcast:3 row_mask:0xf bank_mask:0x1
    v_mov_b32_dpp v69, v108 row_newbcast:3 row_mask:0xf bank_mask:0x2
    v_mov_b32_dpp v70, v108 row_newbcast:3 row_mask:0xf bank_mask:0x4
    v_mfma_f32_16x16x32_bf16 v[76:79], v[64:67], v[146:149], v[76:79]
    v_mov_b32_dpp v71, v108 row_newbcast:3 row_mask:0xf bank_mask:0x8
    v_add_f32_dpp v107, v107, v107 row_ror:2 row_mask:0xf bank_mask:0xf
    s_nop 0
    v_mfma_f32_16x16x32_bf16 v[72:75], v[68:71], v[150:153], v[72:75]
    v_mov_b32_dpp v64, v108 row_newbcast:4 row_mask:0xf bank_mask:0x1
    v_mov_b32_dpp v65, v108 row_newbcast:4 row_mask:0xf bank_mask:0x2
    v_mov_b32_dpp v66, v108 row_newbcast:4 row_mask:0xf bank_mask:0x4
    v_mfma_f32_16x16x32_bf16 v[76:79], v[68:71], v[154:157], v[76:79]
    v_mov_b32_dpp v67, v108 row_newbcast:4 row_mask:0xf bank_mask:0x8
    v_add_f32_dpp v107, v107, v107 row_ror:4 row_mask:0xf bank_mask:0xf
    s_nop 0
    v_mfma_f32_16x16x32_bf16 v[72:75], v[64:67], v[158:161], v[72:75]
    v_mov_b32_dpp v68, v108 row_newbcast:5 row_mask:0xf bank_mask:0x1
    v_mov_b32_dpp v69, v108 row_newbcast:5 row_mask:0xf bank_mask:0x2
    v_mov_b32_dpp v70, v108 row_newbcast:5 row_mask:0xf bank_mask:0x4
    v_mfma_f32_16x16x32_bf16 v[76:79], v[64:67], v[162:165], v[76:79]
    v_mov_b32_dpp v71, v108 row_newbcast:5 row_mask:0xf bank_mask:0x8
    v_add_f32_dpp v107, v107, v107 row_ror:8 row_mask:0xf bank_mask:0xf
    s_nop 0
    v_mfma_f32_16x16x32_bf16 v[72:75], v[68:71], v[166:169], v[72:75]
    v_mov_b32_dpp v64, v108 row_newbcast:6 row_mask:0xf bank_mask:0x1
    v_mov_b32_dpp v65, v108 row_newbcast:6 row_mask:0xf bank_mask:0x2
    v_mov_b32_dpp v66, v108 row_newbcast:6 row_mask:0xf bank_mask:0x4
    v_mfma_f32_16x16x32_bf16 v[76:79], v[68:71], v[170:173], v[76:79]
    v_mov_b32_dpp v67, v108 row_newbcast:6 row_mask:0xf bank_mask:0x8
    v_add_f32_dpp v107, v107, v107 row_bcast:15 row_mask:0xa bank_mask:0xf
    s_nop 0
    v_mfma_f32_16x16x32_bf16 v[72:75], v[64:67], v[174:177], v[72:75]
    v_mov_b32_dpp v68, v108 row_newbcast:7 row_mask:0xf bank_mask:0x1
    v_mov_b32_dpp v69, v108 row_newbcast:7 row_mask:0xf bank_mask:0x2
    v_mov_b32_dpp v70, v108 row_newbcast:7 row_mask:0xf bank_mask:0x4
    v_mfma_f32_16x16x32_bf16 v[76:79], v[64:67], v[178:181], v[76:79]
    v_mov_b32_dpp v71, v108 row_newbcast:7 row_mask:0xf bank_mask:0x8
    v_add_f32_dpp v107, v107, v107 row_bcast:31 row_mask:0xc bank_mask:0xf
    s_nop 0
    v_mfma_f32_16x16x32_bf16 v[72:75], v[68:71], v[182:185], v[72:75]
    v_mov_b32_dpp v64, v108 row_newbcast:8 row_mask:0xf bank_mask:0x1
    v_mov_b32_dpp v65, v108 row_newbcast:8 row_mask:0xf bank_mask:0x2
    v_mov_b32_dpp v66, v108 row_newbcast:8 row_mask:0xf bank_mask:0x4
    v_mfma_f32_16x16x32_bf16 v[76:79], v[68:71], v[186:189], v[76:79]
    v_mov_b32_dpp v67, v108 row_newbcast:8 row_mask:0xf bank_mask:0x8
    ds_write_b64 v18, v[106:107]
    s_nop 0
    v_mfma_f32_16x16x32_bf16 v[72:75], v[64:67], v[190:193], v[72:75]
    v_mov_b32_dpp v68, v108 row_newbcast:9 row_mask:0xf bank_mask:0x1
    v_mov_b32_dpp v69, v108 row_newbcast:9 row_mask:0xf bank_mask:0x2
    v_mov_b32_dpp v70, v108 row_newbcast:9 row_mask:0xf bank_mask:0x4
    v_mfma_f32_16x16x32_bf16 v[76:79], v[64:67], v[194:197], v[76:79]
    v_mov_b32_dpp v71, v108 row_newbcast:9 row_mask:0xf bank_mask:0x8
    s_waitcnt lgkmcnt(0)
    s_barrier
    ds_read_b64 v[110:111], v19
    v_mfma_f32_16x16x32_bf16 v[72:75], v[68:71], v[198:201], v[72:75]
    v_mov_b32_dpp v64, v108 row_newbcast:10 row_mask:0xf bank_mask:0x1
    v_mov_b32_dpp v65, v108 row_newbcast:10 row_mask:0xf bank_mask:0x2
    v_mov_b32_dpp v66, v108 row_newbcast:10 row_mask:0xf bank_mask:0x4
    v_mfma_f32_16x16x32_bf16 v[76:79], v[68:71], v[202:205], v[76:79]
    v_mov_b32_dpp v67, v108 row_newbcast:10 row_mask:0xf bank_mask:0x8
    s_nop 0
    s_nop 0
    v_mfma_f32_16x16x32_bf16 v[72:75], v[64:67], v[206:209], v[72:75]
    v_mov_b32_dpp v68, v108 row_newbcast:11 row_mask:0xf bank_mask:0x1
    v_mov_b32_dpp v69, v108 row_newbcast:11 row_mask:0xf bank_mask:0x2
    v_mov_b32_dpp v70, v108 row_newbcast:11 row_mask:0xf bank_mask:0x4
    v_mfma_f32_16x16x32_bf16 v[76:79], v[64:67], v[210:213], v[76:79]
    v_mov_b32_dpp v71, v108 row_newbcast:11 row_mask:0xf bank_mask:0x8
    s_waitcnt lgkmcnt(0)
    s_nop 0
    v_mfma_f32_16x16x32_bf16 v[72:75], v[68:71], v[214:217], v[72:75]
    v_mov_b32_dpp v64, v108 row_newbcast:12 row_mask:0xf bank_mask:0x1
    v_mov_b32_dpp v65, v108 row_newbcast:12 row_mask:0xf bank_mask:0x2
    v_mov_b32_dpp v66, v108 row_newbcast:12 row_mask:0xf bank_mask:0x4
    v_mfma_f32_16x16x32_bf16 v[76:79], v[68:71], v[218:221], v[76:79]
    v_mov_b32_dpp v67, v108 row_newbcast:12 row_mask:0xf bank_mask:0x8
    v_max_f32_dpp v112, v110, v110 quad_perm:[1,0,3,2] row_mask:0xf bank_mask:0xf
    s_nop 0
    v_mfma_f32_16x16x32_bf16 v[72:75], v[64:67], v[222:225], v[72:75]
    v_mov_b32_dpp v68, v108 row_newbcast:13 row_mask:0xf bank_mask:0x1
    v_mov_b32_dpp v69, v108 row_newbcast:13 row_mask:0xf bank_mask:0x2
    v_mov_b32_dpp v70, v108 row_newbcast:13 row_mask:0xf bank_mask:0x4
    v_mfma_f32_16x16x32_bf16 v[76:79], v[64:67], v[226:229], v[76:79]
    v_mov_b32_dpp v71, v108 row_newbcast:13 row_mask:0xf bank_mask:0x8
    v_max_f32_dpp v112, v112, v112 quad_perm:[2,3,0,1] row_mask:0xf bank_mask:0xf
    v_sub_f32 v109, v110, v112
    v_mfma_f32_16x16x32_bf16 v[72:75], v[68:71], v[230:233], v[72:75]
    v_mov_b32_dpp v64, v108 row_newbcast:14 row_mask:0xf bank_mask:0x1
    v_mov_b32_dpp v65, v108 row_newbcast:14 row_mask:0xf bank_mask:0x2
    v_mov_b32_dpp v66, v108 row_newbcast:14 row_mask:0xf bank_mask:0x4
    v_mfma_f32_16x16x32_bf16 v[76:79], v[68:71], v[234:237], v[76:79]
    v_mov_b32_dpp v67, v108 row_newbcast:14 row_mask:0xf bank_mask:0x8
    v_exp_f32 v109, v109
    s_nop 0
    v_mfma_f32_16x16x32_bf16 v[72:75], v[64:67], v[238:241], v[72:75]
    v_mov_b32_dpp v68, v108 row_newbcast:15 row_mask:0xf bank_mask:0x1
    v_mov_b32_dpp v69, v108 row_newbcast:15 row_mask:0xf bank_mask:0x2
    v_mov_b32_dpp v70, v108 row_newbcast:15 row_mask:0xf bank_mask:0x4
    v_mfma_f32_16x16x32_bf16 v[76:79], v[64:67], v[242:245], v[76:79]
    v_mov_b32_dpp v71, v108 row_newbcast:15 row_mask:0xf bank_mask:0x8
    v_mul_f32 v113, v109, v111
    s_nop 0
    v_mfma_f32_16x16x32_bf16 v[72:75], v[68:71], v[246:249], v[72:75]
    v_mfma_f32_16x16x32_bf16 v[76:79], v[68:71], v[250:253], v[76:79]
    v_add_f32_dpp v113, v113, v113 quad_perm:[1,0,3,2] row_mask:0xf bank_mask:0xf
    s_nop 0
    s_nop 0
    v_add_f32_dpp v113, v113, v113 quad_perm:[2,3,0,1] row_mask:0xf bank_mask:0xf
    s_cmp_lg_u32 s7, 0
    s_cbranch_scc1 Lnos_304
    s_mov_b64 exec, 0x10001
    buffer_store_dwordx2 v[112:113], v1, s[16:19], s65 offen sc1
    s_mov_b64 exec, -1
Lnos_304:
LS20_305:
    s_nop 0
    v_mul_f32_dpp v104, v109, v72 quad_perm:[0,0,0,0] row_mask:0xf bank_mask:0xf
    v_mul_f32_dpp v105, v109, v76 quad_perm:[0,0,0,0] row_mask:0xf bank_mask:0xf
    ds_write2_b32 v20, v104, v105 offset0:0 offset1:64
    s_cmp_lg_u32 s7, 0
    s_waitcnt lgkmcnt(0)
    s_barrier
    s_cbranch_scc1 Lsk_306
    ds_read2_b64 v[72:75], v21 offset0:0 offset1:64
    ds_read2_b64 v[76:79], v21 offset0:128 offset1:192
    s_waitcnt lgkmcnt(1)
    v_pk_add_f32 v[72:73], v[72:73], v[74:75]
    s_waitcnt lgkmcnt(0)
    v_pk_add_f32 v[76:77], v[76:77], v[78:79]
    v_pk_add_f32 v[72:73], v[72:73], v[76:77]
    v_cvt_pk_bf16_f32 v72, v72, v73
    buffer_store_dword v72, v8, s[16:19], s64 offen sc1
Lsk_306:
LS21_307:
    v_and_b32 v113, 0x30, v0
    s_cmp_lg_u32 s7, 1
    s_cbranch_scc1 Lb_308
    s_nop 15
    s_nop 15
    s_nop 15
    s_nop 15
    s_nop 15
    s_nop 15
    s_nop 15
    s_nop 15
    s_nop 15
    s_nop 15
    s_nop 15
    s_nop 15
    s_nop 15
    s_nop 15
    s_nop 15
    s_nop 15
    s_nop 15
    s_nop 15
    s_nop 15
    v_mov_b32 v42, 0
    v_mov_b32 v43, 0
    buffer_atomic_or_x2 v[42:43], v13, s[16:19], s66 offen offset:128 sc0 sc1
    v_and_b32 v112, 7, v0
    v_lshl_add_u32 v112, v112, 1, v113
    s_nop 15
    s_nop 15
    s_nop 15
    v_mov_b32 v44, 0
    v_mov_b32 v45, 0
    buffer_atomic_or_x2 v[44:45], v13, s[16:19], s66 offen offset:128 sc0 sc1
    s_nop 15
    s_nop 15
    s_nop 15
Lp_309:
    v_mov_b32 v46, 0
    v_mov_b32_e64 v47, 0
    buffer_atomic_or_x2 v[46:47], v13, s[16:19], s66 offen offset:128 sc0 sc1
    s_waitcnt vmcnt(2)
    v_cmp_gt_u32 vcc, 0x41000000, v43
    v_add_f64 v[110:111], v[42:43], v[40:41]
    s_cbranch_vccz Lok_310
    v_mov_b32 v42, 0
    v_mov_b32_e64 v43, 0
    buffer_atomic_or_x2 v[42:43], v13, s[16:19], s66 offen offset:128 sc0 sc1
    s_waitcnt vmcnt(2)
    v_cmp_gt_u32 vcc, 0x41000000, v45
    v_add_f64 v[110:111], v[44:45], v[40:41]
    s_cbranch_vccz Lok_310
    v_mov_b32 v44, 0
    v_mov_b32 v45, 0
    buffer_atomic_or_x2 v[44:45], v13, s[16:19], s66 offen offset:128 sc0 sc1
    s_waitcnt vmcnt(2)
    v_cmp_gt_u32 vcc, 0x41000000, v47
    v_add_f64 v[110:111], v[46:47], v[40:41]
    s_cbranch_vccz Lok_310
    s_sub_u32 s69, s69, 1
    s_cbranch_scc0 Lp_309
    s_mov_b32 s69, 0
Lok_310:
    v_cvt_f32_f64_e64 v109, v[110:111]
    s_nop 1
    v_add_f32_dpp v109, v109, v109 row_ror:8 row_mask:0xf bank_mask:0xf
    v_cvt_pk_bf16_f32 v109, v109, v109
    ds_write_b16 v112, v109 offset:10240
    s_waitcnt lgkmcnt(0)
Lb_308:
    s_barrier
    ds_read_b128 v[32:35], v113 offset:10240
    s_waitcnt lgkmcnt(0)
LS23_311:
    v_mfma_f32_16x16x32_bf16 v[72:75], v[32:35], a[192:195], 0
    v_mov_b32_dpp v36, v32 quad_perm:[0,1,2,3] row_mask:0xf bank_mask:0x3
    v_mov_b32_dpp v37, v33 quad_perm:[0,1,2,3] row_mask:0xf bank_mask:0x3
    v_mfma_f32_16x16x32_bf16 v[76:79], v[32:35], a[196:199], 0
    v_mov_b32_dpp v38, v34 quad_perm:[0,1,2,3] row_mask:0xf bank_mask:0x3
    v_mov_b32_dpp v39, v35 quad_perm:[0,1,2,3] row_mask:0xf bank_mask:0x3
    v_mfma_f32_16x16x32_bf16 v[80:83], v[32:35], a[200:203], 0
    v_mfma_f32_16x16x32_bf16 v[84:87], v[32:35], a[204:207], 0
    v_mfma_f32_16x16x32_bf16 v[120:123], v[32:35], v[36:39], 0
    s_mov_b64 exec, 0xffff
    s_nop 1
    v_mov_b32 v73, v76
    s_nop 1
    v_mov_b32 v74, v80
    v_mov_b32 v75, v84
    buffer_store_dwordx4 v[72:75], v14, s[16:19], s64 offen sc1
    s_mov_b64 exec, 0x101
    buffer_store_dword v120, v5, s[16:19], s64 offen offset:256 sc1
    s_mov_b64 exec, -1
    s_mov_b32 exec_lo, 0x00ff00ff
    s_mov_b32 exec_hi, 0x00ff00ff
    v_lshlrev_b32 v112, 16, v109
    v_accvgpr_read_b32 v113, a226
    v_lshlrev_b32 v113, 16, v113
    v_add_f32 v112, v112, v113
    v_cvt_f64_f32 v[40:41], v112
    v_add_f64 v[40:41], v[40:41], -s[0:1]
    s_mov_b64 exec, -1
LS24_312:
    s_mov_b32 s67, s3
    s_cmp_lg_u32 s67, 0
    s_cbranch_scc1 Lfin_313
    v_and_b32 v113, 0x30, v0
    s_cmp_lg_u32 s7, 1
    s_cbranch_scc1 Lb_314
    s_waitcnt vmcnt(0)
    v_mov_b32 v42, 0
    v_mov_b32 v43, 0
    buffer_atomic_or_x2 v[42:43], v13, s[16:19], s66 offen offset:192 sc0 sc1
    v_and_b32 v112, 7, v0
    v_lshl_add_u32 v112, v112, 1, v113
    s_lshl_b32 s67, s74, 6
    s_nop 15
    s_nop 15
    v_mov_b32 v44, 0
    v_mov_b32 v45, 0
    buffer_atomic_or_x2 v[44:45], v13, s[16:19], s66 offen offset:192 sc0 sc1
    s_nop 15
    s_nop 15
Lp_315:
    v_mov_b32 v46, 0
    v_mov_b32 v47, 0
    buffer_atomic_or_x2 v[46:47], v13, s[16:19], s66 offen offset:192 sc0 sc1
    s_waitcnt vmcnt(2)
    v_cmp_gt_u32 vcc, 0x41000000, v43
    v_add_f64 v[110:111], v[42:43], v[40:41]
    s_cbranch_vccz Lok_316
    v_mov_b32 v42, 0
    v_mov_b32 v43, 0
    buffer_atomic_or_x2 v[42:43], v13, s[16:19], s66 offen offset:192 sc0 sc1
    s_waitcnt vmcnt(2)
    v_cmp_gt_u32 vcc, 0x41000000, v45
    v_add_f64 v[110:111], v[44:45], v[40:41]
    s_cbranch_vccz Lok_316
    v_mov_b32 v44, 0
    v_mov_b32 v45, 0
    buffer_atomic_or_x2 v[44:45], v13, s[16:19], s66 offen offset:192 sc0 sc1
    s_waitcnt vmcnt(2)
    v_cmp_gt_u32 vcc, 0x41000000, v47
    v_add_f64 v[110:111], v[46:47], v[40:41]
    s_cbranch_vccz Lok_316
    s_sub_u32 s69, s69, 1
    s_cbranch_scc0 Lp_315
    s_mov_b32 s69, 0
Lok_316:
    v_cvt_f32_f64 v109, v[110:111]
    s_nop 1
    v_add_f32_dpp v109, v109, v109 row_ror:8 row_mask:0xf bank_mask:0xf
    v_cvt_pk_bf16_f32 v109, v109, v109
    s_mov_b32 exec_lo, 0x00ff00ff
    s_mov_b32 exec_hi, 0x00ff00ff
    buffer_store_short v109, v112, s[48:51], s67 offen
    s_mov_b64 exec, -1
Lb_314:
Lfin_313:
    s_endpgm
Lretry_280:
    s_cmp_eq_u32 s69, 0
    s_cbranch_scc1 Lfok_278
    s_sub_u32 s69, s69, 1
    s_branch Lfp_277
Lfp_277:
    buffer_load_dword v114, v119, s[52:55], 0 offen sc1
    s_waitcnt vmcnt(0)
    s_branch Lfc_279
Lgive_282:
    s_mov_b32 s69, 0
    s_waitcnt vmcnt(0)
    s_branch Lok_283
Lbw_296:
    s_waitcnt vmcnt(0)
    s_branch Lb_292
Lgive_301:
    s_mov_b32 s69, 0
    s_waitcnt vmcnt(0)
    s_branch Lok_300
.section .rodata,"a"
.p2align 6
.amdhsa_kernel interleave_layers__gqa_block_cached__mixer_channel_mlp__decode_kernel
  .amdhsa_next_free_vgpr 512
  .amdhsa_next_free_sgpr 102
  .amdhsa_accum_offset 256
  .amdhsa_group_segment_fixed_size 0
  .amdhsa_kernarg_size 104
  .amdhsa_user_sgpr_count 2
  .amdhsa_user_sgpr_kernarg_segment_ptr 1
  .amdhsa_system_sgpr_workgroup_id_x 1
.end_amdhsa_kernel
```
